```python
import torch

def _softmax(x, axis=-1):
    return torch.softmax(x, dim=axis)

def _gelu(x):
    return torch.nn.functional.gelu(x, approximate='tanh')

def _silu(x):
    return torch.nn.functional.silu(x)

def _sigmoid(x):
    return torch.sigmoid(x)

def _layernorm(x, axis=-1, eps=1e-05):
    m = x.mean(dim=axis, keepdim=True)
    v = x.var(dim=axis, keepdim=True, unbiased=False)
    return (x - m) / torch.sqrt(v + eps)

def _scatter_add(tgt, idx, src, axis=0):
    return tgt.clone().index_add_(axis, idx, src)

def _segment_sum(src, seg, n):
    out = torch.zeros((n,) + src.shape[1:], dtype=src.dtype)
    return out.index_add_(0, seg, src)

def _pad(x, pw):
    flat = tuple((v for pair in reversed(pw) for v in pair))
    return torch.nn.functional.pad(x, flat)
kernel_name = 'adaLN_cond__ssm_conv_h3__glu_gated_geglu__prompt'

def setup_inputs():

    _w = lambda a: (lambda t: t.to(torch.bfloat16) if t.is_floating_point() else t)(torch.as_tensor(a))

    def _A_setup():
        B, S, D = (1, 2048, 1024)
        ks = 4
        return {'q': _w((lambda *s: torch.randn(*s, dtype=torch.bfloat16) * 0.05)(B, S, D)), 'k': _w((lambda *s: torch.randn(*s, dtype=torch.bfloat16) * 1.6)(B, S, D)), 'v': _w((lambda *s: torch.randn(*s, dtype=torch.bfloat16) * 1.6)(B, S, D)), 'shift_k': _w((lambda *s: torch.randn(*s, dtype=torch.bfloat16) * 1.6)(D, ks) * 0.5), 'ssm_k': _w((lambda *s: torch.randn(*s, dtype=torch.bfloat16) * 1.6)(D, S) * (1.0 / S ** 0.5)), 'ssm_D': _w((lambda *s: torch.randn(*s, dtype=torch.bfloat16) * 1.6)(D))}
    _A_in = _A_setup()

    def _B_setup():
        B, S, Dm, Df = (1, 2048, 1024, 3584)
        return {'x': _w((lambda *s: torch.randn(*s, dtype=torch.bfloat16) * 0.05)(B, S, Dm)), 'w_gate': _w((lambda *s: torch.randn(*s, dtype=torch.bfloat16) * 3.2)(Dm, Df) * Dm ** (-0.5)), 'w_up': _w((lambda *s: torch.randn(*s, dtype=torch.bfloat16) * 3.2)(Dm, Df) * Dm ** (-0.5)), 'w_down': _w((lambda *s: torch.randn(*s, dtype=torch.bfloat16) * 3.2)(Df, Dm) * Df ** (-0.5))}
    _B_in = _B_setup()
    return {'A_q': _A_in['q'], 'A_k': _A_in['k'], 'A_v': _A_in['v'], 'A_shift_k': _A_in['shift_k'], 'A_ssm_k': _A_in['ssm_k'], 'A_ssm_D': _A_in['ssm_D'], 'B_x': _B_in['x'], 'B_w_gate': _B_in['w_gate'], 'B_w_up': _B_in['w_up'], 'B_w_down': _B_in['w_down'], 'c': _w((lambda *s: torch.randn(*s, dtype=torch.bfloat16) * 0.1)(1, 1024) * 8.0), 'w_mod': _w((lambda *s: torch.randn(*s, dtype=torch.bfloat16) * 0.1)(1024, 6 * 1024) * 1024 ** (-0.5) * 8.0)}

def reference(A_q, A_k, A_v, A_shift_k, A_ssm_k, A_ssm_D, B_x, B_w_gate, B_w_up, B_w_down, c, w_mod):

    def _A_ref(q, k, v, shift_k, ssm_k, ssm_D):
        B, S, D = q.shape
        ks = shift_k.shape[-1]
        k_pad = _pad(k, ((0, 0), (ks - 1, 0), (0, 0)))
        k_shift = torch.zeros_like(k)
        for t in range(ks):
            k_shift = k_shift + k_pad[:, t:t + S, :] * shift_k[:, ks - 1 - t][None, None, :]
        kv = k_shift * v
        L = 2 * S
        kv_pad = _pad(kv, ((0, 0), (0, S), (0, 0)))
        kf_pad = _pad(ssm_k, ((0, 0), (0, S)))
        kv_f = (lambda x, axes=(-2, -1): torch.fft.rfft2(x.float(), dim=axes))(kv_pad[:, None, :, :], axes=(1, 2))
        kf_f = (lambda x, axes=(-2, -1): torch.fft.rfft2(x.float(), dim=axes))(kf_pad[:, None, :], axes=(1, 2))
        kf_f = (lambda x, *d: x.permute(*d))(kf_f, 1, 2, 0)
        y_f = kv_f * kf_f[None, :, :, :]
        y = (lambda x, s, axes=(-2, -1): torch.fft.irfft2(x, s=s, dim=axes).to(torch.bfloat16))(y_f, (1, L), axes=(1, 2))[:, 0, :S, :]
        y = y + kv * ssm_D[None, None, :]
        return q * y

    def _B_ref(x, w_gate, w_up, w_down):
        g = torch.einsum('bsd,df->bsf', x, w_gate)
        u = torch.einsum('bsd,df->bsf', x, w_up)
        h = _gelu(g) * u
        return torch.einsum('bsf,fd->bsd', h, w_down)
    x = A_q
    mod = (_silu(c) @ w_mod).reshape(c.shape[0], 6, 1, -1)
    sa, ca, ga, sb, cb, gb = (mod[:, 0].clone(), mod[:, 1].clone(), mod[:, 2].clone(), mod[:, 3].clone(), mod[:, 4].clone(), mod[:, 5].clone())
    h = _layernorm(x, axis=-1) * (1 + ca) + sa
    x = x + ga * _A_ref(h, A_k, A_v, A_shift_k, A_ssm_k, A_ssm_D)
    h = _layernorm(x, axis=-1) * (1 + cb) + sb
    x = x + gb * _B_ref(h, B_w_gate, B_w_up, B_w_down)
    return x
```

```asm
; @launch grid=(256,1,1) block=(256,1,1) lds=163840
.amdgcn_target "amdgcn-amd-amdhsa--gfx950"
.text
.globl adaLN_cond__ssm_conv_h3__glu_gated_geglu__prompt_kernel
.p2align 8
.type adaLN_cond__ssm_conv_h3__glu_gated_geglu__prompt_kernel,@function
adaLN_cond__ssm_conv_h3__glu_gated_geglu__prompt_kernel:
    s_cmp_ge_u32 s2, 256
    s_cbranch_scc1 L_adaLN_cond__ssm_conv_h3__glu_gated_geglu__prompt_kernel_end
    s_memrealtime s[86:87]
    s_load_dwordx2 s[4:5], s[0:1], 112
    s_load_dwordx4 s[8:11], s[0:1], 8
    s_load_dwordx4 s[12:15], s[0:1], 24
    s_load_dwordx2 s[6:7], s[0:1], 40
    s_load_dwordx4 s[56:59], s[0:1], 80
    s_load_dwordx4 s[64:67], s[0:1], 56
    s_load_dwordx2 s[68:69], s[0:1], 104
    s_load_dwordx2 s[80:81], s[0:1], 0
    v_lshrrev_b32 v224, 6, v0
    v_and_b32 v225, 63, v0
    v_readfirstlane_b32 s3, v224
    s_getpc_b64 s[76:77]
L_cpf_1:
    s_sub_u32 s76, s76, L_cpf_1-adaLN_cond__ssm_conv_h3__glu_gated_geglu__prompt_kernel
    s_subb_u32 s77, s77, 0
    v_lshlrev_b32 v216, 7, v225
    s_lshl_b32 s78, s3, 13
    v_add_u32 v216, s78, v216
    s_cmp_lt_u32 s2, 16
    s_cselect_b32 s78, -1, 0
    v_and_b32 v216, s78, v216
    v_min_u32 v217, L_adaLN_cond__ssm_conv_h3__glu_gated_geglu__prompt_kernel_end-adaLN_cond__ssm_conv_h3__glu_gated_geglu__prompt_kernel-4, v216
    global_load_dword v218, v217, s[76:77]
    v_add_u32 v216, 32768, v216
    v_min_u32 v217, L_adaLN_cond__ssm_conv_h3__glu_gated_geglu__prompt_kernel_end-adaLN_cond__ssm_conv_h3__glu_gated_geglu__prompt_kernel-4, v216
    global_load_dword v218, v217, s[76:77]
    s_and_b32 s70, s2, 7
    s_lshl_b32 s70, s70, 1
    s_lshr_b32 s71, s2, 7
    s_add_u32 s70, s70, s71
    s_bfe_u32 s71, s2, 0x40003
    s_lshl_b32 s72, s70, 4
    s_add_u32 s72, s72, s71
    s_lshl_b32 s72, s72, 2
    s_add_u32 s72, s72, s3
    s_mul_i32 s73, s3, 21760
    v_and_b32 v1, 15, v0
    v_lshrrev_b32 v2, 4, v0
    s_lshl_b32 s74, s71, 7
    v_lshlrev_b32 v3, 3, v2
    v_add_u32 v3, s74, v3
    s_lshl_b32 s74, s70, 6
    v_lshlrev_b32 v4, 2, v1
    v_add_u32 v4, s74, v4
    v_lshlrev_b32 v5, 11, v3
    v_lshlrev_b32 v6, 1, v4
    v_add_u32 v5, v5, v6
    v_subrev_u32 v6, 6144, v5
    s_waitcnt lgkmcnt(0)
    s_mov_b32 s16, s8
    s_mov_b32 s17, s9
    s_mov_b32 s18, 4194304
    s_mov_b32 s19, 0x00020000
    s_mov_b32 s20, s10
    s_mov_b32 s21, s11
    s_mov_b32 s22, 4194304
    s_mov_b32 s23, 0x00020000
    s_mov_b32 s24, s12
    s_mov_b32 s25, s13
    s_mov_b32 s26, 8192
    s_mov_b32 s27, 0x00020000
    s_add_u32 s28, s4, 0
    s_addc_u32 s29, s5, 0
    s_mov_b32 s30, 4194304
    s_mov_b32 s31, 0x00020000
    s_mov_b32 s32, 0
    s_mov_b32 s33, 2048
    s_mov_b32 s34, 4096
    s_mov_b32 s35, 6144
    s_mov_b32 s36, 8192
    s_mov_b32 s37, 10240
    s_mov_b32 s38, 12288
    s_mov_b32 s39, 14336
    buffer_load_dwordx2 v[8:9], v6, s[16:19], s32 offen
    buffer_load_dwordx2 v[10:11], v6, s[16:19], s33 offen
    buffer_load_dwordx2 v[12:13], v6, s[16:19], s34 offen
    buffer_load_dwordx2 v[14:15], v5, s[16:19], s32 offen
    buffer_load_dwordx2 v[16:17], v5, s[16:19], s33 offen
    buffer_load_dwordx2 v[18:19], v5, s[16:19], s34 offen
    buffer_load_dwordx2 v[20:21], v5, s[16:19], s35 offen
    buffer_load_dwordx2 v[22:23], v5, s[16:19], s36 offen
    buffer_load_dwordx2 v[24:25], v5, s[16:19], s37 offen
    buffer_load_dwordx2 v[26:27], v5, s[16:19], s38 offen
    buffer_load_dwordx2 v[28:29], v5, s[16:19], s39 offen
    v_lshlrev_b32 v7, 3, v4
    buffer_load_dwordx4 v[48:51], v7, s[24:27], 0 offen
    buffer_load_dwordx4 v[52:55], v7, s[24:27], 0 offen offset:16
    buffer_load_dwordx2 v[32:33], v5, s[20:23], s32 offen
    buffer_load_dwordx2 v[34:35], v5, s[20:23], s33 offen
    buffer_load_dwordx2 v[36:37], v5, s[20:23], s34 offen
    buffer_load_dwordx2 v[38:39], v5, s[20:23], s35 offen
    buffer_load_dwordx2 v[40:41], v5, s[20:23], s36 offen
    buffer_load_dwordx2 v[42:43], v5, s[20:23], s37 offen
    buffer_load_dwordx2 v[44:45], v5, s[20:23], s38 offen
    buffer_load_dwordx2 v[46:47], v5, s[20:23], s39 offen
    s_lshl_b32 s74, s72, 12
    s_add_u32 s40, s14, s74
    s_addc_u32 s41, s15, 0
    s_mov_b32 s42, 4096
    s_mov_b32 s43, 0x00020000
    s_add_u32 s44, s4, 0
    s_addc_u32 s45, s5, 0
    s_add_u32 s44, s44, s74
    s_addc_u32 s45, s45, 0
    s_mov_b32 s46, 4096
    s_mov_b32 s47, 0x00020000
    v_lshlrev_b32 v219, 4, v225
    buffer_load_dwordx4 v[226:229], v219, s[40:43], 0 offen offset:0
    buffer_load_dwordx2 v[230:231], v219, s[40:43], 0 offen offset:16
    buffer_load_dwordx4 v[232:235], v219, s[40:43], 0 offen offset:1024
    buffer_load_dwordx2 v[236:237], v219, s[40:43], 0 offen offset:1040
    buffer_load_dwordx4 v[238:241], v219, s[40:43], 0 offen offset:2048
    buffer_load_dwordx2 v[242:243], v219, s[40:43], 0 offen offset:2064
    buffer_load_dwordx4 v[244:247], v219, s[40:43], 0 offen offset:3072
    buffer_load_dwordx2 v[248:249], v219, s[40:43], 0 offen offset:3088
    v_mov_b32 v217, 0
    buffer_load_dwordx2 v[252:253], v217, s[40:43], 0 offen
    s_lshr_b32 s74, s72, 1
    s_lshl_b32 s74, s74, 2
    s_load_dword s75, s[6:7], s74
    v_lshlrev_b32 v4, 12, v4
    v_lshlrev_b32 v3, 1, v3
    v_add_u32 v4, v4, v3
    s_waitcnt vmcnt(17)
    v_lshlrev_b32 v56, 16, v48
    v_and_b32 v60, 0xffff0000, v48
    v_lshlrev_b32 v64, 16, v49
    v_and_b32 v68, 0xffff0000, v49
    v_lshlrev_b32 v57, 16, v50
    v_and_b32 v61, 0xffff0000, v50
    v_lshlrev_b32 v65, 16, v51
    v_and_b32 v69, 0xffff0000, v51
    v_lshlrev_b32 v58, 16, v52
    v_and_b32 v62, 0xffff0000, v52
    v_lshlrev_b32 v66, 16, v53
    v_and_b32 v70, 0xffff0000, v53
    v_lshlrev_b32 v59, 16, v54
    v_and_b32 v63, 0xffff0000, v54
    v_lshlrev_b32 v67, 16, v55
    v_and_b32 v71, 0xffff0000, v55
    v_lshlrev_b32 v128, 16, v8
    v_and_b32 v129, 0xffff0000, v8
    v_lshlrev_b32 v130, 16, v9
    v_and_b32 v131, 0xffff0000, v9
    v_lshlrev_b32 v132, 16, v10
    v_and_b32 v133, 0xffff0000, v10
    v_lshlrev_b32 v134, 16, v11
    v_and_b32 v135, 0xffff0000, v11
    v_lshlrev_b32 v136, 16, v12
    v_and_b32 v137, 0xffff0000, v12
    v_lshlrev_b32 v138, 16, v13
    v_and_b32 v139, 0xffff0000, v13
    v_lshlrev_b32 v140, 16, v14
    v_and_b32 v141, 0xffff0000, v14
    v_lshlrev_b32 v142, 16, v15
    v_and_b32 v143, 0xffff0000, v15
    v_lshlrev_b32 v144, 16, v16
    v_and_b32 v145, 0xffff0000, v16
    v_lshlrev_b32 v146, 16, v17
    v_and_b32 v147, 0xffff0000, v17
    v_lshlrev_b32 v148, 16, v18
    v_and_b32 v149, 0xffff0000, v18
    v_lshlrev_b32 v150, 16, v19
    v_and_b32 v151, 0xffff0000, v19
    v_lshlrev_b32 v152, 16, v20
    v_and_b32 v153, 0xffff0000, v20
    v_lshlrev_b32 v154, 16, v21
    v_and_b32 v155, 0xffff0000, v21
    v_lshlrev_b32 v156, 16, v22
    v_and_b32 v157, 0xffff0000, v22
    v_lshlrev_b32 v158, 16, v23
    v_and_b32 v159, 0xffff0000, v23
    v_lshlrev_b32 v160, 16, v24
    v_and_b32 v161, 0xffff0000, v24
    v_lshlrev_b32 v162, 16, v25
    v_and_b32 v163, 0xffff0000, v25
    v_lshlrev_b32 v164, 16, v26
    v_and_b32 v165, 0xffff0000, v26
    v_lshlrev_b32 v166, 16, v27
    v_and_b32 v167, 0xffff0000, v27
    v_lshlrev_b32 v168, 16, v28
    v_and_b32 v169, 0xffff0000, v28
    v_lshlrev_b32 v170, 16, v29
    v_and_b32 v171, 0xffff0000, v29
    v_pk_mul_f32 v[72:73], v[140:141], v[56:57]
    v_pk_fma_f32 v[72:73], v[136:137], v[60:61], v[72:73]
    v_pk_fma_f32 v[72:73], v[132:133], v[64:65], v[72:73]
    v_pk_fma_f32 v[72:73], v[128:129], v[68:69], v[72:73]
    v_pk_mul_f32 v[74:75], v[142:143], v[58:59]
    v_pk_fma_f32 v[74:75], v[138:139], v[62:63], v[74:75]
    v_pk_fma_f32 v[74:75], v[134:135], v[66:67], v[74:75]
    v_pk_fma_f32 v[74:75], v[130:131], v[70:71], v[74:75]
    v_pk_mul_f32 v[76:77], v[144:145], v[56:57]
    v_pk_fma_f32 v[76:77], v[140:141], v[60:61], v[76:77]
    v_pk_fma_f32 v[76:77], v[136:137], v[64:65], v[76:77]
    v_pk_fma_f32 v[76:77], v[132:133], v[68:69], v[76:77]
    v_pk_mul_f32 v[78:79], v[146:147], v[58:59]
    v_pk_fma_f32 v[78:79], v[142:143], v[62:63], v[78:79]
    v_pk_fma_f32 v[78:79], v[138:139], v[66:67], v[78:79]
    v_pk_fma_f32 v[78:79], v[134:135], v[70:71], v[78:79]
    v_pk_mul_f32 v[80:81], v[148:149], v[56:57]
    v_pk_fma_f32 v[80:81], v[144:145], v[60:61], v[80:81]
    v_pk_fma_f32 v[80:81], v[140:141], v[64:65], v[80:81]
    v_pk_fma_f32 v[80:81], v[136:137], v[68:69], v[80:81]
    v_pk_mul_f32 v[82:83], v[150:151], v[58:59]
    v_pk_fma_f32 v[82:83], v[146:147], v[62:63], v[82:83]
    v_pk_fma_f32 v[82:83], v[142:143], v[66:67], v[82:83]
    v_pk_fma_f32 v[82:83], v[138:139], v[70:71], v[82:83]
    v_pk_mul_f32 v[84:85], v[152:153], v[56:57]
    v_pk_fma_f32 v[84:85], v[148:149], v[60:61], v[84:85]
    v_pk_fma_f32 v[84:85], v[144:145], v[64:65], v[84:85]
    v_pk_fma_f32 v[84:85], v[140:141], v[68:69], v[84:85]
    v_pk_mul_f32 v[86:87], v[154:155], v[58:59]
    v_pk_fma_f32 v[86:87], v[150:151], v[62:63], v[86:87]
    v_pk_fma_f32 v[86:87], v[146:147], v[66:67], v[86:87]
    v_pk_fma_f32 v[86:87], v[142:143], v[70:71], v[86:87]
    v_pk_mul_f32 v[88:89], v[156:157], v[56:57]
    v_pk_fma_f32 v[88:89], v[152:153], v[60:61], v[88:89]
    v_pk_fma_f32 v[88:89], v[148:149], v[64:65], v[88:89]
    v_pk_fma_f32 v[88:89], v[144:145], v[68:69], v[88:89]
    v_pk_mul_f32 v[90:91], v[158:159], v[58:59]
    v_pk_fma_f32 v[90:91], v[154:155], v[62:63], v[90:91]
    v_pk_fma_f32 v[90:91], v[150:151], v[66:67], v[90:91]
    v_pk_fma_f32 v[90:91], v[146:147], v[70:71], v[90:91]
    v_pk_mul_f32 v[92:93], v[160:161], v[56:57]
    v_pk_fma_f32 v[92:93], v[156:157], v[60:61], v[92:93]
    v_pk_fma_f32 v[92:93], v[152:153], v[64:65], v[92:93]
    v_pk_fma_f32 v[92:93], v[148:149], v[68:69], v[92:93]
    v_pk_mul_f32 v[94:95], v[162:163], v[58:59]
    v_pk_fma_f32 v[94:95], v[158:159], v[62:63], v[94:95]
    v_pk_fma_f32 v[94:95], v[154:155], v[66:67], v[94:95]
    v_pk_fma_f32 v[94:95], v[150:151], v[70:71], v[94:95]
    v_pk_mul_f32 v[96:97], v[164:165], v[56:57]
    v_pk_fma_f32 v[96:97], v[160:161], v[60:61], v[96:97]
    v_pk_fma_f32 v[96:97], v[156:157], v[64:65], v[96:97]
    v_pk_fma_f32 v[96:97], v[152:153], v[68:69], v[96:97]
    v_pk_mul_f32 v[98:99], v[166:167], v[58:59]
    v_pk_fma_f32 v[98:99], v[162:163], v[62:63], v[98:99]
    v_pk_fma_f32 v[98:99], v[158:159], v[66:67], v[98:99]
    v_pk_fma_f32 v[98:99], v[154:155], v[70:71], v[98:99]
    v_pk_mul_f32 v[100:101], v[168:169], v[56:57]
    v_pk_fma_f32 v[100:101], v[164:165], v[60:61], v[100:101]
    v_pk_fma_f32 v[100:101], v[160:161], v[64:65], v[100:101]
    v_pk_fma_f32 v[100:101], v[156:157], v[68:69], v[100:101]
    v_pk_mul_f32 v[102:103], v[170:171], v[58:59]
    v_pk_fma_f32 v[102:103], v[166:167], v[62:63], v[102:103]
    v_pk_fma_f32 v[102:103], v[162:163], v[66:67], v[102:103]
    v_pk_fma_f32 v[102:103], v[158:159], v[70:71], v[102:103]
    s_waitcnt vmcnt(9)
    v_lshlrev_b32 v176, 16, v32
    v_and_b32 v177, 0xffff0000, v32
    v_lshlrev_b32 v178, 16, v33
    v_and_b32 v179, 0xffff0000, v33
    v_lshlrev_b32 v180, 16, v34
    v_and_b32 v181, 0xffff0000, v34
    v_lshlrev_b32 v182, 16, v35
    v_and_b32 v183, 0xffff0000, v35
    v_lshlrev_b32 v184, 16, v36
    v_and_b32 v185, 0xffff0000, v36
    v_lshlrev_b32 v186, 16, v37
    v_and_b32 v187, 0xffff0000, v37
    v_lshlrev_b32 v188, 16, v38
    v_and_b32 v189, 0xffff0000, v38
    v_lshlrev_b32 v190, 16, v39
    v_and_b32 v191, 0xffff0000, v39
    v_lshlrev_b32 v192, 16, v40
    v_and_b32 v193, 0xffff0000, v40
    v_lshlrev_b32 v194, 16, v41
    v_and_b32 v195, 0xffff0000, v41
    v_lshlrev_b32 v196, 16, v42
    v_and_b32 v197, 0xffff0000, v42
    v_lshlrev_b32 v198, 16, v43
    v_and_b32 v199, 0xffff0000, v43
    v_lshlrev_b32 v200, 16, v44
    v_and_b32 v201, 0xffff0000, v44
    v_lshlrev_b32 v202, 16, v45
    v_and_b32 v203, 0xffff0000, v45
    v_lshlrev_b32 v204, 16, v46
    v_and_b32 v205, 0xffff0000, v46
    v_lshlrev_b32 v206, 16, v47
    v_and_b32 v207, 0xffff0000, v47
    v_pk_mul_f32 v[72:73], v[72:73], v[176:177]
    v_pk_mul_f32 v[74:75], v[74:75], v[178:179]
    v_pk_mul_f32 v[76:77], v[76:77], v[180:181]
    v_pk_mul_f32 v[78:79], v[78:79], v[182:183]
    v_pk_mul_f32 v[80:81], v[80:81], v[184:185]
    v_pk_mul_f32 v[82:83], v[82:83], v[186:187]
    v_pk_mul_f32 v[84:85], v[84:85], v[188:189]
    v_pk_mul_f32 v[86:87], v[86:87], v[190:191]
    v_pk_mul_f32 v[88:89], v[88:89], v[192:193]
    v_pk_mul_f32 v[90:91], v[90:91], v[194:195]
    v_pk_mul_f32 v[92:93], v[92:93], v[196:197]
    v_pk_mul_f32 v[94:95], v[94:95], v[198:199]
    v_pk_mul_f32 v[96:97], v[96:97], v[200:201]
    v_pk_mul_f32 v[98:99], v[98:99], v[202:203]
    v_pk_mul_f32 v[100:101], v[100:101], v[204:205]
    v_pk_mul_f32 v[102:103], v[102:103], v[206:207]
    v_cvt_pk_bf16_f32 v8, v100, v96
    v_cvt_pk_bf16_f32 v9, v92, v88
    v_cvt_pk_bf16_f32 v10, v84, v80
    v_cvt_pk_bf16_f32 v11, v76, v72
    s_mov_b32 s48, 0
    buffer_store_dwordx4 v[8:11], v4, s[28:31], s48 offen sc1
    v_cvt_pk_bf16_f32 v12, v101, v97
    v_cvt_pk_bf16_f32 v13, v93, v89
    v_cvt_pk_bf16_f32 v14, v85, v81
    v_cvt_pk_bf16_f32 v15, v77, v73
    s_mov_b32 s48, 4096
    buffer_store_dwordx4 v[12:15], v4, s[28:31], s48 offen sc1
    v_cvt_pk_bf16_f32 v16, v102, v98
    v_cvt_pk_bf16_f32 v17, v94, v90
    v_cvt_pk_bf16_f32 v18, v86, v82
    v_cvt_pk_bf16_f32 v19, v78, v74
    s_mov_b32 s48, 8192
    buffer_store_dwordx4 v[16:19], v4, s[28:31], s48 offen sc1
    v_cvt_pk_bf16_f32 v20, v103, v99
    v_cvt_pk_bf16_f32 v21, v95, v91
    v_cvt_pk_bf16_f32 v22, v87, v83
    v_cvt_pk_bf16_f32 v23, v79, v75
    s_mov_b32 s48, 12288
    buffer_store_dwordx4 v[20:23], v4, s[28:31], s48 offen sc1
    v_mov_b32 v216, 0
    v_cmp_eq_u32 vcc, 0, v225
    s_nop 1
    s_and_saveexec_b64 s[50:51], vcc
    s_add_u32 s52, s4, 58916864
    s_addc_u32 s53, s5, 0
    s_mov_b32 s54, 2048
    s_mov_b32 s55, 0x00020000
    s_lshl_b32 s49, s70, 7
    s_cmp_eq_u32 s71, 0
    s_cselect_b32 s49, s49, 0x10000
    buffer_store_dword v216, v216, s[52:55], s49 offen sc1
    s_mov_b64 exec, s[50:51]
    s_and_b32 s32, s2, 7
    s_mul_i32 s32, s32, 12
    s_lshr_b32 s33, s2, 3
    s_cmp_ge_u32 s33, 12
    s_cselect_b32 s34, 1, 0
    s_mul_i32 s35, s34, 12
    s_sub_u32 s33, s33, s35
    s_add_u32 s33, s33, s32
    s_lshl_b32 s35, s34, 9
    s_lshl_b32 s36, s3, 7
    s_add_u32 s31, s35, s36
    s_mul_i32 s36, s35, 12288
    s_lshl_b32 s37, s33, 7
    s_add_u32 s36, s36, s37
    s_lshl_b32 s37, s31, 1
    s_cmp_ge_u32 s2, 192
    s_cselect_b32 s36, 0x7ff00000, s36
    v_lshrrev_b32 v209, 3, v225
    v_mul_u32_u24 v209, 12288, v209
    v_and_b32 v208, 7, v225
    v_lshlrev_b32 v208, 4, v208
    v_add_u32 v209, v209, v208
    v_lshlrev_b32 v208, 2, v225
    s_lshl_b32 s38, s3, 14
    s_add_u32 s38, s38, 89088
    s_lshl_b32 s39, s3, 8
    s_add_u32 s39, s39, 87552
    s_mov_b32 s16, s58
    s_mov_b32 s17, s59
    s_mov_b32 s18, 12582912
    s_mov_b32 s19, 0x00020000
    s_mov_b32 s20, s56
    s_mov_b32 s21, s57
    s_mov_b32 s22, 2048
    s_mov_b32 s23, 0x00020000
    buffer_load_dword v211, v208, s[20:23], s37 offen
    s_lshl_b32 s48, s3, 7
    s_mul_i32 s48, s48, 12288
    s_add_u32 s36, s36, s48
    s_branch L_f_nogdma
    s_cmp_eq_u32 s3, 0
    s_cbranch_scc1 L_f_nogdma
    s_sub_u32 s48, s3, 1
    s_mul_i32 s49, s48, 98304
    s_add_u32 s36, s36, s49
    s_lshl_b32 s49, s48, 10
    s_add_u32 s49, s49, 89088
    s_mov_b32 m0, s49
    s_nop 0
    buffer_load_dwordx4 v209, s[16:19], s36 offen nt lds
    s_add_u32 s36, s36, 294912
    s_add_u32 s49, s49, 3072
    s_mov_b32 m0, s49
    s_nop 0
    buffer_load_dwordx4 v209, s[16:19], s36 offen nt lds
    s_add_u32 s36, s36, 294912
    s_add_u32 s49, s49, 3072
    s_mov_b32 m0, s49
    s_nop 0
    buffer_load_dwordx4 v209, s[16:19], s36 offen nt lds
    s_add_u32 s36, s36, 294912
    s_add_u32 s49, s49, 3072
    s_mov_b32 m0, s49
    s_nop 0
    buffer_load_dwordx4 v209, s[16:19], s36 offen nt lds
    s_add_u32 s36, s36, 294912
    s_add_u32 s49, s49, 3072
    s_mov_b32 m0, s49
    s_nop 0
    buffer_load_dwordx4 v209, s[16:19], s36 offen nt lds
    s_add_u32 s36, s36, 294912
    s_add_u32 s49, s49, 3072
    s_mov_b32 m0, s49
    s_nop 0
    buffer_load_dwordx4 v209, s[16:19], s36 offen nt lds
    s_add_u32 s36, s36, 294912
    s_add_u32 s49, s49, 3072
    s_mov_b32 m0, s49
    s_nop 0
    buffer_load_dwordx4 v209, s[16:19], s36 offen nt lds
    s_add_u32 s36, s36, 294912
    s_add_u32 s49, s49, 3072
    s_mov_b32 m0, s49
    s_nop 0
    buffer_load_dwordx4 v209, s[16:19], s36 offen nt lds
    s_add_u32 s36, s36, 294912
    s_add_u32 s49, s49, 3072
    s_mov_b32 m0, s49
    s_nop 0
    buffer_load_dwordx4 v209, s[16:19], s36 offen nt lds
    s_add_u32 s36, s36, 294912
    s_add_u32 s49, s49, 3072
    s_mov_b32 m0, s49
    s_nop 0
    buffer_load_dwordx4 v209, s[16:19], s36 offen nt lds
    s_add_u32 s36, s36, 294912
    s_add_u32 s49, s49, 3072
    s_mov_b32 m0, s49
    s_nop 0
    buffer_load_dwordx4 v209, s[16:19], s36 offen nt lds
    s_add_u32 s36, s36, 294912
    s_add_u32 s49, s49, 3072
    s_mov_b32 m0, s49
    s_nop 0
    buffer_load_dwordx4 v209, s[16:19], s36 offen nt lds
    s_add_u32 s36, s36, 294912
    s_add_u32 s49, s49, 3072
    s_mov_b32 m0, s49
    s_nop 0
    buffer_load_dwordx4 v209, s[16:19], s36 offen nt lds
    s_add_u32 s36, s36, 294912
    s_add_u32 s49, s49, 3072
    s_mov_b32 m0, s49
    s_nop 0
    buffer_load_dwordx4 v209, s[16:19], s36 offen nt lds
    s_add_u32 s36, s36, 294912
    s_add_u32 s49, s49, 3072
    s_mov_b32 m0, s49
    s_nop 0
    buffer_load_dwordx4 v209, s[16:19], s36 offen nt lds
    s_add_u32 s36, s36, 294912
    s_add_u32 s49, s49, 3072
    s_mov_b32 m0, s49
    s_nop 0
    buffer_load_dwordx4 v209, s[16:19], s36 offen nt lds
    s_add_u32 s36, s36, 294912
    s_add_u32 s49, s49, 3072
    s_mov_b32 m0, s49
    s_nop 0
    buffer_load_dwordx4 v209, s[16:19], s36 offen nt lds
    s_add_u32 s36, s36, 294912
    s_add_u32 s49, s49, 3072
    s_mov_b32 m0, s49
    s_nop 0
    buffer_load_dwordx4 v209, s[16:19], s36 offen nt lds
    s_add_u32 s36, s36, 294912
    s_add_u32 s49, s49, 3072
    s_mov_b32 m0, s49
    s_nop 0
    buffer_load_dwordx4 v209, s[16:19], s36 offen nt lds
    s_add_u32 s36, s36, 294912
    s_add_u32 s49, s49, 3072
    s_mov_b32 m0, s49
    s_nop 0
    buffer_load_dwordx4 v209, s[16:19], s36 offen nt lds
    s_add_u32 s36, s36, 294912
    s_add_u32 s49, s49, 3072
    s_mov_b32 m0, s49
    s_nop 0
    buffer_load_dwordx4 v209, s[16:19], s36 offen nt lds
    s_add_u32 s36, s36, 294912
    s_add_u32 s49, s49, 3072
    s_mov_b32 m0, s49
    s_cmp_ge_u32 s49, 154624
    s_cselect_b32 s36, 0x7ff00000, s36
    buffer_load_dwordx4 v209, s[16:19], s36 offen nt lds
    s_add_u32 s36, s36, 294912
    s_add_u32 s49, s49, 3072
L_f_nogdma:
    v_lshrrev_b32 v134, 4, v225
    v_mul_u32_u24 v134, 1280, v134
    v_and_b32 v135, 15, v225
    v_lshlrev_b32 v135, 4, v135
    v_add_u32 v134, v134, v135
    v_add_u32 v134, s73, v134
    v_mov_b32 v68, 0
    v_mov_b32 v69, 0
    v_mov_b32 v70, 0
    v_mov_b32 v71, 0
    ds_write_b128 v134, v[68:71] offset:16640
    v_add_u32 v136, s73, v219
    s_cmp_eq_u32 s3, s3
    s_cbranch_scc1 L_f_w0a
    s_waitcnt vmcnt(28)
    s_branch L_f_w0b
L_f_w0a:
    s_waitcnt vmcnt(6)
L_f_w0b:
    ds_write_b128 v136, v[226:229] offset:64
    v_alignbit_b32 v72, v227, v226, 16
    v_alignbit_b32 v73, v228, v227, 16
    v_alignbit_b32 v74, v229, v228, 16
    v_alignbit_b32 v75, v230, v229, 16
    ds_write_b128 v136, v[72:75] offset:4224
    v_mov_b32 v76, v227
    v_mov_b32 v77, v228
    v_mov_b32 v78, v229
    v_mov_b32 v79, v230
    ds_write_b128 v136, v[76:79] offset:8384
    v_alignbit_b32 v80, v228, v227, 16
    v_alignbit_b32 v81, v229, v228, 16
    v_alignbit_b32 v82, v230, v229, 16
    v_alignbit_b32 v83, v231, v230, 16
    ds_write_b128 v136, v[80:83] offset:12544
    ds_write_b128 v136, v[232:235] offset:1088
    v_alignbit_b32 v84, v233, v232, 16
    v_alignbit_b32 v85, v234, v233, 16
    v_alignbit_b32 v86, v235, v234, 16
    v_alignbit_b32 v87, v236, v235, 16
    ds_write_b128 v136, v[84:87] offset:5248
    v_mov_b32 v88, v233
    v_mov_b32 v89, v234
    v_mov_b32 v90, v235
    v_mov_b32 v91, v236
    ds_write_b128 v136, v[88:91] offset:9408
    v_alignbit_b32 v92, v234, v233, 16
    v_alignbit_b32 v93, v235, v234, 16
    v_alignbit_b32 v94, v236, v235, 16
    v_alignbit_b32 v95, v237, v236, 16
    ds_write_b128 v136, v[92:95] offset:13568
    ds_write_b128 v136, v[238:241] offset:2112
    v_alignbit_b32 v72, v239, v238, 16
    v_alignbit_b32 v73, v240, v239, 16
    v_alignbit_b32 v74, v241, v240, 16
    v_alignbit_b32 v75, v242, v241, 16
    ds_write_b128 v136, v[72:75] offset:6272
    v_mov_b32 v76, v239
    v_mov_b32 v77, v240
    v_mov_b32 v78, v241
    v_mov_b32 v79, v242
    ds_write_b128 v136, v[76:79] offset:10432
    v_alignbit_b32 v80, v240, v239, 16
    v_alignbit_b32 v81, v241, v240, 16
    v_alignbit_b32 v82, v242, v241, 16
    v_alignbit_b32 v83, v243, v242, 16
    ds_write_b128 v136, v[80:83] offset:14592
    ds_write_b128 v136, v[244:247] offset:3136
    v_alignbit_b32 v84, v245, v244, 16
    v_alignbit_b32 v85, v246, v245, 16
    v_alignbit_b32 v86, v247, v246, 16
    v_alignbit_b32 v87, v248, v247, 16
    ds_write_b128 v136, v[84:87] offset:7296
    v_mov_b32 v88, v245
    v_mov_b32 v89, v246
    v_mov_b32 v90, v247
    v_mov_b32 v91, v248
    ds_write_b128 v136, v[88:91] offset:11456
    v_alignbit_b32 v92, v246, v245, 16
    v_alignbit_b32 v93, v247, v246, 16
    v_alignbit_b32 v94, v248, v247, 16
    v_alignbit_b32 v95, v249, v248, 16
    ds_write_b128 v136, v[92:95] offset:15616
    v_lshrrev_b32 v137, 2, v225
    v_and_b32 v138, 3, v225
    v_lshlrev_b32 v139, 4, v137
    v_sub_u32 v139, 64, v139
    v_lshlrev_b64 v[70:71], v139, v[252:253]
    v_cmp_eq_u32 vcc, 3, v138
    v_cmp_ne_u32 s[50:51], 0, v137
    s_nop 1
    s_and_b64 vcc, vcc, s[50:51]
    v_cndmask_b32 v70, 0, v70, vcc
    v_cndmask_b32 v71, 0, v71, vcc
    v_mul_u32_u24 v137, 4160, v137
    v_lshlrev_b32 v138, 4, v138
    v_add_u32 v137, v137, v138
    v_add_u32 v137, s73, v137
    v_cmp_gt_u32 vcc, 16, v225
    s_nop 1
    s_and_saveexec_b64 s[50:51], vcc
    ds_write_b128 v137, v[68:71]
    s_mov_b64 exec, s[50:51]
    v_lshlrev_b32 v212, 2, v0
    v_add_u32 v212, 87040, v212
    v_mov_b32 v213, 0
    v_cmp_gt_u32 vcc, 72, v0
    s_nop 1
    s_and_saveexec_b64 s[50:51], vcc
    ds_write_b32 v212, v213
    s_mov_b64 exec, s[50:51]
    s_cmp_eq_u32 s3, s3
    s_cbranch_scc1 L_f_w1a
    s_waitcnt vmcnt(23) lgkmcnt(0)
    s_branch L_f_w1b
L_f_w1a:
    s_waitcnt vmcnt(1) lgkmcnt(0)
L_f_w1b:
    s_barrier
    s_add_u32 s52, s4, 58851328
    s_addc_u32 s53, s5, 0
    s_mov_b32 s54, 32768
    s_mov_b32 s55, 0x00020000
    s_cmp_lg_u32 s3, 0
    s_cbranch_scc1 L_f_nopub
    v_mov_b32 v212, s86
    v_xor_b32 v213, 0x5a17c3e9, v212
    v_cmp_eq_u32 vcc, 0, v225
    s_nop 1
    s_and_saveexec_b64 s[50:51], vcc
    s_lshl_b32 s48, s2, 7
    buffer_store_dwordx2 v[212:213], v217, s[52:55], s48 offen sc1
    s_mov_b64 exec, s[50:51]
L_f_nopub:
    v_and_b32 v142, 15, v225
    v_lshrrev_b32 v143, 4, v225
    v_add_u32 v144, 1, v142
    v_and_b32 v144, 3, v144
    v_add_u32 v145, 25, v142
    v_sub_u32 v145, v145, v144
    v_lshlrev_b32 v146, 3, v143
    v_sub_u32 v145, v145, v146
    v_lshlrev_b32 v145, 1, v145
    v_mul_u32_u24 v144, 4160, v144
    v_add_u32 v140, v144, v145
    v_add_u32 v140, s73, v140
    v_mul_u32_u24 v144, 1280, v143
    v_lshlrev_b32 v145, 4, v142
    v_add_u32 v141, v144, v145
    v_add_u32 v141, s73, v141
    v_add_u32 v141, 16896, v141
    v_mov_b32 v210, v0
    v_mov_b32 v0, 0
    v_mov_b32 v1, 0
    v_mov_b32 v2, 0
    v_mov_b32 v3, 0
    v_mov_b32 v4, 0
    v_mov_b32 v5, 0
    v_mov_b32 v6, 0
    v_mov_b32 v7, 0
    v_mov_b32 v8, 0
    v_mov_b32 v9, 0
    v_mov_b32 v10, 0
    v_mov_b32 v11, 0
    v_mov_b32 v12, 0
    v_mov_b32 v13, 0
    v_mov_b32 v14, 0
    v_mov_b32 v15, 0
    v_mov_b32 v16, 0
    v_mov_b32 v17, 0
    v_mov_b32 v18, 0
    v_mov_b32 v19, 0
    v_mov_b32 v20, 0
    v_mov_b32 v21, 0
    v_mov_b32 v22, 0
    v_mov_b32 v23, 0
    v_mov_b32 v24, 0
    v_mov_b32 v25, 0
    v_mov_b32 v26, 0
    v_mov_b32 v27, 0
    v_mov_b32 v28, 0
    v_mov_b32 v29, 0
    v_mov_b32 v30, 0
    v_mov_b32 v31, 0
    s_add_u32 s24, s4, 4194304
    s_addc_u32 s25, s5, 0
    s_mov_b32 s26, 4194304
    s_mov_b32 s27, 0x00020000
    s_cmp_lg_u32 s3, 0
    s_cbranch_scc1 L_f_kvpoll_ok
    v_and_b32 v147, 15, v225
    v_lshlrev_b32 v147, 10, v147
    s_and_b32 s48, s2, 0x87
    s_lshl_b32 s48, s48, 7
    s_mov_b32 s60, 0x8000
    s_sub_u32 s61, s86, 4000
L_f_kvpoll:
    buffer_load_dwordx2 v[204:205], v147, s[52:55], s48 offen sc1
    s_waitcnt vmcnt(0)
    v_xor_b32 v205, v204, v205
    v_cmp_eq_u32 vcc, 0x5a17c3e9, v205
    v_subrev_u32 v204, s61, v204
    s_nop 0
    s_mov_b64 s[62:63], vcc
    v_cmp_gt_u32 vcc, 0x40000000, v204
    s_nop 1
    s_and_b64 vcc, vcc, s[62:63]
    s_cmp_eq_u64 vcc, exec
    s_cbranch_scc1 L_f_kvpoll_ok
    s_sleep 3
    s_sub_u32 s60, s60, 1
    s_cmp_lg_u32 s60, 0
    s_cbranch_scc1 L_f_kvpoll
L_f_kvpoll_ok:
    s_barrier
    v_lshlrev_b32 v131, 6, v225
    s_add_u32 m0, s73, 16896
    s_nop 0
    buffer_load_dwordx4 v131, s[44:47], 0 offen sc1 lds
    s_add_u32 m0, s73, 18176
    s_nop 0
    buffer_load_dwordx4 v131, s[44:47], 16 offen sc1 lds
    s_add_u32 m0, s73, 19456
    s_nop 0
    buffer_load_dwordx4 v131, s[44:47], 32 offen sc1 lds
    s_add_u32 m0, s73, 20736
    s_nop 0
    buffer_load_dwordx4 v131, s[44:47], 48 offen sc1 lds
    s_lshl_b32 s48, s2, 8
    v_add_u32 v206, s48, v210
    v_lshlrev_b32 v206, 7, v206
    s_waitcnt vmcnt(0) lgkmcnt(0)
    v_mov_b32 v216, 0
    v_cmp_eq_u32 vcc, 0, v225
    s_nop 1
    s_and_saveexec_b64 s[50:51], vcc
    s_add_u32 s28, s4, 58785792
    s_addc_u32 s29, s5, 0
    s_mov_b32 s30, 8192
    s_mov_b32 s31, 0x00020000
    s_lshl_b32 s49, s2, 7
    s_cmp_lt_u32 s2, 40
    s_cselect_b32 s49, s49, 0x10000
    buffer_store_dword v216, v216, s[28:31], s49 offen sc1
    s_mov_b64 exec, s[50:51]
    s_add_u32 s28, s4, 46137344
    s_addc_u32 s29, s5, 0
    s_mov_b32 s30, 4194304
    s_mov_b32 s31, 0x00020000
    s_lshl_b32 s49, s2, 2
    s_add_u32 s49, s49, s3
    s_lshl_b32 s49, s49, 12
    v_mov_b32 v212, -1
    v_mov_b32 v213, -1
    v_mov_b32 v214, -1
    v_mov_b32 v215, -1
    buffer_store_dwordx4 v[212:215], v219, s[28:31], s49 offen offset:0 sc1
    buffer_store_dwordx4 v[212:215], v219, s[28:31], s49 offen offset:1024 sc1
    buffer_store_dwordx4 v[212:215], v219, s[28:31], s49 offen offset:2048 sc1
    buffer_store_dwordx4 v[212:215], v219, s[28:31], s49 offen offset:3072 sc1
    s_add_u32 s28, s4, 33554432
    s_addc_u32 s29, s5, 0
    s_mov_b32 s30, 49152
    s_mov_b32 s31, 0x00020000
    s_lshl_b32 s48, s33, 8
    s_mul_i32 s49, s34, 24576
    s_add_u32 s48, s48, s49
    s_cmp_ge_u32 s2, 192
    s_cselect_b32 s48, 0x100000, s48
    buffer_store_dword v212, v208, s[28:31], s48 offen sc1
    s_mov_b32 s52, s80
    s_mov_b32 s53, s81
    s_mov_b32 s54, 4194304
    s_mov_b32 s55, 0x00020000
    s_lshl_b32 s60, s2, 14
    v_lshlrev_b32 v214, 3, v210
    s_add_u32 s61, s60, 0
    buffer_load_dwordx2 a[0:1], v214, s[52:55], s61 offen
    s_add_u32 s61, s60, 2048
    buffer_load_dwordx2 a[2:3], v214, s[52:55], s61 offen
    s_add_u32 s61, s60, 4096
    buffer_load_dwordx2 a[4:5], v214, s[52:55], s61 offen
    s_add_u32 s61, s60, 6144
    buffer_load_dwordx2 a[6:7], v214, s[52:55], s61 offen
    s_add_u32 s61, s60, 8192
    buffer_load_dwordx2 a[8:9], v214, s[52:55], s61 offen
    s_add_u32 s61, s60, 10240
    buffer_load_dwordx2 a[10:11], v214, s[52:55], s61 offen
    s_add_u32 s61, s60, 12288
    buffer_load_dwordx2 a[12:13], v214, s[52:55], s61 offen
    s_add_u32 s61, s60, 14336
    buffer_load_dwordx2 a[14:15], v214, s[52:55], s61 offen
    ds_read_b128 v[64:67], v141 offset:0
    ds_read_b128 v[68:71], v141 offset:256
    ds_read_b128 v[72:75], v141 offset:512
    ds_read_b128 v[76:79], v141 offset:768
    ds_read_b64 v[32:33], v140 offset:0
    ds_read_b64 v[34:35], v140 offset:8
    ds_read_b64 v[36:37], v140 offset:32
    ds_read_b64 v[38:39], v140 offset:40
    ds_read_b64 v[40:41], v140 offset:1024
    ds_read_b64 v[42:43], v140 offset:1032
    ds_read_b64 v[44:45], v140 offset:1056
    ds_read_b64 v[46:47], v140 offset:1064
    ds_read_b64 v[48:49], v140 offset:2048
    ds_read_b64 v[50:51], v140 offset:2056
    ds_read_b64 v[52:53], v140 offset:2080
    ds_read_b64 v[54:55], v140 offset:2088
    ds_read_b64 v[56:57], v140 offset:3072
    ds_read_b64 v[58:59], v140 offset:3080
    ds_read_b64 v[60:61], v140 offset:3104
    ds_read_b64 v[62:63], v140 offset:3112
    s_mov_b32 s48, 8
L_f_conv:
    s_waitcnt lgkmcnt(0)
    v_add_u32 v140, 64, v140
    v_subrev_u32 v141, 16, v141
    v_mfma_f32_16x16x32_bf16 v[0:3], v[32:35], v[64:67], v[0:3]
    ds_read_b128 v[112:115], v141 offset:0
    ds_read_b128 v[116:119], v141 offset:256
    v_mfma_f32_16x16x32_bf16 v[4:7], v[36:39], v[64:67], v[4:7]
    ds_read_b128 v[120:123], v141 offset:512
    v_mfma_f32_16x16x32_bf16 v[8:11], v[32:35], v[68:71], v[8:11]
    ds_read_b128 v[124:127], v141 offset:768
    ds_read_b64 v[80:81], v140 offset:0
    v_mfma_f32_16x16x32_bf16 v[12:15], v[36:39], v[68:71], v[12:15]
    ds_read_b64 v[82:83], v140 offset:8
    v_mfma_f32_16x16x32_bf16 v[16:19], v[32:35], v[72:75], v[16:19]
    ds_read_b64 v[84:85], v140 offset:32
    ds_read_b64 v[86:87], v140 offset:40
    v_mfma_f32_16x16x32_bf16 v[20:23], v[36:39], v[72:75], v[20:23]
    ds_read_b64 v[88:89], v140 offset:1024
    v_mfma_f32_16x16x32_bf16 v[24:27], v[32:35], v[76:79], v[24:27]
    ds_read_b64 v[90:91], v140 offset:1032
    v_mfma_f32_16x16x32_bf16 v[28:31], v[36:39], v[76:79], v[28:31]
    ds_read_b64 v[92:93], v140 offset:1056
    ds_read_b64 v[94:95], v140 offset:1064
    v_mfma_f32_16x16x32_bf16 v[8:11], v[40:43], v[64:67], v[8:11]
    ds_read_b64 v[96:97], v140 offset:2048
    v_mfma_f32_16x16x32_bf16 v[12:15], v[44:47], v[64:67], v[12:15]
    ds_read_b64 v[98:99], v140 offset:2056
    ds_read_b64 v[100:101], v140 offset:2080
    v_mfma_f32_16x16x32_bf16 v[16:19], v[40:43], v[68:71], v[16:19]
    ds_read_b64 v[102:103], v140 offset:2088
    v_mfma_f32_16x16x32_bf16 v[20:23], v[44:47], v[68:71], v[20:23]
    ds_read_b64 v[104:105], v140 offset:3072
    ds_read_b64 v[106:107], v140 offset:3080
    v_mfma_f32_16x16x32_bf16 v[24:27], v[40:43], v[72:75], v[24:27]
    ds_read_b64 v[108:109], v140 offset:3104
    v_mfma_f32_16x16x32_bf16 v[28:31], v[44:47], v[72:75], v[28:31]
    ds_read_b64 v[110:111], v140 offset:3112
    v_mfma_f32_16x16x32_bf16 v[16:19], v[48:51], v[64:67], v[16:19]
    s_mov_b32 m0, s38
    v_mfma_f32_16x16x32_bf16 v[20:23], v[52:55], v[64:67], v[20:23]
    v_mfma_f32_16x16x32_bf16 v[24:27], v[48:51], v[68:71], v[24:27]
    buffer_load_dwordx4 v209, s[16:19], s36 offen nt lds
    v_mfma_f32_16x16x32_bf16 v[28:31], v[52:55], v[68:71], v[28:31]
    s_add_u32 s38, s38, 1024
    s_add_u32 s36, s36, 98304
    v_mfma_f32_16x16x32_bf16 v[24:27], v[56:59], v[64:67], v[24:27]
    v_mfma_f32_16x16x32_bf16 v[28:31], v[60:63], v[64:67], v[28:31]
    s_waitcnt lgkmcnt(0)
    v_add_u32 v140, 64, v140
    v_subrev_u32 v141, 16, v141
    v_mfma_f32_16x16x32_bf16 v[0:3], v[80:83], v[112:115], v[0:3]
    ds_read_b128 v[64:67], v141 offset:0
    ds_read_b128 v[68:71], v141 offset:256
    v_mfma_f32_16x16x32_bf16 v[4:7], v[84:87], v[112:115], v[4:7]
    ds_read_b128 v[72:75], v141 offset:512
    v_mfma_f32_16x16x32_bf16 v[8:11], v[80:83], v[116:119], v[8:11]
    ds_read_b128 v[76:79], v141 offset:768
    ds_read_b64 v[32:33], v140 offset:0
    v_mfma_f32_16x16x32_bf16 v[12:15], v[84:87], v[116:119], v[12:15]
    ds_read_b64 v[34:35], v140 offset:8
    v_mfma_f32_16x16x32_bf16 v[16:19], v[80:83], v[120:123], v[16:19]
    ds_read_b64 v[36:37], v140 offset:32
    ds_read_b64 v[38:39], v140 offset:40
    v_mfma_f32_16x16x32_bf16 v[20:23], v[84:87], v[120:123], v[20:23]
    ds_read_b64 v[40:41], v140 offset:1024
    v_mfma_f32_16x16x32_bf16 v[24:27], v[80:83], v[124:127], v[24:27]
    ds_read_b64 v[42:43], v140 offset:1032
    v_mfma_f32_16x16x32_bf16 v[28:31], v[84:87], v[124:127], v[28:31]
    ds_read_b64 v[44:45], v140 offset:1056
    ds_read_b64 v[46:47], v140 offset:1064
    v_mfma_f32_16x16x32_bf16 v[8:11], v[88:91], v[112:115], v[8:11]
    ds_read_b64 v[48:49], v140 offset:2048
    v_mfma_f32_16x16x32_bf16 v[12:15], v[92:95], v[112:115], v[12:15]
    ds_read_b64 v[50:51], v140 offset:2056
    ds_read_b64 v[52:53], v140 offset:2080
    v_mfma_f32_16x16x32_bf16 v[16:19], v[88:91], v[116:119], v[16:19]
    ds_read_b64 v[54:55], v140 offset:2088
    v_mfma_f32_16x16x32_bf16 v[20:23], v[92:95], v[116:119], v[20:23]
    ds_read_b64 v[56:57], v140 offset:3072
    ds_read_b64 v[58:59], v140 offset:3080
    v_mfma_f32_16x16x32_bf16 v[24:27], v[88:91], v[120:123], v[24:27]
    ds_read_b64 v[60:61], v140 offset:3104
    v_mfma_f32_16x16x32_bf16 v[28:31], v[92:95], v[120:123], v[28:31]
    ds_read_b64 v[62:63], v140 offset:3112
    v_mfma_f32_16x16x32_bf16 v[16:19], v[96:99], v[112:115], v[16:19]
    s_mov_b32 m0, s38
    v_mfma_f32_16x16x32_bf16 v[20:23], v[100:103], v[112:115], v[20:23]
    v_mfma_f32_16x16x32_bf16 v[24:27], v[96:99], v[116:119], v[24:27]
    buffer_load_dwordx4 v209, s[16:19], s36 offen nt lds
    v_mfma_f32_16x16x32_bf16 v[28:31], v[100:103], v[116:119], v[28:31]
    s_add_u32 s38, s38, 1024
    s_add_u32 s36, s36, 98304
    v_mfma_f32_16x16x32_bf16 v[24:27], v[104:107], v[112:115], v[24:27]
    v_mfma_f32_16x16x32_bf16 v[28:31], v[108:111], v[112:115], v[28:31]
    s_sub_u32 s48, s48, 1
    s_cmp_lg_u32 s48, 0
    s_cbranch_scc1 L_f_conv
    s_waitcnt lgkmcnt(0)
    s_sub_u32 s38, s38, 16384
    s_and_b32 s74, s72, 1
    s_lshl_b32 s74, s74, 4
    s_lshr_b32 s75, s75, s74
    s_lshl_b32 s75, s75, 16
    v_lshrrev_b32 v144, 1, v143
    v_mul_u32_u24 v144, 1280, v144
    v_lshlrev_b32 v145, 4, v142
    v_add_u32 v144, v144, v145
    v_and_b32 v145, 1, v143
    v_xor_b32 v145, 1, v145
    v_lshlrev_b32 v145, 3, v145
    v_add_u32 v144, v144, v145
    v_add_u32 v144, s73, v144
    ds_read_b64 v[32:33], v144 offset:16896
    ds_read_b64 v[34:35], v144 offset:19456
    ds_read_b64 v[36:37], v144 offset:17152
    ds_read_b64 v[38:39], v144 offset:19712
    ds_read_b64 v[40:41], v144 offset:17408
    ds_read_b64 v[42:43], v144 offset:19968
    ds_read_b64 v[44:45], v144 offset:17664
    ds_read_b64 v[46:47], v144 offset:20224
    v_lshlrev_b32 v145, 2, v142
    v_and_b32 v146, 1, v143
    v_lshlrev_b32 v146, 1, v146
    v_add_u32 v145, v145, v146
    v_lshrrev_b32 v146, 1, v143
    v_add_u32 v145, v145, v146
    v_mul_u32_u24 v145, 80, v145
    s_lshl_b32 s74, s3, 4
    v_add_u32 v145, s74, v145
    s_waitcnt lgkmcnt(0)
    v_and_b32 v64, 0xffff0000, v33
    v_lshlrev_b32 v65, 16, v33
    v_and_b32 v66, 0xffff0000, v32
    v_lshlrev_b32 v67, 16, v32
    v_fmac_f32 v0, s75, v64
    v_fmac_f32 v1, s75, v65
    v_fmac_f32 v2, s75, v66
    v_fmac_f32 v3, s75, v67
    v_and_b32 v68, 0xffff0000, v35
    v_lshlrev_b32 v69, 16, v35
    v_and_b32 v70, 0xffff0000, v34
    v_lshlrev_b32 v71, 16, v34
    v_fmac_f32 v4, s75, v68
    v_fmac_f32 v5, s75, v69
    v_fmac_f32 v6, s75, v70
    v_fmac_f32 v7, s75, v71
    v_cvt_pk_bf16_f32 v72, v0, v1
    v_cvt_pk_bf16_f32 v73, v2, v3
    v_cvt_pk_bf16_f32 v74, v4, v5
    v_cvt_pk_bf16_f32 v75, v6, v7
    s_nop 0
    v_permlane16_swap_b32 v72, v74
    v_permlane16_swap_b32 v73, v75
    v_and_b32 v64, 0xffff0000, v37
    v_lshlrev_b32 v65, 16, v37
    v_and_b32 v66, 0xffff0000, v36
    v_lshlrev_b32 v67, 16, v36
    v_fmac_f32 v8, s75, v64
    v_fmac_f32 v9, s75, v65
    v_fmac_f32 v10, s75, v66
    v_fmac_f32 v11, s75, v67
    v_and_b32 v68, 0xffff0000, v39
    v_lshlrev_b32 v69, 16, v39
    v_and_b32 v70, 0xffff0000, v38
    v_lshlrev_b32 v71, 16, v38
    v_fmac_f32 v12, s75, v68
    v_fmac_f32 v13, s75, v69
    v_fmac_f32 v14, s75, v70
    v_fmac_f32 v15, s75, v71
    v_cvt_pk_bf16_f32 v76, v8, v9
    v_cvt_pk_bf16_f32 v77, v10, v11
    v_cvt_pk_bf16_f32 v78, v12, v13
    v_cvt_pk_bf16_f32 v79, v14, v15
    s_nop 0
    v_permlane16_swap_b32 v76, v78
    v_permlane16_swap_b32 v77, v79
    v_and_b32 v64, 0xffff0000, v41
    v_lshlrev_b32 v65, 16, v41
    v_and_b32 v66, 0xffff0000, v40
    v_lshlrev_b32 v67, 16, v40
    v_fmac_f32 v16, s75, v64
    v_fmac_f32 v17, s75, v65
    v_fmac_f32 v18, s75, v66
    v_fmac_f32 v19, s75, v67
    v_and_b32 v68, 0xffff0000, v43
    v_lshlrev_b32 v69, 16, v43
    v_and_b32 v70, 0xffff0000, v42
    v_lshlrev_b32 v71, 16, v42
    v_fmac_f32 v20, s75, v68
    v_fmac_f32 v21, s75, v69
    v_fmac_f32 v22, s75, v70
    v_fmac_f32 v23, s75, v71
    v_cvt_pk_bf16_f32 v80, v16, v17
    v_cvt_pk_bf16_f32 v81, v18, v19
    v_cvt_pk_bf16_f32 v82, v20, v21
    v_cvt_pk_bf16_f32 v83, v22, v23
    s_nop 0
    v_permlane16_swap_b32 v80, v82
    v_permlane16_swap_b32 v81, v83
    v_and_b32 v64, 0xffff0000, v45
    v_lshlrev_b32 v65, 16, v45
    v_and_b32 v66, 0xffff0000, v44
    v_lshlrev_b32 v67, 16, v44
    v_fmac_f32 v24, s75, v64
    v_fmac_f32 v25, s75, v65
    v_fmac_f32 v26, s75, v66
    v_fmac_f32 v27, s75, v67
    v_and_b32 v68, 0xffff0000, v47
    v_lshlrev_b32 v69, 16, v47
    v_and_b32 v70, 0xffff0000, v46
    v_lshlrev_b32 v71, 16, v46
    v_fmac_f32 v28, s75, v68
    v_fmac_f32 v29, s75, v69
    v_fmac_f32 v30, s75, v70
    v_fmac_f32 v31, s75, v71
    v_cvt_pk_bf16_f32 v84, v24, v25
    v_cvt_pk_bf16_f32 v85, v26, v27
    v_cvt_pk_bf16_f32 v86, v28, v29
    v_cvt_pk_bf16_f32 v87, v30, v31
    s_nop 0
    v_permlane16_swap_b32 v84, v86
    v_permlane16_swap_b32 v85, v87
    s_barrier
    ds_write_b128 v145, v[72:75] offset:0
    ds_write_b128 v145, v[76:79] offset:5120
    ds_write_b128 v145, v[80:83] offset:10240
    ds_write_b128 v145, v[84:87] offset:15360
    s_waitcnt lgkmcnt(0)
    s_barrier
    v_and_b32 v144, 3, v210
    v_lshrrev_b32 v145, 2, v210
    v_mul_u32_u24 v146, 80, v145
    v_lshlrev_b32 v147, 4, v144
    v_add_u32 v146, v146, v147
    ds_read_b128 v[32:35], v146 offset:0
    ds_read_b128 v[36:39], v146 offset:5120
    ds_read_b128 v[40:43], v146 offset:10240
    ds_read_b128 v[44:47], v146 offset:15360
    v_lshlrev_b32 v145, 14, v145
    v_add_u32 v145, v145, v147
    s_lshr_b32 s74, s72, 2
    s_lshl_b32 s74, s74, 6
    s_waitcnt lgkmcnt(0)
    s_add_u32 s48, s74, 0
    buffer_store_dwordx4 v[32:35], v145, s[24:27], s48 offen sc1
    s_add_u32 s48, s74, 1048576
    buffer_store_dwordx4 v[36:39], v145, s[24:27], s48 offen sc1
    s_add_u32 s48, s74, 2097152
    buffer_store_dwordx4 v[40:43], v145, s[24:27], s48 offen sc1
    s_add_u32 s48, s74, 3145728
    buffer_store_dwordx4 v[44:47], v145, s[24:27], s48 offen sc1
    s_waitcnt vmcnt(0)
    s_barrier
    s_cmp_lg_u32 s3, 0
    s_cbranch_scc1 L_f_stats
    v_mov_b32 v5, 1
    v_mov_b32 v6, 0
    s_add_u32 s28, s4, 58916864
    s_addc_u32 s29, s5, 0
    s_mov_b32 s30, 2048
    s_mov_b32 s31, 0x00020000
    s_lshl_b32 s48, s70, 7
    v_cmp_eq_u32 vcc, 0, v225
    s_nop 1
    s_and_saveexec_b64 s[50:51], vcc
    buffer_atomic_add v5, v6, s[28:31], s48 offen sc0 sc1
    s_waitcnt vmcnt(0)
    v_readfirstlane_b32 s49, v5
    s_nop 1
    s_cmp_lg_u32 s49, 15
    s_cbranch_scc1 L_f_notlast
    s_mov_b64 exec, s[50:51]
    s_add_u32 s28, s4, 59768832
    s_addc_u32 s29, s5, 0
    s_mov_b32 s30, 32768
    s_mov_b32 s31, 0x00020000
    v_mov_b32 v8, s86
    v_xor_b32 v9, 0x3c96e5a1, v8
    v_lshlrev_b32 v7, 7, v225
    s_lshl_b32 s48, s70, 3
    s_add_u32 s49, s48, 0
    buffer_store_dwordx2 v[8:9], v7, s[28:31], s49 offen sc1
    s_add_u32 s49, s48, 8192
    buffer_store_dwordx2 v[8:9], v7, s[28:31], s49 offen sc1
    s_add_u32 s49, s48, 16384
    buffer_store_dwordx2 v[8:9], v7, s[28:31], s49 offen sc1
    s_add_u32 s49, s48, 24576
    buffer_store_dwordx2 v[8:9], v7, s[28:31], s49 offen sc1
L_f_notlast:
    s_mov_b64 exec, s[50:51]
L_f_stats:
    s_getpc_b64 s[76:77]
L_cpf_2:
    v_lshlrev_b32 v198, 7, v225
    s_lshl_b32 s78, s3, 13
    v_add_u32 v198, s78, v198
    s_cmp_lt_u32 s2, 16
    s_cselect_b32 s78, -1, 0
    v_and_b32 v198, s78, v198
    v_min_u32 v199, L_b_k26-L_cpf_2-4, v198
    global_load_dword v221, v199, s[76:77]
    s_bfe_u32 s28, s2, 0x30003
    s_and_b32 s29, s2, 7
    s_lshl_b32 s29, s29, 2
    s_lshr_b32 s30, s2, 6
    s_add_u32 s29, s29, s30
    s_lshl_b32 s28, s28, 6
    s_and_b32 s30, s3, 1
    s_lshl_b32 s30, s30, 5
    s_add_u32 s28, s28, s30
    s_mul_i32 s28, s28, 7168
    s_mul_i32 s29, s29, 224
    s_add_u32 s28, s28, s29
    v_lshrrev_b32 v200, 1, v225
    v_mul_u32_u24 v200, 7168, v200
    v_and_b32 v201, 1, v225
    v_lshlrev_b32 v201, 7, v201
    v_add_u32 v200, v200, v201
    v_add_u32 v200, s28, v200
    v_and_b32 v201, 31, v225
    v_mul_u32_u24 v201, 7168, v201
    v_add_u32 v201, s28, v201
    v_add_u32 v201, 223, v201
    s_cmp_ge_u32 s3, 2
    s_cselect_b32 s28, s66, s64
    s_cselect_b32 s29, s67, s65
    s_mov_b32 s30, 7340032
    s_mov_b32 s31, 0x00020000
    s_mov_b32 s48, 0
    buffer_load_ubyte v221, v200, s[28:31], s48 offen
    buffer_load_ubyte v221, v201, s[28:31], s48 offen
    s_cmp_ge_u32 s2, 192
    s_cbranch_scc1 L_f_gemv_done
    v_lshlrev_b32 v10, 16, v211
    v_and_b32 v11, 0xffff0000, v211
    v_mul_f32 v12, 0xbfb8aa3b, v10
    v_mul_f32 v13, 0xbfb8aa3b, v11
    v_exp_f32 v12, v12
    v_exp_f32 v13, v13
    v_add_f32 v12, 1.0, v12
    v_add_f32 v13, 1.0, v13
    v_rcp_f32 v12, v12
    v_rcp_f32 v13, v13
    v_mul_f32 v12, v12, v10
    v_mul_f32 v13, v13, v11
    v_cvt_pk_bf16_f32 v12, v12, v13
    v_add_u32 v14, s39, v208
    ds_write_b32 v14, v12
    v_lshrrev_b32 v15, 4, v225
    v_lshlrev_b32 v15, 4, v15
    v_add_u32 v15, s39, v15
    v_lshrrev_b32 v16, 4, v225
    v_lshlrev_b32 v16, 3, v16
    v_bfe_u32 v17, v225, 2, 2
    v_add_u32 v16, v16, v17
    v_lshlrev_b32 v16, 7, v16
    v_and_b32 v17, 3, v225
    v_lshlrev_b32 v17, 3, v17
    v_add_u32 v16, v16, v17
    v_add_u32 v16, s38, v16
    s_waitcnt lgkmcnt(0)
    ds_read_b128 v[84:87], v15 offset:0
    ds_read_b128 v[88:91], v15 offset:64
    ds_read_b128 v[92:95], v15 offset:128
    ds_read_b128 v[96:99], v15 offset:192
    v_mov_b32 v100, 0
    v_mov_b32 v101, 0
    v_mov_b32 v102, 0
    v_mov_b32 v103, 0
    v_mov_b32 v104, 0
    v_mov_b32 v105, 0
    v_mov_b32 v106, 0
    v_mov_b32 v107, 0
    v_mov_b32 v108, 0
    v_mov_b32 v109, 0
    v_mov_b32 v110, 0
    v_mov_b32 v111, 0
    v_mov_b32 v112, 0
    v_mov_b32 v113, 0
    v_mov_b32 v114, 0
    v_mov_b32 v115, 0
    ds_read_b64_tr_b16 v[128:129], v16 offset:0
    ds_read_b64_tr_b16 v[130:131], v16 offset:512
    ds_read_b64_tr_b16 v[132:133], v16 offset:32
    ds_read_b64_tr_b16 v[134:135], v16 offset:544
    ds_read_b64_tr_b16 v[136:137], v16 offset:64
    ds_read_b64_tr_b16 v[138:139], v16 offset:576
    ds_read_b64_tr_b16 v[140:141], v16 offset:96
    ds_read_b64_tr_b16 v[142:143], v16 offset:608
    ds_read_b64_tr_b16 v[144:145], v16 offset:4096
    ds_read_b64_tr_b16 v[146:147], v16 offset:4608
    ds_read_b64_tr_b16 v[148:149], v16 offset:4128
    ds_read_b64_tr_b16 v[150:151], v16 offset:4640
    ds_read_b64_tr_b16 v[152:153], v16 offset:4160
    ds_read_b64_tr_b16 v[154:155], v16 offset:4672
    ds_read_b64_tr_b16 v[156:157], v16 offset:4192
    ds_read_b64_tr_b16 v[158:159], v16 offset:4704
    ds_read_b64_tr_b16 v[160:161], v16 offset:8192
    ds_read_b64_tr_b16 v[162:163], v16 offset:8704
    ds_read_b64_tr_b16 v[164:165], v16 offset:8224
    ds_read_b64_tr_b16 v[166:167], v16 offset:8736
    ds_read_b64_tr_b16 v[168:169], v16 offset:8256
    ds_read_b64_tr_b16 v[170:171], v16 offset:8768
    ds_read_b64_tr_b16 v[172:173], v16 offset:8288
    ds_read_b64_tr_b16 v[174:175], v16 offset:8800
    ds_read_b64_tr_b16 v[176:177], v16 offset:12288
    ds_read_b64_tr_b16 v[178:179], v16 offset:12800
    ds_read_b64_tr_b16 v[180:181], v16 offset:12320
    ds_read_b64_tr_b16 v[182:183], v16 offset:12832
    ds_read_b64_tr_b16 v[184:185], v16 offset:12352
    ds_read_b64_tr_b16 v[186:187], v16 offset:12864
    ds_read_b64_tr_b16 v[188:189], v16 offset:12384
    ds_read_b64_tr_b16 v[190:191], v16 offset:12896
    s_waitcnt lgkmcnt(0)
    v_mfma_f32_16x16x32_bf16 v[100:103], v[128:131], v[84:87], v[100:103]
    v_mfma_f32_16x16x32_bf16 v[104:107], v[132:135], v[84:87], v[104:107]
    v_mfma_f32_16x16x32_bf16 v[108:111], v[136:139], v[84:87], v[108:111]
    v_mfma_f32_16x16x32_bf16 v[112:115], v[140:143], v[84:87], v[112:115]
    v_mfma_f32_16x16x32_bf16 v[100:103], v[144:147], v[88:91], v[100:103]
    v_mfma_f32_16x16x32_bf16 v[104:107], v[148:151], v[88:91], v[104:107]
    v_mfma_f32_16x16x32_bf16 v[108:111], v[152:155], v[88:91], v[108:111]
    v_mfma_f32_16x16x32_bf16 v[112:115], v[156:159], v[88:91], v[112:115]
    v_mfma_f32_16x16x32_bf16 v[100:103], v[160:163], v[92:95], v[100:103]
    v_mfma_f32_16x16x32_bf16 v[104:107], v[164:167], v[92:95], v[104:107]
    v_mfma_f32_16x16x32_bf16 v[108:111], v[168:171], v[92:95], v[108:111]
    v_mfma_f32_16x16x32_bf16 v[112:115], v[172:175], v[92:95], v[112:115]
    v_mfma_f32_16x16x32_bf16 v[100:103], v[176:179], v[96:99], v[100:103]
    v_mfma_f32_16x16x32_bf16 v[104:107], v[180:183], v[96:99], v[104:107]
    v_mfma_f32_16x16x32_bf16 v[108:111], v[184:187], v[96:99], v[108:111]
    v_mfma_f32_16x16x32_bf16 v[112:115], v[188:191], v[96:99], v[112:115]
    v_lshrrev_b32 v5, 4, v225
    v_lshlrev_b32 v5, 4, v5
    v_add_u32 v5, 87040, v5
    v_and_b32 v6, 15, v225
    v_cmp_eq_u32 vcc, 0, v6
    s_nop 1
    s_and_saveexec_b64 s[50:51], vcc
    ds_add_f32 v5, v100 offset:0
    ds_add_f32 v5, v101 offset:4
    ds_add_f32 v5, v102 offset:8
    ds_add_f32 v5, v103 offset:12
    ds_add_f32 v5, v104 offset:64
    ds_add_f32 v5, v105 offset:68
    ds_add_f32 v5, v106 offset:72
    ds_add_f32 v5, v107 offset:76
    ds_add_f32 v5, v108 offset:128
    ds_add_f32 v5, v109 offset:132
    ds_add_f32 v5, v110 offset:136
    ds_add_f32 v5, v111 offset:140
    ds_add_f32 v5, v112 offset:192
    ds_add_f32 v5, v113 offset:196
    ds_add_f32 v5, v114 offset:200
    ds_add_f32 v5, v115 offset:204
    s_mov_b64 exec, s[50:51]
    s_waitcnt lgkmcnt(0)
L_f_gemv_done:
    s_barrier
    s_cmp_ge_u32 s2, 192
    s_cbranch_scc1 L_f_mod_done
    s_cmp_lg_u32 s3, 0
    s_cbranch_scc1 L_f_mod_done
    v_lshlrev_b32 v5, 2, v225
    v_add_u32 v6, 87040, v5
    ds_read_b32 v64, v6
    s_add_u32 s28, s4, 33554432
    s_addc_u32 s29, s5, 0
    s_mov_b32 s30, 49152
    s_mov_b32 s31, 0x00020000
    s_lshl_b32 s48, s33, 8
    s_mul_i32 s49, s34, 24576
    s_add_u32 s48, s48, s49
    s_waitcnt lgkmcnt(0)
    buffer_store_dword v64, v5, s[28:31], s48 offen sc1
L_f_mod_done:
    v_accvgpr_read_b32 v112, a0
    v_accvgpr_read_b32 v113, a1
    v_accvgpr_read_b32 v114, a2
    v_accvgpr_read_b32 v115, a3
    v_accvgpr_read_b32 v116, a4
    v_accvgpr_read_b32 v117, a5
    v_accvgpr_read_b32 v118, a6
    v_accvgpr_read_b32 v119, a7
    v_accvgpr_read_b32 v120, a8
    v_accvgpr_read_b32 v121, a9
    v_accvgpr_read_b32 v122, a10
    v_accvgpr_read_b32 v123, a11
    v_accvgpr_read_b32 v124, a12
    v_accvgpr_read_b32 v125, a13
    v_accvgpr_read_b32 v126, a14
    v_accvgpr_read_b32 v127, a15
    v_lshlrev_b32 v32, 16, v112
    v_and_b32 v33, 0xffff0000, v112
    v_lshlrev_b32 v34, 16, v113
    v_and_b32 v35, 0xffff0000, v113
    v_lshlrev_b32 v36, 16, v114
    v_and_b32 v37, 0xffff0000, v114
    v_lshlrev_b32 v38, 16, v115
    v_and_b32 v39, 0xffff0000, v115
    v_lshlrev_b32 v40, 16, v116
    v_and_b32 v41, 0xffff0000, v116
    v_lshlrev_b32 v42, 16, v117
    v_and_b32 v43, 0xffff0000, v117
    v_lshlrev_b32 v44, 16, v118
    v_and_b32 v45, 0xffff0000, v118
    v_lshlrev_b32 v46, 16, v119
    v_and_b32 v47, 0xffff0000, v119
    v_lshlrev_b32 v48, 16, v120
    v_and_b32 v49, 0xffff0000, v120
    v_lshlrev_b32 v50, 16, v121
    v_and_b32 v51, 0xffff0000, v121
    v_lshlrev_b32 v52, 16, v122
    v_and_b32 v53, 0xffff0000, v122
    v_lshlrev_b32 v54, 16, v123
    v_and_b32 v55, 0xffff0000, v123
    v_lshlrev_b32 v56, 16, v124
    v_and_b32 v57, 0xffff0000, v124
    v_lshlrev_b32 v58, 16, v125
    v_and_b32 v59, 0xffff0000, v125
    v_lshlrev_b32 v60, 16, v126
    v_and_b32 v61, 0xffff0000, v126
    v_lshlrev_b32 v62, 16, v127
    v_and_b32 v63, 0xffff0000, v127
    v_add_f32 v96, v32, v33
    v_mul_f32 v104, v32, v32
    v_add_f32 v97, v36, v37
    v_mul_f32 v105, v36, v36
    v_add_f32 v98, v40, v41
    v_mul_f32 v106, v40, v40
    v_add_f32 v99, v44, v45
    v_mul_f32 v107, v44, v44
    v_add_f32 v100, v48, v49
    v_mul_f32 v108, v48, v48
    v_add_f32 v101, v52, v53
    v_mul_f32 v109, v52, v52
    v_add_f32 v102, v56, v57
    v_mul_f32 v110, v56, v56
    v_add_f32 v103, v60, v61
    v_mul_f32 v111, v60, v60
    v_add_f32 v96, v96, v34
    v_fmac_f32 v104, v33, v33
    v_add_f32 v97, v97, v38
    v_fmac_f32 v105, v37, v37
    v_add_f32 v98, v98, v42
    v_fmac_f32 v106, v41, v41
    v_add_f32 v99, v99, v46
    v_fmac_f32 v107, v45, v45
    v_add_f32 v100, v100, v50
    v_fmac_f32 v108, v49, v49
    v_add_f32 v101, v101, v54
    v_fmac_f32 v109, v53, v53
    v_add_f32 v102, v102, v58
    v_fmac_f32 v110, v57, v57
    v_add_f32 v103, v103, v62
    v_fmac_f32 v111, v61, v61
    v_add_f32 v96, v96, v35
    v_fmac_f32 v104, v34, v34
    v_add_f32 v97, v97, v39
    v_fmac_f32 v105, v38, v38
    v_add_f32 v98, v98, v43
    v_fmac_f32 v106, v42, v42
    v_add_f32 v99, v99, v47
    v_fmac_f32 v107, v46, v46
    v_add_f32 v100, v100, v51
    v_fmac_f32 v108, v50, v50
    v_add_f32 v101, v101, v55
    v_fmac_f32 v109, v54, v54
    v_add_f32 v102, v102, v59
    v_fmac_f32 v110, v58, v58
    v_add_f32 v103, v103, v63
    v_fmac_f32 v111, v62, v62
    v_fmac_f32 v104, v35, v35
    v_fmac_f32 v105, v39, v39
    v_fmac_f32 v106, v43, v43
    v_fmac_f32 v107, v47, v47
    v_fmac_f32 v108, v51, v51
    v_fmac_f32 v109, v55, v55
    v_fmac_f32 v110, v59, v59
    v_fmac_f32 v111, v63, v63
    v_add_f32_dpp v96, v96, v96 row_shr:1 row_mask:0xf bank_mask:0xf
    v_add_f32_dpp v97, v97, v97 row_shr:1 row_mask:0xf bank_mask:0xf
    v_add_f32_dpp v98, v98, v98 row_shr:1 row_mask:0xf bank_mask:0xf
    v_add_f32_dpp v99, v99, v99 row_shr:1 row_mask:0xf bank_mask:0xf
    v_add_f32_dpp v100, v100, v100 row_shr:1 row_mask:0xf bank_mask:0xf
    v_add_f32_dpp v101, v101, v101 row_shr:1 row_mask:0xf bank_mask:0xf
    v_add_f32_dpp v102, v102, v102 row_shr:1 row_mask:0xf bank_mask:0xf
    v_add_f32_dpp v103, v103, v103 row_shr:1 row_mask:0xf bank_mask:0xf
    v_add_f32_dpp v104, v104, v104 row_shr:1 row_mask:0xf bank_mask:0xf
    v_add_f32_dpp v105, v105, v105 row_shr:1 row_mask:0xf bank_mask:0xf
    v_add_f32_dpp v106, v106, v106 row_shr:1 row_mask:0xf bank_mask:0xf
    v_add_f32_dpp v107, v107, v107 row_shr:1 row_mask:0xf bank_mask:0xf
    v_add_f32_dpp v108, v108, v108 row_shr:1 row_mask:0xf bank_mask:0xf
    v_add_f32_dpp v109, v109, v109 row_shr:1 row_mask:0xf bank_mask:0xf
    v_add_f32_dpp v110, v110, v110 row_shr:1 row_mask:0xf bank_mask:0xf
    v_add_f32_dpp v111, v111, v111 row_shr:1 row_mask:0xf bank_mask:0xf
    v_add_f32_dpp v96, v96, v96 row_shr:2 row_mask:0xf bank_mask:0xf
    v_add_f32_dpp v97, v97, v97 row_shr:2 row_mask:0xf bank_mask:0xf
    v_add_f32_dpp v98, v98, v98 row_shr:2 row_mask:0xf bank_mask:0xf
    v_add_f32_dpp v99, v99, v99 row_shr:2 row_mask:0xf bank_mask:0xf
    v_add_f32_dpp v100, v100, v100 row_shr:2 row_mask:0xf bank_mask:0xf
    v_add_f32_dpp v101, v101, v101 row_shr:2 row_mask:0xf bank_mask:0xf
    v_add_f32_dpp v102, v102, v102 row_shr:2 row_mask:0xf bank_mask:0xf
    v_add_f32_dpp v103, v103, v103 row_shr:2 row_mask:0xf bank_mask:0xf
    v_add_f32_dpp v104, v104, v104 row_shr:2 row_mask:0xf bank_mask:0xf
    v_add_f32_dpp v105, v105, v105 row_shr:2 row_mask:0xf bank_mask:0xf
    v_add_f32_dpp v106, v106, v106 row_shr:2 row_mask:0xf bank_mask:0xf
    v_add_f32_dpp v107, v107, v107 row_shr:2 row_mask:0xf bank_mask:0xf
    v_add_f32_dpp v108, v108, v108 row_shr:2 row_mask:0xf bank_mask:0xf
    v_add_f32_dpp v109, v109, v109 row_shr:2 row_mask:0xf bank_mask:0xf
    v_add_f32_dpp v110, v110, v110 row_shr:2 row_mask:0xf bank_mask:0xf
    v_add_f32_dpp v111, v111, v111 row_shr:2 row_mask:0xf bank_mask:0xf
    v_add_f32_dpp v96, v96, v96 row_shr:4 row_mask:0xf bank_mask:0xf
    v_add_f32_dpp v97, v97, v97 row_shr:4 row_mask:0xf bank_mask:0xf
    v_add_f32_dpp v98, v98, v98 row_shr:4 row_mask:0xf bank_mask:0xf
    v_add_f32_dpp v99, v99, v99 row_shr:4 row_mask:0xf bank_mask:0xf
    v_add_f32_dpp v100, v100, v100 row_shr:4 row_mask:0xf bank_mask:0xf
    v_add_f32_dpp v101, v101, v101 row_shr:4 row_mask:0xf bank_mask:0xf
    v_add_f32_dpp v102, v102, v102 row_shr:4 row_mask:0xf bank_mask:0xf
    v_add_f32_dpp v103, v103, v103 row_shr:4 row_mask:0xf bank_mask:0xf
    v_add_f32_dpp v104, v104, v104 row_shr:4 row_mask:0xf bank_mask:0xf
    v_add_f32_dpp v105, v105, v105 row_shr:4 row_mask:0xf bank_mask:0xf
    v_add_f32_dpp v106, v106, v106 row_shr:4 row_mask:0xf bank_mask:0xf
    v_add_f32_dpp v107, v107, v107 row_shr:4 row_mask:0xf bank_mask:0xf
    v_add_f32_dpp v108, v108, v108 row_shr:4 row_mask:0xf bank_mask:0xf
    v_add_f32_dpp v109, v109, v109 row_shr:4 row_mask:0xf bank_mask:0xf
    v_add_f32_dpp v110, v110, v110 row_shr:4 row_mask:0xf bank_mask:0xf
    v_add_f32_dpp v111, v111, v111 row_shr:4 row_mask:0xf bank_mask:0xf
    v_add_f32_dpp v96, v96, v96 row_shr:8 row_mask:0xf bank_mask:0xf
    v_add_f32_dpp v97, v97, v97 row_shr:8 row_mask:0xf bank_mask:0xf
    v_add_f32_dpp v98, v98, v98 row_shr:8 row_mask:0xf bank_mask:0xf
    v_add_f32_dpp v99, v99, v99 row_shr:8 row_mask:0xf bank_mask:0xf
    v_add_f32_dpp v100, v100, v100 row_shr:8 row_mask:0xf bank_mask:0xf
    v_add_f32_dpp v101, v101, v101 row_shr:8 row_mask:0xf bank_mask:0xf
    v_add_f32_dpp v102, v102, v102 row_shr:8 row_mask:0xf bank_mask:0xf
    v_add_f32_dpp v103, v103, v103 row_shr:8 row_mask:0xf bank_mask:0xf
    v_add_f32_dpp v104, v104, v104 row_shr:8 row_mask:0xf bank_mask:0xf
    v_add_f32_dpp v105, v105, v105 row_shr:8 row_mask:0xf bank_mask:0xf
    v_add_f32_dpp v106, v106, v106 row_shr:8 row_mask:0xf bank_mask:0xf
    v_add_f32_dpp v107, v107, v107 row_shr:8 row_mask:0xf bank_mask:0xf
    v_add_f32_dpp v108, v108, v108 row_shr:8 row_mask:0xf bank_mask:0xf
    v_add_f32_dpp v109, v109, v109 row_shr:8 row_mask:0xf bank_mask:0xf
    v_add_f32_dpp v110, v110, v110 row_shr:8 row_mask:0xf bank_mask:0xf
    v_add_f32_dpp v111, v111, v111 row_shr:8 row_mask:0xf bank_mask:0xf
    v_add_f32_dpp v96, v96, v96 row_bcast:15 row_mask:0xa bank_mask:0xf
    v_add_f32_dpp v97, v97, v97 row_bcast:15 row_mask:0xa bank_mask:0xf
    v_add_f32_dpp v98, v98, v98 row_bcast:15 row_mask:0xa bank_mask:0xf
    v_add_f32_dpp v99, v99, v99 row_bcast:15 row_mask:0xa bank_mask:0xf
    v_add_f32_dpp v100, v100, v100 row_bcast:15 row_mask:0xa bank_mask:0xf
    v_add_f32_dpp v101, v101, v101 row_bcast:15 row_mask:0xa bank_mask:0xf
    v_add_f32_dpp v102, v102, v102 row_bcast:15 row_mask:0xa bank_mask:0xf
    v_add_f32_dpp v103, v103, v103 row_bcast:15 row_mask:0xa bank_mask:0xf
    v_add_f32_dpp v104, v104, v104 row_bcast:15 row_mask:0xa bank_mask:0xf
    v_add_f32_dpp v105, v105, v105 row_bcast:15 row_mask:0xa bank_mask:0xf
    v_add_f32_dpp v106, v106, v106 row_bcast:15 row_mask:0xa bank_mask:0xf
    v_add_f32_dpp v107, v107, v107 row_bcast:15 row_mask:0xa bank_mask:0xf
    v_add_f32_dpp v108, v108, v108 row_bcast:15 row_mask:0xa bank_mask:0xf
    v_add_f32_dpp v109, v109, v109 row_bcast:15 row_mask:0xa bank_mask:0xf
    v_add_f32_dpp v110, v110, v110 row_bcast:15 row_mask:0xa bank_mask:0xf
    v_add_f32_dpp v111, v111, v111 row_bcast:15 row_mask:0xa bank_mask:0xf
    v_add_f32_dpp v96, v96, v96 row_bcast:31 row_mask:0xc bank_mask:0xf
    v_add_f32_dpp v97, v97, v97 row_bcast:31 row_mask:0xc bank_mask:0xf
    v_add_f32_dpp v98, v98, v98 row_bcast:31 row_mask:0xc bank_mask:0xf
    v_add_f32_dpp v99, v99, v99 row_bcast:31 row_mask:0xc bank_mask:0xf
    v_add_f32_dpp v100, v100, v100 row_bcast:31 row_mask:0xc bank_mask:0xf
    v_add_f32_dpp v101, v101, v101 row_bcast:31 row_mask:0xc bank_mask:0xf
    v_add_f32_dpp v102, v102, v102 row_bcast:31 row_mask:0xc bank_mask:0xf
    v_add_f32_dpp v103, v103, v103 row_bcast:31 row_mask:0xc bank_mask:0xf
    v_add_f32_dpp v104, v104, v104 row_bcast:31 row_mask:0xc bank_mask:0xf
    v_add_f32_dpp v105, v105, v105 row_bcast:31 row_mask:0xc bank_mask:0xf
    v_add_f32_dpp v106, v106, v106 row_bcast:31 row_mask:0xc bank_mask:0xf
    v_add_f32_dpp v107, v107, v107 row_bcast:31 row_mask:0xc bank_mask:0xf
    v_add_f32_dpp v108, v108, v108 row_bcast:31 row_mask:0xc bank_mask:0xf
    v_add_f32_dpp v109, v109, v109 row_bcast:31 row_mask:0xc bank_mask:0xf
    v_add_f32_dpp v110, v110, v110 row_bcast:31 row_mask:0xc bank_mask:0xf
    v_add_f32_dpp v111, v111, v111 row_bcast:31 row_mask:0xc bank_mask:0xf
    s_lshl_b32 s48, s3, 6
    s_add_u32 s48, s48, 88576
    v_mov_b32 v112, s48
    v_cmp_eq_u32 vcc, 63, v225
    s_nop 1
    s_and_saveexec_b64 s[50:51], vcc
    ds_write_b128 v112, v[96:99] offset:0
    ds_write_b128 v112, v[100:103] offset:16
    ds_write_b128 v112, v[104:107] offset:32
    ds_write_b128 v112, v[108:111] offset:48
    s_mov_b64 exec, s[50:51]
    s_waitcnt lgkmcnt(0)
    s_barrier
    v_and_b32 v112, 15, v225
    v_lshlrev_b32 v112, 2, v112
    v_add_u32 v112, 88576, v112
    ds_read_b32 v113, v112 offset:0
    ds_read_b32 v114, v112 offset:64
    ds_read_b32 v115, v112 offset:128
    ds_read_b32 v116, v112 offset:192
    s_waitcnt lgkmcnt(0)
    v_add_f32 v113, v113, v114
    v_add_f32 v115, v115, v116
    v_add_f32 v113, v113, v115
    s_nop 1
    v_mov_b32_dpp v114, v113 row_ror:8 row_mask:0xf bank_mask:0xf
    v_mul_f32 v222, 0x3a800000, v113
    v_mul_f32 v114, 0x3a800000, v114
    v_fma_f32 v114, -v222, v222, v114
    v_max_f32 v114, 0, v114
    v_add_f32 v114, 0x3727c5ac, v114
    v_rsq_f32 v223, v114
    v_readlane_b32 s60, v222, 0
    v_readlane_b32 s8, v223, 0
    v_readlane_b32 s61, v222, 1
    v_readlane_b32 s9, v223, 1
    v_readlane_b32 s62, v222, 2
    v_readlane_b32 s10, v223, 2
    v_readlane_b32 s63, v222, 3
    v_readlane_b32 s11, v223, 3
    v_readlane_b32 s64, v222, 4
    v_readlane_b32 s12, v223, 4
    v_readlane_b32 s65, v222, 5
    v_readlane_b32 s13, v223, 5
    v_readlane_b32 s66, v222, 6
    v_readlane_b32 s14, v223, 6
    v_readlane_b32 s67, v222, 7
    v_readlane_b32 s15, v223, 7
    v_mov_b32 v64, v32
    v_subrev_f32 v120, s60, v32
    v_mul_f32 v120, s8, v120
    v_mov_b32 v65, v33
    v_subrev_f32 v121, s60, v33
    v_mul_f32 v121, s8, v121
    v_mov_b32 v66, v34
    v_subrev_f32 v122, s60, v34
    v_mul_f32 v122, s8, v122
    v_mov_b32 v67, v35
    v_subrev_f32 v123, s60, v35
    v_mul_f32 v123, s8, v123
    v_mov_b32 v68, v36
    v_subrev_f32 v124, s61, v36
    v_mul_f32 v124, s9, v124
    v_mov_b32 v69, v37
    v_subrev_f32 v125, s61, v37
    v_mul_f32 v125, s9, v125
    v_mov_b32 v70, v38
    v_subrev_f32 v126, s61, v38
    v_mul_f32 v126, s9, v126
    v_mov_b32 v71, v39
    v_subrev_f32 v127, s61, v39
    v_mul_f32 v127, s9, v127
    v_mov_b32 v72, v40
    v_subrev_f32 v128, s62, v40
    v_mul_f32 v128, s10, v128
    v_mov_b32 v73, v41
    v_subrev_f32 v129, s62, v41
    v_mul_f32 v129, s10, v129
    v_mov_b32 v74, v42
    v_subrev_f32 v130, s62, v42
    v_mul_f32 v130, s10, v130
    v_mov_b32 v75, v43
    v_subrev_f32 v131, s62, v43
    v_mul_f32 v131, s10, v131
    v_mov_b32 v76, v44
    v_subrev_f32 v132, s63, v44
    v_mul_f32 v132, s11, v132
    v_mov_b32 v77, v45
    v_subrev_f32 v133, s63, v45
    v_mul_f32 v133, s11, v133
    v_mov_b32 v78, v46
    v_subrev_f32 v134, s63, v46
    v_mul_f32 v134, s11, v134
    v_mov_b32 v79, v47
    v_subrev_f32 v135, s63, v47
    v_mul_f32 v135, s11, v135
    v_mov_b32 v80, v48
    v_subrev_f32 v136, s64, v48
    v_mul_f32 v136, s12, v136
    v_mov_b32 v81, v49
    v_subrev_f32 v137, s64, v49
    v_mul_f32 v137, s12, v137
    v_mov_b32 v82, v50
    v_subrev_f32 v138, s64, v50
    v_mul_f32 v138, s12, v138
    v_mov_b32 v83, v51
    v_subrev_f32 v139, s64, v51
    v_mul_f32 v139, s12, v139
    v_mov_b32 v84, v52
    v_subrev_f32 v140, s65, v52
    v_mul_f32 v140, s13, v140
    v_mov_b32 v85, v53
    v_subrev_f32 v141, s65, v53
    v_mul_f32 v141, s13, v141
    v_mov_b32 v86, v54
    v_subrev_f32 v142, s65, v54
    v_mul_f32 v142, s13, v142
    v_mov_b32 v87, v55
    v_subrev_f32 v143, s65, v55
    v_mul_f32 v143, s13, v143
    v_mov_b32 v88, v56
    v_subrev_f32 v144, s66, v56
    v_mul_f32 v144, s14, v144
    v_mov_b32 v89, v57
    v_subrev_f32 v145, s66, v57
    v_mul_f32 v145, s14, v145
    v_mov_b32 v90, v58
    v_subrev_f32 v146, s66, v58
    v_mul_f32 v146, s14, v146
    v_mov_b32 v91, v59
    v_subrev_f32 v147, s66, v59
    v_mul_f32 v147, s14, v147
    v_mov_b32 v92, v60
    v_subrev_f32 v148, s67, v60
    v_mul_f32 v148, s15, v148
    v_mov_b32 v93, v61
    v_subrev_f32 v149, s67, v61
    v_mul_f32 v149, s15, v149
    v_mov_b32 v94, v62
    v_subrev_f32 v150, s67, v62
    v_mul_f32 v150, s15, v150
    v_mov_b32 v95, v63
    v_subrev_f32 v151, s67, v63
    v_mul_f32 v151, s15, v151
    s_cmp_lg_u32 s3, 0
    s_cbranch_scc1 L_f_go_ok
    s_add_u32 s28, s4, 59768832
    s_addc_u32 s29, s5, 0
    s_mov_b32 s30, 32768
    s_mov_b32 s31, 0x00020000
    v_and_b32 v7, 15, v225
    v_lshlrev_b32 v7, 3, v7
    s_lshl_b32 s48, s2, 7
    s_mov_b32 s60, 0x8000
    s_sub_u32 s61, s86, 4000
L_f_go:
    buffer_load_dwordx2 v[8:9], v7, s[28:31], s48 offen sc1
    s_waitcnt vmcnt(0)
    v_xor_b32 v9, v8, v9
    v_cmp_eq_u32 vcc, 0x3c96e5a1, v9
    v_subrev_u32 v8, s61, v8
    s_nop 0
    s_mov_b64 s[62:63], vcc
    v_cmp_gt_u32 vcc, 0x40000000, v8
    s_nop 1
    s_and_b64 vcc, vcc, s[62:63]
    s_cmp_eq_u64 vcc, exec
    s_cbranch_scc1 L_f_go_ok
    s_sleep 3
    s_sub_u32 s60, s60, 1
    s_cmp_lg_u32 s60, 0
    s_cbranch_scc1 L_f_go
L_f_go_ok:
    s_barrier
    v_mov_b32 v0, v210
    s_load_dwordx2 s[4:5], s[0:1], 112
    s_load_dwordx2 s[12:13], s[0:1], 0
    s_load_dwordx4 s[40:43], s[0:1], 56
    s_and_b32 s14, s2, 7
    s_lshr_b32 s15, s2, 3
    s_and_b32 s6, s15, 7
    s_lshr_b32 s7, s15, 3
    s_lshl_b32 s14, s14, 2
    s_add_u32 s7, s7, s14
    s_waitcnt lgkmcnt(0)
    s_add_u32 s8, s4, 58785792
    s_addc_u32 s9, s5, 0
    s_mov_b32 s10, 8192
    s_mov_b32 s11, 0x00020000
    s_mov_b32 s16, s12
    s_mov_b32 s17, s13
    s_mov_b32 s18, 4194304
    s_mov_b32 s19, 0x00020000
    s_add_u32 s20, s4, 4194304
    s_addc_u32 s21, s5, 0
    s_mov_b32 s22, 4194304
    s_mov_b32 s23, 0x00020000
    s_add_u32 s24, s4, 33554432
    s_addc_u32 s25, s5, 0
    s_mov_b32 s26, 49152
    s_mov_b32 s27, 0x00020000
    s_lshl_b32 s14, s2, 14
    v_lshlrev_b32 v1, 6, v0
    buffer_load_dwordx4 v[8:11], v1, s[20:23], s14 offen offset:0 sc1
    buffer_load_dwordx4 v[12:15], v1, s[20:23], s14 offen offset:16 sc1
    buffer_load_dwordx4 v[16:19], v1, s[20:23], s14 offen offset:32 sc1
    buffer_load_dwordx4 v[20:23], v1, s[20:23], s14 offen offset:48 sc1
    v_lshlrev_b32 v2, 3, v0
    s_add_u32 s44, s14, 0
    s_add_u32 s45, s14, 2048
    s_add_u32 s46, s14, 4096
    s_add_u32 s47, s14, 6144
    s_add_u32 s48, s14, 8192
    s_add_u32 s49, s14, 10240
    s_add_u32 s50, s14, 12288
    s_add_u32 s51, s14, 14336
    v_lshlrev_b32 v3, 4, v0
    s_mov_b32 s52, 0
    buffer_load_dwordx4 v[40:43], v3, s[24:27], s52 offen sc1
    s_mov_b32 s53, 24576
    buffer_load_dwordx4 v[200:203], v3, s[24:27], s53 offen sc1
    s_mov_b32 s52, 4096
    buffer_load_dwordx4 v[44:47], v3, s[24:27], s52 offen sc1
    s_mov_b32 s53, 28672
    buffer_load_dwordx4 v[204:207], v3, s[24:27], s53 offen sc1
    s_mov_b32 s52, 8192
    buffer_load_dwordx4 v[48:51], v3, s[24:27], s52 offen sc1
    s_mov_b32 s53, 32768
    buffer_load_dwordx4 v[208:211], v3, s[24:27], s53 offen sc1
    s_mov_b32 s52, 12288
    buffer_load_dwordx4 v[52:55], v3, s[24:27], s52 offen sc1
    s_mov_b32 s53, 36864
    buffer_load_dwordx4 v[212:215], v3, s[24:27], s53 offen sc1
    s_mov_b32 s52, 16384
    buffer_load_dwordx4 v[56:59], v3, s[24:27], s52 offen sc1
    s_mov_b32 s53, 40960
    buffer_load_dwordx4 v[216:219], v3, s[24:27], s53 offen sc1
    s_cmp_ge_u32 s3, 2
    s_cselect_b32 s28, s42, s40
    s_cselect_b32 s29, s43, s41
    s_mov_b32 s30, 7340032
    s_mov_b32 s31, 0x00020000
    s_lshl_b32 s32, s3, 12
    s_lshr_b32 s33, s3, 1
    s_mul_i32 s33, s33, 7296
    s_and_b32 s14, s3, 1
    s_mul_i32 s14, s14, 3072
    s_add_u32 s33, s33, s14
    s_add_u32 s33, s33, 16384
    s_mov_b32 s34, 0
    s_mul_i32 s35, s7, 224
    s_lshl_b32 s14, s6, 6
    s_and_b32 s15, s3, 1
    s_lshl_b32 s15, s15, 5
    s_add_u32 s14, s14, s15
    s_mul_i32 s14, s14, 7168
    s_mul_i32 s15, s7, 224
    s_add_u32 s14, s14, s15
    v_lshrrev_b32 v236, 1, v225
    v_mul_u32_u24 v236, 7168, v236
    v_and_b32 v237, 1, v225
    v_lshlrev_b32 v237, 7, v237
    v_add_u32 v231, v236, v237
    v_add_u32 v231, s14, v231
    v_and_b32 v236, 31, v225
    v_mul_u32_u24 v236, 7168, v236
    v_add_u32 v254, s14, v236
    v_add_u32 v254, 223, v254
    s_add_u32 s16, s4, 8388608
    s_addc_u32 s17, s5, 0
    s_mov_b32 s18, 4194304
    s_mov_b32 s19, 0x00020000
    s_add_u32 s20, s4, 12582912
    s_addc_u32 s21, s5, 0
    s_mov_b32 s22, 4194304
    s_mov_b32 s23, 0x00020000
    s_waitcnt vmcnt(0)
    s_mov_b32 s54, 0x20000
L_b_modchk:
    v_max3_u32 v112, v40, v41, v42
    v_max3_u32 v112, v112, v43, v44
    v_max3_u32 v112, v112, v45, v46
    v_max3_u32 v112, v112, v47, v48
    v_max3_u32 v112, v112, v49, v50
    v_max3_u32 v112, v112, v51, v52
    v_max3_u32 v112, v112, v53, v54
    v_max3_u32 v112, v112, v55, v56
    v_max3_u32 v112, v112, v57, v58
    v_max3_u32 v112, v112, v59, v200
    v_max3_u32 v112, v112, v201, v202
    v_max3_u32 v112, v112, v203, v204
    v_max3_u32 v112, v112, v205, v206
    v_max3_u32 v112, v112, v207, v208
    v_max3_u32 v112, v112, v209, v210
    v_max3_u32 v112, v112, v211, v212
    v_max3_u32 v112, v112, v213, v214
    v_max3_u32 v112, v112, v215, v216
    v_max3_u32 v112, v112, v217, v218
    v_max_u32 v112, v112, v219
    v_cmp_eq_u32 vcc, -1, v112
    s_nop 1
    s_cmp_eq_u64 vcc, 0
    s_cbranch_scc1 L_b_modok
    s_mov_b32 s52, 0
    buffer_load_dwordx4 v[40:43], v3, s[24:27], s52 offen sc1
    s_mov_b32 s53, 24576
    buffer_load_dwordx4 v[200:203], v3, s[24:27], s53 offen sc1
    s_mov_b32 s52, 4096
    buffer_load_dwordx4 v[44:47], v3, s[24:27], s52 offen sc1
    s_mov_b32 s53, 28672
    buffer_load_dwordx4 v[204:207], v3, s[24:27], s53 offen sc1
    s_mov_b32 s52, 8192
    buffer_load_dwordx4 v[48:51], v3, s[24:27], s52 offen sc1
    s_mov_b32 s53, 32768
    buffer_load_dwordx4 v[208:211], v3, s[24:27], s53 offen sc1
    s_mov_b32 s52, 12288
    buffer_load_dwordx4 v[52:55], v3, s[24:27], s52 offen sc1
    s_mov_b32 s53, 36864
    buffer_load_dwordx4 v[212:215], v3, s[24:27], s53 offen sc1
    s_mov_b32 s52, 16384
    buffer_load_dwordx4 v[56:59], v3, s[24:27], s52 offen sc1
    s_mov_b32 s53, 40960
    buffer_load_dwordx4 v[216:219], v3, s[24:27], s53 offen sc1
    s_waitcnt vmcnt(0)
    s_sub_u32 s54, s54, 1
    s_cmp_lg_u32 s54, 0
    s_cbranch_scc1 L_b_modchk
L_b_modok:
    v_add_f32 v40, v40, v200
    v_add_f32 v41, v41, v201
    v_cvt_pk_bf16_f32 v112, v40, v41
    v_lshlrev_b32 v40, 16, v112
    v_and_b32 v41, 0xffff0000, v112
    v_add_f32 v42, v42, v202
    v_add_f32 v43, v43, v203
    v_cvt_pk_bf16_f32 v112, v42, v43
    v_lshlrev_b32 v42, 16, v112
    v_and_b32 v43, 0xffff0000, v112
    v_add_f32 v44, v44, v204
    v_add_f32 v45, v45, v205
    v_cvt_pk_bf16_f32 v112, v44, v45
    v_lshlrev_b32 v44, 16, v112
    v_and_b32 v45, 0xffff0000, v112
    v_add_f32 v46, v46, v206
    v_add_f32 v47, v47, v207
    v_cvt_pk_bf16_f32 v112, v46, v47
    v_lshlrev_b32 v46, 16, v112
    v_and_b32 v47, 0xffff0000, v112
    v_add_f32 v48, v48, v208
    v_add_f32 v49, v49, v209
    v_cvt_pk_bf16_f32 v112, v48, v49
    v_lshlrev_b32 v48, 16, v112
    v_and_b32 v49, 0xffff0000, v112
    v_add_f32 v50, v50, v210
    v_add_f32 v51, v51, v211
    v_cvt_pk_bf16_f32 v112, v50, v51
    v_lshlrev_b32 v50, 16, v112
    v_and_b32 v51, 0xffff0000, v112
    v_add_f32 v52, v52, v212
    v_add_f32 v53, v53, v213
    v_cvt_pk_bf16_f32 v112, v52, v53
    v_lshlrev_b32 v52, 16, v112
    v_and_b32 v53, 0xffff0000, v112
    v_add_f32 v54, v54, v214
    v_add_f32 v55, v55, v215
    v_cvt_pk_bf16_f32 v112, v54, v55
    v_lshlrev_b32 v54, 16, v112
    v_and_b32 v55, 0xffff0000, v112
    v_add_f32 v56, v56, v216
    v_add_f32 v57, v57, v217
    v_cvt_pk_bf16_f32 v112, v56, v57
    v_lshlrev_b32 v56, 16, v112
    v_and_b32 v57, 0xffff0000, v112
    v_add_f32 v58, v58, v218
    v_add_f32 v59, v59, v219
    v_cvt_pk_bf16_f32 v112, v58, v59
    v_lshlrev_b32 v58, 16, v112
    v_and_b32 v59, 0xffff0000, v112
    v_add_f32 v44, 1.0, v44
    v_add_f32 v45, 1.0, v45
    v_cvt_pk_bf16_f32 v112, v44, v45
    v_lshlrev_b32 v44, 16, v112
    v_and_b32 v45, 0xffff0000, v112
    v_add_f32 v46, 1.0, v46
    v_add_f32 v47, 1.0, v47
    v_cvt_pk_bf16_f32 v112, v46, v47
    v_lshlrev_b32 v46, 16, v112
    v_and_b32 v47, 0xffff0000, v112
    v_add_f32 v56, 1.0, v56
    v_add_f32 v57, 1.0, v57
    v_cvt_pk_bf16_f32 v112, v56, v57
    v_lshlrev_b32 v56, 16, v112
    v_and_b32 v57, 0xffff0000, v112
    v_add_f32 v58, 1.0, v58
    v_add_f32 v59, 1.0, v59
    v_cvt_pk_bf16_f32 v112, v58, v59
    v_lshlrev_b32 v58, 16, v112
    v_and_b32 v59, 0xffff0000, v112
    v_lshlrev_b32 v114, 16, v8
    v_fma_f32 v112, v120, v44, v40
    v_mul_f32 v112, v112, v114
    v_fma_f32 v120, v112, v48, v64
    v_lshlrev_b32 v115, 16, v12
    v_fma_f32 v113, v121, v45, v41
    v_mul_f32 v113, v113, v115
    v_fma_f32 v121, v113, v49, v65
    v_lshlrev_b32 v114, 16, v16
    v_fma_f32 v112, v122, v46, v42
    v_mul_f32 v112, v112, v114
    v_fma_f32 v122, v112, v50, v66
    v_lshlrev_b32 v115, 16, v20
    v_fma_f32 v113, v123, v47, v43
    v_mul_f32 v113, v113, v115
    v_fma_f32 v123, v113, v51, v67
    v_cvt_pk_bf16_f32 v160, v120, v121
    v_cvt_pk_bf16_f32 v161, v122, v123
    v_lshlrev_b32 v120, 16, v160
    v_and_b32 v121, 0xffff0000, v160
    v_lshlrev_b32 v122, 16, v161
    v_and_b32 v123, 0xffff0000, v161
    v_and_b32 v114, 0xffff0000, v8
    v_fma_f32 v112, v124, v44, v40
    v_mul_f32 v112, v112, v114
    v_fma_f32 v124, v112, v48, v68
    v_and_b32 v115, 0xffff0000, v12
    v_fma_f32 v113, v125, v45, v41
    v_mul_f32 v113, v113, v115
    v_fma_f32 v125, v113, v49, v69
    v_and_b32 v114, 0xffff0000, v16
    v_fma_f32 v112, v126, v46, v42
    v_mul_f32 v112, v112, v114
    v_fma_f32 v126, v112, v50, v70
    v_and_b32 v115, 0xffff0000, v20
    v_fma_f32 v113, v127, v47, v43
    v_mul_f32 v113, v113, v115
    v_fma_f32 v127, v113, v51, v71
    v_cvt_pk_bf16_f32 v162, v124, v125
    v_cvt_pk_bf16_f32 v163, v126, v127
    v_lshlrev_b32 v124, 16, v162
    v_and_b32 v125, 0xffff0000, v162
    v_lshlrev_b32 v126, 16, v163
    v_and_b32 v127, 0xffff0000, v163
    v_lshlrev_b32 v114, 16, v9
    v_fma_f32 v112, v128, v44, v40
    v_mul_f32 v112, v112, v114
    v_fma_f32 v128, v112, v48, v72
    v_lshlrev_b32 v115, 16, v13
    v_fma_f32 v113, v129, v45, v41
    v_mul_f32 v113, v113, v115
    v_fma_f32 v129, v113, v49, v73
    v_lshlrev_b32 v114, 16, v17
    v_fma_f32 v112, v130, v46, v42
    v_mul_f32 v112, v112, v114
    v_fma_f32 v130, v112, v50, v74
    v_lshlrev_b32 v115, 16, v21
    v_fma_f32 v113, v131, v47, v43
    v_mul_f32 v113, v113, v115
    v_fma_f32 v131, v113, v51, v75
    v_cvt_pk_bf16_f32 v164, v128, v129
    v_cvt_pk_bf16_f32 v165, v130, v131
    v_lshlrev_b32 v128, 16, v164
    v_and_b32 v129, 0xffff0000, v164
    v_lshlrev_b32 v130, 16, v165
    v_and_b32 v131, 0xffff0000, v165
    v_and_b32 v114, 0xffff0000, v9
    v_fma_f32 v112, v132, v44, v40
    v_mul_f32 v112, v112, v114
    v_fma_f32 v132, v112, v48, v76
    v_and_b32 v115, 0xffff0000, v13
    v_fma_f32 v113, v133, v45, v41
    v_mul_f32 v113, v113, v115
    v_fma_f32 v133, v113, v49, v77
    v_and_b32 v114, 0xffff0000, v17
    v_fma_f32 v112, v134, v46, v42
    v_mul_f32 v112, v112, v114
    v_fma_f32 v134, v112, v50, v78
    v_and_b32 v115, 0xffff0000, v21
    v_fma_f32 v113, v135, v47, v43
    v_mul_f32 v113, v113, v115
    v_fma_f32 v135, v113, v51, v79
    v_cvt_pk_bf16_f32 v166, v132, v133
    v_cvt_pk_bf16_f32 v167, v134, v135
    v_lshlrev_b32 v132, 16, v166
    v_and_b32 v133, 0xffff0000, v166
    v_lshlrev_b32 v134, 16, v167
    v_and_b32 v135, 0xffff0000, v167
    v_lshlrev_b32 v114, 16, v10
    v_fma_f32 v112, v136, v44, v40
    v_mul_f32 v112, v112, v114
    v_fma_f32 v136, v112, v48, v80
    v_lshlrev_b32 v115, 16, v14
    v_fma_f32 v113, v137, v45, v41
    v_mul_f32 v113, v113, v115
    v_fma_f32 v137, v113, v49, v81
    v_lshlrev_b32 v114, 16, v18
    v_fma_f32 v112, v138, v46, v42
    v_mul_f32 v112, v112, v114
    v_fma_f32 v138, v112, v50, v82
    v_lshlrev_b32 v115, 16, v22
    v_fma_f32 v113, v139, v47, v43
    v_mul_f32 v113, v113, v115
    v_fma_f32 v139, v113, v51, v83
    v_cvt_pk_bf16_f32 v168, v136, v137
    v_cvt_pk_bf16_f32 v169, v138, v139
    v_lshlrev_b32 v136, 16, v168
    v_and_b32 v137, 0xffff0000, v168
    v_lshlrev_b32 v138, 16, v169
    v_and_b32 v139, 0xffff0000, v169
    v_and_b32 v114, 0xffff0000, v10
    v_fma_f32 v112, v140, v44, v40
    v_mul_f32 v112, v112, v114
    v_fma_f32 v140, v112, v48, v84
    v_and_b32 v115, 0xffff0000, v14
    v_fma_f32 v113, v141, v45, v41
    v_mul_f32 v113, v113, v115
    v_fma_f32 v141, v113, v49, v85
    v_and_b32 v114, 0xffff0000, v18
    v_fma_f32 v112, v142, v46, v42
    v_mul_f32 v112, v112, v114
    v_fma_f32 v142, v112, v50, v86
    v_and_b32 v115, 0xffff0000, v22
    v_fma_f32 v113, v143, v47, v43
    v_mul_f32 v113, v113, v115
    v_fma_f32 v143, v113, v51, v87
    v_cvt_pk_bf16_f32 v170, v140, v141
    v_cvt_pk_bf16_f32 v171, v142, v143
    v_lshlrev_b32 v140, 16, v170
    v_and_b32 v141, 0xffff0000, v170
    v_lshlrev_b32 v142, 16, v171
    v_and_b32 v143, 0xffff0000, v171
    v_lshlrev_b32 v114, 16, v11
    v_fma_f32 v112, v144, v44, v40
    v_mul_f32 v112, v112, v114
    v_fma_f32 v144, v112, v48, v88
    v_lshlrev_b32 v115, 16, v15
    v_fma_f32 v113, v145, v45, v41
    v_mul_f32 v113, v113, v115
    v_fma_f32 v145, v113, v49, v89
    v_lshlrev_b32 v114, 16, v19
    v_fma_f32 v112, v146, v46, v42
    v_mul_f32 v112, v112, v114
    v_fma_f32 v146, v112, v50, v90
    v_lshlrev_b32 v115, 16, v23
    v_fma_f32 v113, v147, v47, v43
    v_mul_f32 v113, v113, v115
    v_fma_f32 v147, v113, v51, v91
    v_cvt_pk_bf16_f32 v172, v144, v145
    v_cvt_pk_bf16_f32 v173, v146, v147
    v_lshlrev_b32 v144, 16, v172
    v_and_b32 v145, 0xffff0000, v172
    v_lshlrev_b32 v146, 16, v173
    v_and_b32 v147, 0xffff0000, v173
    v_and_b32 v114, 0xffff0000, v11
    v_fma_f32 v112, v148, v44, v40
    v_mul_f32 v112, v112, v114
    v_fma_f32 v148, v112, v48, v92
    v_and_b32 v115, 0xffff0000, v15
    v_fma_f32 v113, v149, v45, v41
    v_mul_f32 v113, v113, v115
    v_fma_f32 v149, v113, v49, v93
    v_and_b32 v114, 0xffff0000, v19
    v_fma_f32 v112, v150, v46, v42
    v_mul_f32 v112, v112, v114
    v_fma_f32 v150, v112, v50, v94
    v_and_b32 v115, 0xffff0000, v23
    v_fma_f32 v113, v151, v47, v43
    v_mul_f32 v113, v113, v115
    v_fma_f32 v151, v113, v51, v95
    v_cvt_pk_bf16_f32 v174, v148, v149
    v_cvt_pk_bf16_f32 v175, v150, v151
    v_lshlrev_b32 v148, 16, v174
    v_and_b32 v149, 0xffff0000, v174
    v_lshlrev_b32 v150, 16, v175
    v_and_b32 v151, 0xffff0000, v175
    v_and_b32 v116, 1, v225
    v_cmp_eq_u32 vcc, 1, v116
    s_nop 1
    v_cndmask_b32 v208, v160, v168, vcc
    v_cndmask_b32 v210, v168, v160, vcc
    s_nop 1
    v_mov_b32_dpp v212, v210 quad_perm:[1,0,3,2] row_mask:0xf bank_mask:0xf
    v_cndmask_b32 v192, v208, v212, vcc
    v_cndmask_b32 v194, v212, v208, vcc
    v_cndmask_b32 v209, v161, v169, vcc
    v_cndmask_b32 v211, v169, v161, vcc
    s_nop 1
    v_mov_b32_dpp v213, v211 quad_perm:[1,0,3,2] row_mask:0xf bank_mask:0xf
    v_cndmask_b32 v193, v209, v213, vcc
    v_cndmask_b32 v195, v213, v209, vcc
    v_cndmask_b32 v208, v162, v170, vcc
    v_cndmask_b32 v210, v170, v162, vcc
    s_nop 1
    v_mov_b32_dpp v212, v210 quad_perm:[1,0,3,2] row_mask:0xf bank_mask:0xf
    v_cndmask_b32 v196, v208, v212, vcc
    v_cndmask_b32 v198, v212, v208, vcc
    v_cndmask_b32 v209, v163, v171, vcc
    v_cndmask_b32 v211, v171, v163, vcc
    s_nop 1
    v_mov_b32_dpp v213, v211 quad_perm:[1,0,3,2] row_mask:0xf bank_mask:0xf
    v_cndmask_b32 v197, v209, v213, vcc
    v_cndmask_b32 v199, v213, v209, vcc
    v_cndmask_b32 v208, v164, v172, vcc
    v_cndmask_b32 v210, v172, v164, vcc
    s_nop 1
    v_mov_b32_dpp v212, v210 quad_perm:[1,0,3,2] row_mask:0xf bank_mask:0xf
    v_cndmask_b32 v200, v208, v212, vcc
    v_cndmask_b32 v202, v212, v208, vcc
    v_cndmask_b32 v209, v165, v173, vcc
    v_cndmask_b32 v211, v173, v165, vcc
    s_nop 1
    v_mov_b32_dpp v213, v211 quad_perm:[1,0,3,2] row_mask:0xf bank_mask:0xf
    v_cndmask_b32 v201, v209, v213, vcc
    v_cndmask_b32 v203, v213, v209, vcc
    v_cndmask_b32 v208, v166, v174, vcc
    v_cndmask_b32 v210, v174, v166, vcc
    s_nop 1
    v_mov_b32_dpp v212, v210 quad_perm:[1,0,3,2] row_mask:0xf bank_mask:0xf
    v_cndmask_b32 v204, v208, v212, vcc
    v_cndmask_b32 v206, v212, v208, vcc
    v_cndmask_b32 v209, v167, v175, vcc
    v_cndmask_b32 v211, v175, v167, vcc
    s_nop 1
    v_mov_b32_dpp v213, v211 quad_perm:[1,0,3,2] row_mask:0xf bank_mask:0xf
    v_cndmask_b32 v205, v209, v213, vcc
    v_cndmask_b32 v207, v213, v209, vcc
    v_lshrrev_b32 v117, 1, v0
    v_lshlrev_b32 v117, 4, v117
    v_lshlrev_b32 v116, 13, v116
    v_add_u32 v117, v117, v116
    buffer_store_dwordx4 v[192:195], v117, s[16:19], s44 offen sc1
    buffer_store_dwordx4 v[196:199], v117, s[16:19], s45 offen sc1
    buffer_store_dwordx4 v[200:203], v117, s[16:19], s46 offen sc1
    buffer_store_dwordx4 v[204:207], v117, s[16:19], s47 offen sc1
    v_add_f32 v96, v120, v121
    v_mul_f32 v104, v120, v120
    v_add_f32 v97, v124, v125
    v_mul_f32 v105, v124, v124
    v_add_f32 v98, v128, v129
    v_mul_f32 v106, v128, v128
    v_add_f32 v99, v132, v133
    v_mul_f32 v107, v132, v132
    v_add_f32 v100, v136, v137
    v_mul_f32 v108, v136, v136
    v_add_f32 v101, v140, v141
    v_mul_f32 v109, v140, v140
    v_add_f32 v102, v144, v145
    v_mul_f32 v110, v144, v144
    v_add_f32 v103, v148, v149
    v_mul_f32 v111, v148, v148
    v_add_f32 v96, v96, v122
    v_fmac_f32 v104, v121, v121
    v_add_f32 v97, v97, v126
    v_fmac_f32 v105, v125, v125
    v_add_f32 v98, v98, v130
    v_fmac_f32 v106, v129, v129
    v_add_f32 v99, v99, v134
    v_fmac_f32 v107, v133, v133
    v_add_f32 v100, v100, v138
    v_fmac_f32 v108, v137, v137
    v_add_f32 v101, v101, v142
    v_fmac_f32 v109, v141, v141
    v_add_f32 v102, v102, v146
    v_fmac_f32 v110, v145, v145
    v_add_f32 v103, v103, v150
    v_fmac_f32 v111, v149, v149
    v_add_f32 v96, v96, v123
    v_fmac_f32 v104, v122, v122
    v_add_f32 v97, v97, v127
    v_fmac_f32 v105, v126, v126
    v_add_f32 v98, v98, v131
    v_fmac_f32 v106, v130, v130
    v_add_f32 v99, v99, v135
    v_fmac_f32 v107, v134, v134
    v_add_f32 v100, v100, v139
    v_fmac_f32 v108, v138, v138
    v_add_f32 v101, v101, v143
    v_fmac_f32 v109, v142, v142
    v_add_f32 v102, v102, v147
    v_fmac_f32 v110, v146, v146
    v_add_f32 v103, v103, v151
    v_fmac_f32 v111, v150, v150
    v_fmac_f32 v104, v123, v123
    v_fmac_f32 v105, v127, v127
    v_fmac_f32 v106, v131, v131
    v_fmac_f32 v107, v135, v135
    v_fmac_f32 v108, v139, v139
    v_fmac_f32 v109, v143, v143
    v_fmac_f32 v110, v147, v147
    v_fmac_f32 v111, v151, v151
    v_add_f32_dpp v96, v96, v96 row_shr:1 row_mask:0xf bank_mask:0xf
    v_add_f32_dpp v97, v97, v97 row_shr:1 row_mask:0xf bank_mask:0xf
    v_add_f32_dpp v98, v98, v98 row_shr:1 row_mask:0xf bank_mask:0xf
    v_add_f32_dpp v99, v99, v99 row_shr:1 row_mask:0xf bank_mask:0xf
    v_add_f32_dpp v100, v100, v100 row_shr:1 row_mask:0xf bank_mask:0xf
    v_add_f32_dpp v101, v101, v101 row_shr:1 row_mask:0xf bank_mask:0xf
    v_add_f32_dpp v102, v102, v102 row_shr:1 row_mask:0xf bank_mask:0xf
    v_add_f32_dpp v103, v103, v103 row_shr:1 row_mask:0xf bank_mask:0xf
    v_add_f32_dpp v104, v104, v104 row_shr:1 row_mask:0xf bank_mask:0xf
    v_add_f32_dpp v105, v105, v105 row_shr:1 row_mask:0xf bank_mask:0xf
    v_add_f32_dpp v106, v106, v106 row_shr:1 row_mask:0xf bank_mask:0xf
    v_add_f32_dpp v107, v107, v107 row_shr:1 row_mask:0xf bank_mask:0xf
    v_add_f32_dpp v108, v108, v108 row_shr:1 row_mask:0xf bank_mask:0xf
    v_add_f32_dpp v109, v109, v109 row_shr:1 row_mask:0xf bank_mask:0xf
    v_add_f32_dpp v110, v110, v110 row_shr:1 row_mask:0xf bank_mask:0xf
    v_add_f32_dpp v111, v111, v111 row_shr:1 row_mask:0xf bank_mask:0xf
    v_add_f32_dpp v96, v96, v96 row_shr:2 row_mask:0xf bank_mask:0xf
    v_add_f32_dpp v97, v97, v97 row_shr:2 row_mask:0xf bank_mask:0xf
    v_add_f32_dpp v98, v98, v98 row_shr:2 row_mask:0xf bank_mask:0xf
    v_add_f32_dpp v99, v99, v99 row_shr:2 row_mask:0xf bank_mask:0xf
    v_add_f32_dpp v100, v100, v100 row_shr:2 row_mask:0xf bank_mask:0xf
    v_add_f32_dpp v101, v101, v101 row_shr:2 row_mask:0xf bank_mask:0xf
    v_add_f32_dpp v102, v102, v102 row_shr:2 row_mask:0xf bank_mask:0xf
    v_add_f32_dpp v103, v103, v103 row_shr:2 row_mask:0xf bank_mask:0xf
    v_add_f32_dpp v104, v104, v104 row_shr:2 row_mask:0xf bank_mask:0xf
    v_add_f32_dpp v105, v105, v105 row_shr:2 row_mask:0xf bank_mask:0xf
    v_add_f32_dpp v106, v106, v106 row_shr:2 row_mask:0xf bank_mask:0xf
    v_add_f32_dpp v107, v107, v107 row_shr:2 row_mask:0xf bank_mask:0xf
    v_add_f32_dpp v108, v108, v108 row_shr:2 row_mask:0xf bank_mask:0xf
    v_add_f32_dpp v109, v109, v109 row_shr:2 row_mask:0xf bank_mask:0xf
    v_add_f32_dpp v110, v110, v110 row_shr:2 row_mask:0xf bank_mask:0xf
    v_add_f32_dpp v111, v111, v111 row_shr:2 row_mask:0xf bank_mask:0xf
    v_add_f32_dpp v96, v96, v96 row_shr:4 row_mask:0xf bank_mask:0xf
    v_add_f32_dpp v97, v97, v97 row_shr:4 row_mask:0xf bank_mask:0xf
    v_add_f32_dpp v98, v98, v98 row_shr:4 row_mask:0xf bank_mask:0xf
    v_add_f32_dpp v99, v99, v99 row_shr:4 row_mask:0xf bank_mask:0xf
    v_add_f32_dpp v100, v100, v100 row_shr:4 row_mask:0xf bank_mask:0xf
    v_add_f32_dpp v101, v101, v101 row_shr:4 row_mask:0xf bank_mask:0xf
    v_add_f32_dpp v102, v102, v102 row_shr:4 row_mask:0xf bank_mask:0xf
    v_add_f32_dpp v103, v103, v103 row_shr:4 row_mask:0xf bank_mask:0xf
    v_add_f32_dpp v104, v104, v104 row_shr:4 row_mask:0xf bank_mask:0xf
    v_add_f32_dpp v105, v105, v105 row_shr:4 row_mask:0xf bank_mask:0xf
    v_add_f32_dpp v106, v106, v106 row_shr:4 row_mask:0xf bank_mask:0xf
    v_add_f32_dpp v107, v107, v107 row_shr:4 row_mask:0xf bank_mask:0xf
    v_add_f32_dpp v108, v108, v108 row_shr:4 row_mask:0xf bank_mask:0xf
    v_add_f32_dpp v109, v109, v109 row_shr:4 row_mask:0xf bank_mask:0xf
    v_add_f32_dpp v110, v110, v110 row_shr:4 row_mask:0xf bank_mask:0xf
    v_add_f32_dpp v111, v111, v111 row_shr:4 row_mask:0xf bank_mask:0xf
    v_add_f32_dpp v96, v96, v96 row_shr:8 row_mask:0xf bank_mask:0xf
    v_add_f32_dpp v97, v97, v97 row_shr:8 row_mask:0xf bank_mask:0xf
    v_add_f32_dpp v98, v98, v98 row_shr:8 row_mask:0xf bank_mask:0xf
    v_add_f32_dpp v99, v99, v99 row_shr:8 row_mask:0xf bank_mask:0xf
    v_add_f32_dpp v100, v100, v100 row_shr:8 row_mask:0xf bank_mask:0xf
    v_add_f32_dpp v101, v101, v101 row_shr:8 row_mask:0xf bank_mask:0xf
    v_add_f32_dpp v102, v102, v102 row_shr:8 row_mask:0xf bank_mask:0xf
    v_add_f32_dpp v103, v103, v103 row_shr:8 row_mask:0xf bank_mask:0xf
    v_add_f32_dpp v104, v104, v104 row_shr:8 row_mask:0xf bank_mask:0xf
    v_add_f32_dpp v105, v105, v105 row_shr:8 row_mask:0xf bank_mask:0xf
    v_add_f32_dpp v106, v106, v106 row_shr:8 row_mask:0xf bank_mask:0xf
    v_add_f32_dpp v107, v107, v107 row_shr:8 row_mask:0xf bank_mask:0xf
    v_add_f32_dpp v108, v108, v108 row_shr:8 row_mask:0xf bank_mask:0xf
    v_add_f32_dpp v109, v109, v109 row_shr:8 row_mask:0xf bank_mask:0xf
    v_add_f32_dpp v110, v110, v110 row_shr:8 row_mask:0xf bank_mask:0xf
    v_add_f32_dpp v111, v111, v111 row_shr:8 row_mask:0xf bank_mask:0xf
    v_add_f32_dpp v96, v96, v96 row_bcast:15 row_mask:0xa bank_mask:0xf
    v_add_f32_dpp v97, v97, v97 row_bcast:15 row_mask:0xa bank_mask:0xf
    v_add_f32_dpp v98, v98, v98 row_bcast:15 row_mask:0xa bank_mask:0xf
    v_add_f32_dpp v99, v99, v99 row_bcast:15 row_mask:0xa bank_mask:0xf
    v_add_f32_dpp v100, v100, v100 row_bcast:15 row_mask:0xa bank_mask:0xf
    v_add_f32_dpp v101, v101, v101 row_bcast:15 row_mask:0xa bank_mask:0xf
    v_add_f32_dpp v102, v102, v102 row_bcast:15 row_mask:0xa bank_mask:0xf
    v_add_f32_dpp v103, v103, v103 row_bcast:15 row_mask:0xa bank_mask:0xf
    v_add_f32_dpp v104, v104, v104 row_bcast:15 row_mask:0xa bank_mask:0xf
    v_add_f32_dpp v105, v105, v105 row_bcast:15 row_mask:0xa bank_mask:0xf
    v_add_f32_dpp v106, v106, v106 row_bcast:15 row_mask:0xa bank_mask:0xf
    v_add_f32_dpp v107, v107, v107 row_bcast:15 row_mask:0xa bank_mask:0xf
    v_add_f32_dpp v108, v108, v108 row_bcast:15 row_mask:0xa bank_mask:0xf
    v_add_f32_dpp v109, v109, v109 row_bcast:15 row_mask:0xa bank_mask:0xf
    v_add_f32_dpp v110, v110, v110 row_bcast:15 row_mask:0xa bank_mask:0xf
    v_add_f32_dpp v111, v111, v111 row_bcast:15 row_mask:0xa bank_mask:0xf
    v_add_f32_dpp v96, v96, v96 row_bcast:31 row_mask:0xc bank_mask:0xf
    v_add_f32_dpp v97, v97, v97 row_bcast:31 row_mask:0xc bank_mask:0xf
    v_add_f32_dpp v98, v98, v98 row_bcast:31 row_mask:0xc bank_mask:0xf
    v_add_f32_dpp v99, v99, v99 row_bcast:31 row_mask:0xc bank_mask:0xf
    v_add_f32_dpp v100, v100, v100 row_bcast:31 row_mask:0xc bank_mask:0xf
    v_add_f32_dpp v101, v101, v101 row_bcast:31 row_mask:0xc bank_mask:0xf
    v_add_f32_dpp v102, v102, v102 row_bcast:31 row_mask:0xc bank_mask:0xf
    v_add_f32_dpp v103, v103, v103 row_bcast:31 row_mask:0xc bank_mask:0xf
    v_add_f32_dpp v104, v104, v104 row_bcast:31 row_mask:0xc bank_mask:0xf
    v_add_f32_dpp v105, v105, v105 row_bcast:31 row_mask:0xc bank_mask:0xf
    v_add_f32_dpp v106, v106, v106 row_bcast:31 row_mask:0xc bank_mask:0xf
    v_add_f32_dpp v107, v107, v107 row_bcast:31 row_mask:0xc bank_mask:0xf
    v_add_f32_dpp v108, v108, v108 row_bcast:31 row_mask:0xc bank_mask:0xf
    v_add_f32_dpp v109, v109, v109 row_bcast:31 row_mask:0xc bank_mask:0xf
    v_add_f32_dpp v110, v110, v110 row_bcast:31 row_mask:0xc bank_mask:0xf
    v_add_f32_dpp v111, v111, v111 row_bcast:31 row_mask:0xc bank_mask:0xf
    s_lshl_b32 s14, s3, 6
    s_add_u32 s14, s14, 123648
    v_mov_b32 v112, s14
    v_cmp_eq_u32 vcc, 63, v225
    s_nop 1
    s_and_saveexec_b64 s[76:77], vcc
    ds_write_b128 v112, v[96:99] offset:0
    ds_write_b128 v112, v[100:103] offset:16
    ds_write_b128 v112, v[104:107] offset:32
    ds_write_b128 v112, v[108:111] offset:48
    s_mov_b64 exec, s[76:77]
    s_waitcnt lgkmcnt(0)
    s_barrier
    v_and_b32 v112, 15, v225
    v_lshlrev_b32 v112, 2, v112
    v_add_u32 v112, 123648, v112
    ds_read_b32 v113, v112 offset:0
    ds_read_b32 v114, v112 offset:64
    ds_read_b32 v115, v112 offset:128
    ds_read_b32 v116, v112 offset:192
    s_waitcnt lgkmcnt(0)
    v_add_f32 v113, v113, v114
    v_add_f32 v115, v115, v116
    v_add_f32 v113, v113, v115
    s_nop 1
    v_mov_b32_dpp v114, v113 row_ror:8 row_mask:0xf bank_mask:0xf
    v_mul_f32 v113, 0x3a800000, v113
    v_mul_f32 v114, 0x3a800000, v114
    v_fma_f32 v114, -v113, v113, v114
    v_max_f32 v114, 0, v114
    v_add_f32 v114, 0x3727c5ac, v114
    v_rsq_f32 v114, v114
    v_readlane_b32 s60, v113, 0
    v_readlane_b32 s68, v114, 0
    v_readlane_b32 s61, v113, 1
    v_readlane_b32 s69, v114, 1
    v_readlane_b32 s62, v113, 2
    v_readlane_b32 s70, v114, 2
    v_readlane_b32 s63, v113, 3
    v_readlane_b32 s71, v114, 3
    v_readlane_b32 s64, v113, 4
    v_readlane_b32 s72, v114, 4
    v_readlane_b32 s65, v113, 5
    v_readlane_b32 s73, v114, 5
    v_readlane_b32 s66, v113, 6
    v_readlane_b32 s74, v114, 6
    v_readlane_b32 s67, v113, 7
    v_readlane_b32 s75, v114, 7
    v_subrev_f32 v120, s60, v120
    v_mul_f32 v120, s68, v120
    v_fma_f32 v120, v120, v56, v52
    v_subrev_f32 v121, s60, v121
    v_mul_f32 v121, s68, v121
    v_fma_f32 v121, v121, v57, v53
    v_subrev_f32 v122, s60, v122
    v_mul_f32 v122, s68, v122
    v_fma_f32 v122, v122, v58, v54
    v_subrev_f32 v123, s60, v123
    v_mul_f32 v123, s68, v123
    v_fma_f32 v123, v123, v59, v55
    v_cvt_pk_bf16_f32 v176, v120, v121
    v_cvt_pk_bf16_f32 v177, v122, v123
    v_subrev_f32 v124, s61, v124
    v_mul_f32 v124, s69, v124
    v_fma_f32 v124, v124, v56, v52
    v_subrev_f32 v125, s61, v125
    v_mul_f32 v125, s69, v125
    v_fma_f32 v125, v125, v57, v53
    v_subrev_f32 v126, s61, v126
    v_mul_f32 v126, s69, v126
    v_fma_f32 v126, v126, v58, v54
    v_subrev_f32 v127, s61, v127
    v_mul_f32 v127, s69, v127
    v_fma_f32 v127, v127, v59, v55
    v_cvt_pk_bf16_f32 v178, v124, v125
    v_cvt_pk_bf16_f32 v179, v126, v127
    v_subrev_f32 v128, s62, v128
    v_mul_f32 v128, s70, v128
    v_fma_f32 v128, v128, v56, v52
    v_subrev_f32 v129, s62, v129
    v_mul_f32 v129, s70, v129
    v_fma_f32 v129, v129, v57, v53
    v_subrev_f32 v130, s62, v130
    v_mul_f32 v130, s70, v130
    v_fma_f32 v130, v130, v58, v54
    v_subrev_f32 v131, s62, v131
    v_mul_f32 v131, s70, v131
    v_fma_f32 v131, v131, v59, v55
    v_cvt_pk_bf16_f32 v180, v128, v129
    v_cvt_pk_bf16_f32 v181, v130, v131
    v_subrev_f32 v132, s63, v132
    v_mul_f32 v132, s71, v132
    v_fma_f32 v132, v132, v56, v52
    v_subrev_f32 v133, s63, v133
    v_mul_f32 v133, s71, v133
    v_fma_f32 v133, v133, v57, v53
    v_subrev_f32 v134, s63, v134
    v_mul_f32 v134, s71, v134
    v_fma_f32 v134, v134, v58, v54
    v_subrev_f32 v135, s63, v135
    v_mul_f32 v135, s71, v135
    v_fma_f32 v135, v135, v59, v55
    v_cvt_pk_bf16_f32 v182, v132, v133
    v_cvt_pk_bf16_f32 v183, v134, v135
    v_subrev_f32 v136, s64, v136
    v_mul_f32 v136, s72, v136
    v_fma_f32 v136, v136, v56, v52
    v_subrev_f32 v137, s64, v137
    v_mul_f32 v137, s72, v137
    v_fma_f32 v137, v137, v57, v53
    v_subrev_f32 v138, s64, v138
    v_mul_f32 v138, s72, v138
    v_fma_f32 v138, v138, v58, v54
    v_subrev_f32 v139, s64, v139
    v_mul_f32 v139, s72, v139
    v_fma_f32 v139, v139, v59, v55
    v_cvt_pk_bf16_f32 v184, v136, v137
    v_cvt_pk_bf16_f32 v185, v138, v139
    v_subrev_f32 v140, s65, v140
    v_mul_f32 v140, s73, v140
    v_fma_f32 v140, v140, v56, v52
    v_subrev_f32 v141, s65, v141
    v_mul_f32 v141, s73, v141
    v_fma_f32 v141, v141, v57, v53
    v_subrev_f32 v142, s65, v142
    v_mul_f32 v142, s73, v142
    v_fma_f32 v142, v142, v58, v54
    v_subrev_f32 v143, s65, v143
    v_mul_f32 v143, s73, v143
    v_fma_f32 v143, v143, v59, v55
    v_cvt_pk_bf16_f32 v186, v140, v141
    v_cvt_pk_bf16_f32 v187, v142, v143
    v_subrev_f32 v144, s66, v144
    v_mul_f32 v144, s74, v144
    v_fma_f32 v144, v144, v56, v52
    v_subrev_f32 v145, s66, v145
    v_mul_f32 v145, s74, v145
    v_fma_f32 v145, v145, v57, v53
    v_subrev_f32 v146, s66, v146
    v_mul_f32 v146, s74, v146
    v_fma_f32 v146, v146, v58, v54
    v_subrev_f32 v147, s66, v147
    v_mul_f32 v147, s74, v147
    v_fma_f32 v147, v147, v59, v55
    v_cvt_pk_bf16_f32 v188, v144, v145
    v_cvt_pk_bf16_f32 v189, v146, v147
    v_subrev_f32 v148, s67, v148
    v_mul_f32 v148, s75, v148
    v_fma_f32 v148, v148, v56, v52
    v_subrev_f32 v149, s67, v149
    v_mul_f32 v149, s75, v149
    v_fma_f32 v149, v149, v57, v53
    v_subrev_f32 v150, s67, v150
    v_mul_f32 v150, s75, v150
    v_fma_f32 v150, v150, v58, v54
    v_subrev_f32 v151, s67, v151
    v_mul_f32 v151, s75, v151
    v_fma_f32 v151, v151, v59, v55
    v_cvt_pk_bf16_f32 v190, v148, v149
    v_cvt_pk_bf16_f32 v191, v150, v151
    v_and_b32 v112, 1, v225
    v_cmp_eq_u32 vcc, 1, v112
    s_nop 1
    v_cndmask_b32 v208, v176, v184, vcc
    v_cndmask_b32 v210, v184, v176, vcc
    s_nop 1
    v_mov_b32_dpp v212, v210 quad_perm:[1,0,3,2] row_mask:0xf bank_mask:0xf
    v_cndmask_b32 v192, v208, v212, vcc
    v_cndmask_b32 v194, v212, v208, vcc
    v_cndmask_b32 v209, v177, v185, vcc
    v_cndmask_b32 v211, v185, v177, vcc
    s_nop 1
    v_mov_b32_dpp v213, v211 quad_perm:[1,0,3,2] row_mask:0xf bank_mask:0xf
    v_cndmask_b32 v193, v209, v213, vcc
    v_cndmask_b32 v195, v213, v209, vcc
    v_cndmask_b32 v208, v178, v186, vcc
    v_cndmask_b32 v210, v186, v178, vcc
    s_nop 1
    v_mov_b32_dpp v212, v210 quad_perm:[1,0,3,2] row_mask:0xf bank_mask:0xf
    v_cndmask_b32 v196, v208, v212, vcc
    v_cndmask_b32 v198, v212, v208, vcc
    v_cndmask_b32 v209, v179, v187, vcc
    v_cndmask_b32 v211, v187, v179, vcc
    s_nop 1
    v_mov_b32_dpp v213, v211 quad_perm:[1,0,3,2] row_mask:0xf bank_mask:0xf
    v_cndmask_b32 v197, v209, v213, vcc
    v_cndmask_b32 v199, v213, v209, vcc
    v_cndmask_b32 v208, v180, v188, vcc
    v_cndmask_b32 v210, v188, v180, vcc
    s_nop 1
    v_mov_b32_dpp v212, v210 quad_perm:[1,0,3,2] row_mask:0xf bank_mask:0xf
    v_cndmask_b32 v200, v208, v212, vcc
    v_cndmask_b32 v202, v212, v208, vcc
    v_cndmask_b32 v209, v181, v189, vcc
    v_cndmask_b32 v211, v189, v181, vcc
    s_nop 1
    v_mov_b32_dpp v213, v211 quad_perm:[1,0,3,2] row_mask:0xf bank_mask:0xf
    v_cndmask_b32 v201, v209, v213, vcc
    v_cndmask_b32 v203, v213, v209, vcc
    v_cndmask_b32 v208, v182, v190, vcc
    v_cndmask_b32 v210, v190, v182, vcc
    s_nop 1
    v_mov_b32_dpp v212, v210 quad_perm:[1,0,3,2] row_mask:0xf bank_mask:0xf
    v_cndmask_b32 v204, v208, v212, vcc
    v_cndmask_b32 v206, v212, v208, vcc
    v_cndmask_b32 v209, v183, v191, vcc
    v_cndmask_b32 v211, v191, v183, vcc
    s_nop 1
    v_mov_b32_dpp v213, v211 quad_perm:[1,0,3,2] row_mask:0xf bank_mask:0xf
    v_cndmask_b32 v205, v209, v213, vcc
    v_cndmask_b32 v207, v213, v209, vcc
    v_lshrrev_b32 v1, 1, v0
    v_lshlrev_b32 v1, 7, v1
    v_lshlrev_b32 v112, 6, v112
    v_add_u32 v1, v1, v112
    v_add_u32 v1, 0, v1
    ds_write_b128 v1, v[192:195] offset:0
    ds_write_b128 v1, v[196:199] offset:16
    ds_write_b128 v1, v[200:203] offset:32
    ds_write_b128 v1, v[204:207] offset:48
    s_lshl_b32 s14, s3, 12
    v_lshlrev_b32 v2, 4, v225
    v_add_u32 v2, s14, v2
    v_add_u32 v2, 0, v2
    s_waitcnt lgkmcnt(0)
    ds_read_b128 v[192:195], v2 offset:0
    ds_read_b128 v[196:199], v2 offset:1024
    ds_read_b128 v[200:203], v2 offset:2048
    ds_read_b128 v[204:207], v2 offset:3072
    s_lshr_b32 s14, s2, 5
    s_lshl_b32 s14, s14, 19
    s_and_b32 s15, s2, 31
    s_lshl_b32 s15, s15, 7
    s_add_u32 s14, s14, s15
    s_lshl_b32 s15, s3, 17
    s_add_u32 s14, s14, s15
    v_lshrrev_b32 v1, 3, v225
    v_lshlrev_b32 v1, 12, v1
    v_and_b32 v3, 7, v225
    v_lshlrev_b32 v3, 4, v3
    v_add_u32 v1, v1, v3
    s_waitcnt lgkmcnt(0)
    buffer_store_dwordx4 v[192:195], v1, s[20:23], s14 offen sc1
    s_add_u32 s14, s14, 32768
    buffer_store_dwordx4 v[196:199], v1, s[20:23], s14 offen sc1
    s_add_u32 s14, s14, 32768
    buffer_store_dwordx4 v[200:203], v1, s[20:23], s14 offen sc1
    s_add_u32 s14, s14, 32768
    buffer_store_dwordx4 v[204:207], v1, s[20:23], s14 offen sc1
    s_lshr_b32 s14, s2, 5
    s_lshl_b32 s14, s14, 7
    s_waitcnt vmcnt(0)
    s_barrier
    s_cmp_lg_u32 s3, 0
    s_cbranch_scc1 L_sig_2526
    v_mov_b32 v214, 1
    v_mov_b32 v215, 0
    v_cmp_eq_u32 vcc, 0, v225
    s_nop 1
    s_and_saveexec_b64 s[76:77], vcc
    buffer_atomic_add v214, v215, s[8:11], s14 offen sc1
    s_mov_b64 exec, s[76:77]
L_sig_2526:
    s_lshl_b32 s14, s6, 19
    s_add_u32 s56, s4, 12582912
    s_addc_u32 s57, s5, 0
    s_add_u32 s56, s56, s14
    s_addc_u32 s57, s57, 0
    s_mov_b32 s58, 524288
    s_mov_b32 s59, 0x00020000
    v_lshlrev_b32 v230, 4, v225
    s_lshl_b32 s14, s3, 12
    v_add_u32 v230, s14, v230
    s_and_b32 s15, s3, 1
    s_mul_i32 s15, s15, 192
    s_mov_b32 s54, 4682
    v_add_u32 v236, s15, v225
    v_mul_lo_u32 v237, s54, v236
    v_lshrrev_b32 v237, 16, v237
    v_mul_u32_u24 v238, 14, v237
    v_sub_u32 v238, v236, v238
    v_and_b32 v239, 0x13, v237
    v_bfe_u32 v236, v237, 2, 1
    v_lshl_or_b32 v239, v236, 3, v239
    v_bfe_u32 v236, v237, 3, 1
    v_lshl_or_b32 v237, v236, 2, v239
    v_mul_u32_u24 v237, 7168, v237
    v_lshlrev_b32 v238, 4, v238
    v_add_u32 v232, v237, v238
    v_add_u32 v236, s15, v225
    v_add_u32 v236, 64, v236
    v_mul_lo_u32 v237, s54, v236
    v_lshrrev_b32 v237, 16, v237
    v_mul_u32_u24 v238, 14, v237
    v_sub_u32 v238, v236, v238
    v_and_b32 v239, 0x13, v237
    v_bfe_u32 v236, v237, 2, 1
    v_lshl_or_b32 v239, v236, 3, v239
    v_bfe_u32 v236, v237, 3, 1
    v_lshl_or_b32 v237, v236, 2, v239
    v_mul_u32_u24 v237, 7168, v237
    v_lshlrev_b32 v238, 4, v238
    v_add_u32 v233, v237, v238
    v_subrev_u32 v233, 1024, v233
    v_add_u32 v236, s15, v225
    v_add_u32 v236, 128, v236
    v_mul_lo_u32 v237, s54, v236
    v_lshrrev_b32 v237, 16, v237
    v_mul_u32_u24 v238, 14, v237
    v_sub_u32 v238, v236, v238
    v_and_b32 v239, 0x13, v237
    v_bfe_u32 v236, v237, 2, 1
    v_lshl_or_b32 v239, v236, 3, v239
    v_bfe_u32 v236, v237, 3, 1
    v_lshl_or_b32 v237, v236, 2, v239
    v_mul_u32_u24 v237, 7168, v237
    v_lshlrev_b32 v238, 4, v238
    v_add_u32 v234, v237, v238
    v_subrev_u32 v234, 2048, v234
    v_add_u32 v236, s15, v225
    v_add_u32 v236, 192, v236
    v_mul_lo_u32 v237, s54, v236
    v_lshrrev_b32 v237, 16, v237
    v_mul_u32_u24 v238, 14, v237
    v_sub_u32 v238, v236, v238
    v_and_b32 v239, 0x13, v237
    v_bfe_u32 v236, v237, 2, 1
    v_lshl_or_b32 v239, v236, 3, v239
    v_bfe_u32 v236, v237, 3, 1
    v_lshl_or_b32 v237, v236, 2, v239
    v_mul_u32_u24 v237, 7168, v237
    v_lshlrev_b32 v238, 4, v238
    v_add_u32 v235, v237, v238
    v_subrev_u32 v235, 3072, v235
    s_mov_b32 s37, 0
    s_add_u32 m0, s37, s33
    s_nop 0
    buffer_load_dwordx4 v232, s[28:31], s35 offen offset:0 lds
    buffer_load_dwordx4 v233, s[28:31], s35 offen offset:1024 lds
    buffer_load_dwordx4 v234, s[28:31], s35 offen offset:2048 lds
    buffer_load_dwordx4 v235, s[28:31], s35 offen offset:3072 lds
    s_add_u32 s35, s35, 229376
    s_mov_b32 s37, 30848
    s_add_u32 m0, s37, s33
    s_nop 0
    buffer_load_dwordx4 v232, s[28:31], s35 offen offset:0 lds
    buffer_load_dwordx4 v233, s[28:31], s35 offen offset:1024 lds
    buffer_load_dwordx4 v234, s[28:31], s35 offen offset:2048 lds
    buffer_load_dwordx4 v235, s[28:31], s35 offen offset:3072 lds
    s_add_u32 s35, s35, 229376
    s_mov_b32 s37, 61696
    s_add_u32 m0, s37, s33
    s_nop 0
    buffer_load_dwordx4 v232, s[28:31], s35 offen offset:0 lds
    buffer_load_dwordx4 v233, s[28:31], s35 offen offset:1024 lds
    buffer_load_dwordx4 v234, s[28:31], s35 offen offset:2048 lds
    buffer_load_dwordx4 v235, s[28:31], s35 offen offset:3072 lds
    s_add_u32 s35, s35, 229376
    s_mov_b32 s37, 92544
    s_add_u32 m0, s37, s33
    s_nop 0
    buffer_load_dwordx4 v232, s[28:31], s35 offen offset:0 lds
    buffer_load_dwordx4 v233, s[28:31], s35 offen offset:1024 lds
    buffer_load_dwordx4 v234, s[28:31], s35 offen offset:2048 lds
    buffer_load_dwordx4 v235, s[28:31], s35 offen offset:3072 lds
    s_add_u32 s35, s35, 229376
    s_mov_b32 s37, 123392
    s_add_u32 m0, s37, s33
    s_nop 0
    buffer_load_dwordx4 v232, s[28:31], s35 offen offset:0 lds
    buffer_load_dwordx4 v233, s[28:31], s35 offen offset:1024 lds
    buffer_load_dwordx4 v234, s[28:31], s35 offen offset:2048 lds
    buffer_load_dwordx4 v235, s[28:31], s35 offen offset:3072 lds
    s_add_u32 s35, s35, 229376
    s_lshl_b32 s14, s6, 6
    s_and_b32 s15, s3, 1
    s_lshl_b32 s15, s15, 5
    s_add_u32 s14, s14, s15
    s_mul_i32 s14, s14, 7168
    s_mul_i32 s15, s7, 224
    s_add_u32 s14, s14, s15
    v_lshrrev_b32 v236, 1, v225
    v_mul_u32_u24 v236, 7168, v236
    v_and_b32 v237, 1, v225
    v_lshlrev_b32 v237, 7, v237
    v_add_u32 v231, v236, v237
    v_add_u32 v231, s14, v231
    v_and_b32 v236, 31, v225
    v_mul_u32_u24 v236, 7168, v236
    v_add_u32 v254, s14, v236
    v_add_u32 v254, 223, v254
    s_mov_b32 s55, 3670016
    v_lshrrev_b32 v236, 4, v225
    v_lshlrev_b32 v236, 12, v236
    v_and_b32 v237, 15, v225
    v_lshlrev_b32 v237, 4, v237
    v_add_u32 v228, v236, v237
    s_lshl_b32 s14, s3, 10
    v_add_u32 v228, s14, v228
    v_lshrrev_b32 v236, 5, v225
    v_lshlrev_b32 v236, 4, v236
    v_bfe_u32 v237, v225, 4, 1
    v_lshlrev_b32 v237, 2, v237
    v_add_u32 v236, v236, v237
    v_bfe_u32 v237, v225, 2, 2
    v_add_u32 v236, v236, v237
    v_mul_u32_u24 v236, 224, v236
    v_and_b32 v237, 3, v225
    v_lshlrev_b32 v237, 3, v237
    v_add_u32 v236, v236, v237
    v_add_u32 v229, 16384, v236
    v_mov_b32 v0, 0
    v_mov_b32 v1, 0
    v_mov_b32 v2, 0
    v_mov_b32 v3, 0
    v_mov_b32 v4, 0
    v_mov_b32 v5, 0
    v_mov_b32 v6, 0
    v_mov_b32 v7, 0
    v_mov_b32 v8, 0
    v_mov_b32 v9, 0
    v_mov_b32 v10, 0
    v_mov_b32 v11, 0
    v_mov_b32 v12, 0
    v_mov_b32 v13, 0
    v_mov_b32 v14, 0
    v_mov_b32 v15, 0
    v_mov_b32 v16, 0
    v_mov_b32 v17, 0
    v_mov_b32 v18, 0
    v_mov_b32 v19, 0
    v_mov_b32 v20, 0
    v_mov_b32 v21, 0
    v_mov_b32 v22, 0
    v_mov_b32 v23, 0
    v_mov_b32 v24, 0
    v_mov_b32 v25, 0
    v_mov_b32 v26, 0
    v_mov_b32 v27, 0
    v_mov_b32 v28, 0
    v_mov_b32 v29, 0
    v_mov_b32 v30, 0
    v_mov_b32 v31, 0
    v_mov_b32 v32, 0
    v_mov_b32 v33, 0
    v_mov_b32 v34, 0
    v_mov_b32 v35, 0
    v_mov_b32 v36, 0
    v_mov_b32 v37, 0
    v_mov_b32 v38, 0
    v_mov_b32 v39, 0
    v_mov_b32 v40, 0
    v_mov_b32 v41, 0
    v_mov_b32 v42, 0
    v_mov_b32 v43, 0
    v_mov_b32 v44, 0
    v_mov_b32 v45, 0
    v_mov_b32 v46, 0
    v_mov_b32 v47, 0
    v_mov_b32 v48, 0
    v_mov_b32 v49, 0
    v_mov_b32 v50, 0
    v_mov_b32 v51, 0
    v_mov_b32 v52, 0
    v_mov_b32 v53, 0
    v_mov_b32 v54, 0
    v_mov_b32 v55, 0
    v_mov_b32 v56, 0
    v_mov_b32 v57, 0
    v_mov_b32 v58, 0
    v_mov_b32 v59, 0
    v_mov_b32 v60, 0
    v_mov_b32 v61, 0
    v_mov_b32 v62, 0
    v_mov_b32 v63, 0
    v_mov_b32 v64, 0
    v_mov_b32 v65, 0
    v_mov_b32 v66, 0
    v_mov_b32 v67, 0
    v_mov_b32 v68, 0
    v_mov_b32 v69, 0
    v_mov_b32 v70, 0
    v_mov_b32 v71, 0
    v_mov_b32 v72, 0
    v_mov_b32 v73, 0
    v_mov_b32 v74, 0
    v_mov_b32 v75, 0
    v_mov_b32 v76, 0
    v_mov_b32 v77, 0
    v_mov_b32 v78, 0
    v_mov_b32 v79, 0
    v_mov_b32 v80, 0
    v_mov_b32 v81, 0
    v_mov_b32 v82, 0
    v_mov_b32 v83, 0
    v_mov_b32 v84, 0
    v_mov_b32 v85, 0
    v_mov_b32 v86, 0
    v_mov_b32 v87, 0
    v_mov_b32 v88, 0
    v_mov_b32 v89, 0
    v_mov_b32 v90, 0
    v_mov_b32 v91, 0
    v_mov_b32 v92, 0
    v_mov_b32 v93, 0
    v_mov_b32 v94, 0
    v_mov_b32 v95, 0
    v_mov_b32 v96, 0
    v_mov_b32 v97, 0
    v_mov_b32 v98, 0
    v_mov_b32 v99, 0
    v_mov_b32 v100, 0
    v_mov_b32 v101, 0
    v_mov_b32 v102, 0
    v_mov_b32 v103, 0
    v_mov_b32 v104, 0
    v_mov_b32 v105, 0
    v_mov_b32 v106, 0
    v_mov_b32 v107, 0
    v_mov_b32 v108, 0
    v_mov_b32 v109, 0
    v_mov_b32 v110, 0
    v_mov_b32 v111, 0
    v_mov_b32 v112, 0
    v_mov_b32 v113, 0
    v_mov_b32 v114, 0
    v_mov_b32 v115, 0
    v_mov_b32 v116, 0
    v_mov_b32 v117, 0
    v_mov_b32 v118, 0
    v_mov_b32 v119, 0
    v_mov_b32 v120, 0
    v_mov_b32 v121, 0
    v_mov_b32 v122, 0
    v_mov_b32 v123, 0
    v_mov_b32 v124, 0
    v_mov_b32 v125, 0
    v_mov_b32 v126, 0
    v_mov_b32 v127, 0
    v_mov_b32 v128, 0
    v_mov_b32 v129, 0
    v_mov_b32 v130, 0
    v_mov_b32 v131, 0
    v_mov_b32 v132, 0
    v_mov_b32 v133, 0
    v_mov_b32 v134, 0
    v_mov_b32 v135, 0
    v_mov_b32 v136, 0
    v_mov_b32 v137, 0
    v_mov_b32 v138, 0
    v_mov_b32 v139, 0
    v_mov_b32 v140, 0
    v_mov_b32 v141, 0
    v_mov_b32 v142, 0
    v_mov_b32 v143, 0
    v_mov_b32 v144, 0
    v_mov_b32 v145, 0
    v_mov_b32 v146, 0
    v_mov_b32 v147, 0
    v_mov_b32 v148, 0
    v_mov_b32 v149, 0
    v_mov_b32 v150, 0
    v_mov_b32 v151, 0
    v_mov_b32 v152, 0
    v_mov_b32 v153, 0
    v_mov_b32 v154, 0
    v_mov_b32 v155, 0
    v_mov_b32 v156, 0
    v_mov_b32 v157, 0
    v_mov_b32 v158, 0
    v_mov_b32 v159, 0
    v_mov_b32 v160, 0
    v_mov_b32 v161, 0
    v_mov_b32 v162, 0
    v_mov_b32 v163, 0
    v_mov_b32 v164, 0
    v_mov_b32 v165, 0
    v_mov_b32 v166, 0
    v_mov_b32 v167, 0
    v_mov_b32 v168, 0
    v_mov_b32 v169, 0
    v_mov_b32 v170, 0
    v_mov_b32 v171, 0
    v_mov_b32 v172, 0
    v_mov_b32 v173, 0
    v_mov_b32 v174, 0
    v_mov_b32 v175, 0
    v_mov_b32 v176, 0
    v_mov_b32 v177, 0
    v_mov_b32 v178, 0
    v_mov_b32 v179, 0
    v_mov_b32 v180, 0
    v_mov_b32 v181, 0
    v_mov_b32 v182, 0
    v_mov_b32 v183, 0
    v_mov_b32 v184, 0
    v_mov_b32 v185, 0
    v_mov_b32 v186, 0
    v_mov_b32 v187, 0
    v_mov_b32 v188, 0
    v_mov_b32 v189, 0
    v_mov_b32 v190, 0
    v_mov_b32 v191, 0
    v_mov_b32 v192, 0
    v_mov_b32 v193, 0
    v_mov_b32 v194, 0
    v_mov_b32 v195, 0
    v_mov_b32 v196, 0
    v_mov_b32 v197, 0
    v_mov_b32 v198, 0
    v_mov_b32 v199, 0
    v_mov_b32 v200, 0
    v_mov_b32 v201, 0
    v_mov_b32 v202, 0
    v_mov_b32 v203, 0
    v_mov_b32 v204, 0
    v_mov_b32 v205, 0
    v_mov_b32 v206, 0
    v_mov_b32 v207, 0
    v_mov_b32 v208, 0
    v_mov_b32 v209, 0
    v_mov_b32 v210, 0
    v_mov_b32 v211, 0
    v_mov_b32 v212, 0
    v_mov_b32 v213, 0
    v_mov_b32 v214, 0
    v_mov_b32 v215, 0
    v_mov_b32 v216, 0
    v_mov_b32 v217, 0
    v_mov_b32 v218, 0
    v_mov_b32 v219, 0
    v_mov_b32 v220, 0
    v_mov_b32 v221, 0
    v_mov_b32 v222, 0
    v_mov_b32 v223, 0
    s_lshl_b32 s14, s6, 7
    s_cmp_lg_u32 s3, 0
    s_cbranch_scc1 L_poll_2909_done
    v_mov_b32 v237, 0
    s_mov_b32 s78, 0x20000
L_poll_2909:
    buffer_load_dword v236, v237, s[8:11], s14 offen sc1
    s_waitcnt vmcnt(0)
    v_readfirstlane_b32 s79, v236
    s_nop 1
    s_cmp_ge_u32 s79, 32
    s_cbranch_scc1 L_poll_2909_done
    s_sleep 1
    s_sub_u32 s78, s78, 1
    s_cmp_lg_u32 s78, 0
    s_cbranch_scc1 L_poll_2909
L_poll_2909_done:
    s_barrier
    s_mov_b32 s37, 0
    s_add_u32 m0, s37, s32
    s_nop 0
    buffer_load_dwordx4 v230, s[56:59], s34 offen offset:0 sc1 lds
    buffer_load_dwordx4 v230, s[56:59], s34 offen offset:1024 sc1 lds
    buffer_load_dwordx4 v230, s[56:59], s34 offen offset:2048 sc1 lds
    buffer_load_dwordx4 v230, s[56:59], s34 offen offset:3072 sc1 lds
    s_add_u32 s34, s34, 16384
    s_mov_b32 s37, 30848
    s_add_u32 m0, s37, s32
    s_nop 0
    buffer_load_dwordx4 v230, s[56:59], s34 offen offset:0 sc1 lds
    buffer_load_dwordx4 v230, s[56:59], s34 offen offset:1024 sc1 lds
    buffer_load_dwordx4 v230, s[56:59], s34 offen offset:2048 sc1 lds
    buffer_load_dwordx4 v230, s[56:59], s34 offen offset:3072 sc1 lds
    s_add_u32 s34, s34, 16384
    s_mov_b32 s37, 61696
    s_add_u32 m0, s37, s32
    s_nop 0
    buffer_load_dwordx4 v230, s[56:59], s34 offen offset:0 sc1 lds
    buffer_load_dwordx4 v230, s[56:59], s34 offen offset:1024 sc1 lds
    buffer_load_dwordx4 v230, s[56:59], s34 offen offset:2048 sc1 lds
    buffer_load_dwordx4 v230, s[56:59], s34 offen offset:3072 sc1 lds
    s_add_u32 s34, s34, 16384
    s_mov_b32 s37, 92544
    s_add_u32 m0, s37, s32
    s_nop 0
    buffer_load_dwordx4 v230, s[56:59], s34 offen offset:0 sc1 lds
    buffer_load_dwordx4 v230, s[56:59], s34 offen offset:1024 sc1 lds
    buffer_load_dwordx4 v230, s[56:59], s34 offen offset:2048 sc1 lds
    buffer_load_dwordx4 v230, s[56:59], s34 offen offset:3072 sc1 lds
    s_add_u32 s34, s34, 16384
    s_mov_b32 s37, 123392
    s_add_u32 m0, s37, s32
    s_nop 0
    buffer_load_dwordx4 v230, s[56:59], s34 offen offset:0 sc1 lds
    buffer_load_dwordx4 v230, s[56:59], s34 offen offset:1024 sc1 lds
    buffer_load_dwordx4 v230, s[56:59], s34 offen offset:2048 sc1 lds
    buffer_load_dwordx4 v230, s[56:59], s34 offen offset:3072 sc1 lds
    s_add_u32 s34, s34, 16384
    s_waitcnt vmcnt(16)
    s_barrier
    v_mov_b32 v226, v228
    v_mov_b32 v227, v229
    ds_read_b128 a[112:115], v226 offset:0
    ds_read_b128 a[116:119], v226 offset:256
    ds_read_b128 a[120:123], v226 offset:512
    ds_read_b128 a[124:127], v226 offset:768
    ds_read_b64_tr_b16 a[0:1], v227 offset:0
    ds_read_b64_tr_b16 a[2:3], v227 offset:1792
    ds_read_b64_tr_b16 a[4:5], v227 offset:7296
    ds_read_b64_tr_b16 a[6:7], v227 offset:9088
    ds_read_b64_tr_b16 a[8:9], v227 offset:32
    ds_read_b64_tr_b16 a[10:11], v227 offset:1824
    ds_read_b64_tr_b16 a[12:13], v227 offset:7328
    ds_read_b64_tr_b16 a[14:15], v227 offset:9120
    ds_read_b64_tr_b16 a[16:17], v227 offset:64
    ds_read_b64_tr_b16 a[18:19], v227 offset:1856
    ds_read_b64_tr_b16 a[20:21], v227 offset:7360
    ds_read_b64_tr_b16 a[22:23], v227 offset:9152
    ds_read_b64_tr_b16 a[24:25], v227 offset:96
    ds_read_b64_tr_b16 a[26:27], v227 offset:1888
    ds_read_b64_tr_b16 a[28:29], v227 offset:7392
    ds_read_b64_tr_b16 a[30:31], v227 offset:9184
    ds_read_b64_tr_b16 a[32:33], v227 offset:128
    ds_read_b64_tr_b16 a[34:35], v227 offset:1920
    ds_read_b64_tr_b16 a[36:37], v227 offset:7424
    ds_read_b64_tr_b16 a[38:39], v227 offset:9216
    ds_read_b64_tr_b16 a[40:41], v227 offset:160
    ds_read_b64_tr_b16 a[42:43], v227 offset:1952
    ds_read_b64_tr_b16 a[44:45], v227 offset:7456
    ds_read_b64_tr_b16 a[46:47], v227 offset:9248
    ds_read_b64_tr_b16 a[48:49], v227 offset:192
    ds_read_b64_tr_b16 a[50:51], v227 offset:1984
    ds_read_b64_tr_b16 a[52:53], v227 offset:7488
    ds_read_b64_tr_b16 a[54:55], v227 offset:9280
    s_mov_b32 s36, 30848
    s_mov_b32 s37, 0
    s_waitcnt lgkmcnt(0)
    v_mfma_f32_16x16x32_bf16 v[0:3], a[0:3], a[112:115], v[0:3]
    v_mfma_f32_16x16x32_bf16 v[4:7], a[0:3], a[116:119], v[4:7]
    v_mfma_f32_16x16x32_bf16 v[8:11], a[0:3], a[120:123], v[8:11]
    v_mfma_f32_16x16x32_bf16 v[12:15], a[0:3], a[124:127], v[12:15]
    s_waitcnt vmcnt(12)
    s_barrier
    v_add_u32 v226, s36, v228
    v_add_u32 v227, s36, v229
    v_mfma_f32_16x16x32_bf16 v[124:127], a[4:7], a[124:127], v[124:127]
    ds_read_b128 a[128:131], v226 offset:0
    v_mfma_f32_16x16x32_bf16 v[120:123], a[4:7], a[120:123], v[120:123]
    ds_read_b128 a[132:135], v226 offset:256
    s_add_u32 m0, s37, s32
    v_mfma_f32_16x16x32_bf16 v[116:119], a[4:7], a[116:119], v[116:119]
    ds_read_b128 a[136:139], v226 offset:512
    v_mfma_f32_16x16x32_bf16 v[112:115], a[4:7], a[112:115], v[112:115]
    ds_read_b128 a[140:143], v226 offset:768
    buffer_load_dwordx4 v230, s[56:59], s34 offen offset:0 sc1 lds
    v_mfma_f32_16x16x32_bf16 v[16:19], a[8:11], a[112:115], v[16:19]
    v_mfma_f32_16x16x32_bf16 v[20:23], a[8:11], a[116:119], v[20:23]
    ds_read_b64_tr_b16 a[56:57], v227 offset:0
    v_mfma_f32_16x16x32_bf16 v[24:27], a[8:11], a[120:123], v[24:27]
    ds_read_b64_tr_b16 a[58:59], v227 offset:1792
    v_mfma_f32_16x16x32_bf16 v[28:31], a[8:11], a[124:127], v[28:31]
    ds_read_b64_tr_b16 a[60:61], v227 offset:7296
    v_mfma_f32_16x16x32_bf16 v[140:143], a[12:15], a[124:127], v[140:143]
    ds_read_b64_tr_b16 a[62:63], v227 offset:9088
    v_mfma_f32_16x16x32_bf16 v[136:139], a[12:15], a[120:123], v[136:139]
    buffer_load_dwordx4 v230, s[56:59], s34 offen offset:1024 sc1 lds
    v_mfma_f32_16x16x32_bf16 v[132:135], a[12:15], a[116:119], v[132:135]
    ds_read_b64_tr_b16 a[64:65], v227 offset:32
    v_mfma_f32_16x16x32_bf16 v[128:131], a[12:15], a[112:115], v[128:131]
    ds_read_b64_tr_b16 a[66:67], v227 offset:1824
    v_mfma_f32_16x16x32_bf16 v[32:35], a[16:19], a[112:115], v[32:35]
    ds_read_b64_tr_b16 a[68:69], v227 offset:7328
    v_mfma_f32_16x16x32_bf16 v[36:39], a[16:19], a[116:119], v[36:39]
    ds_read_b64_tr_b16 a[70:71], v227 offset:9120
    v_mfma_f32_16x16x32_bf16 v[40:43], a[16:19], a[120:123], v[40:43]
    v_mfma_f32_16x16x32_bf16 v[44:47], a[16:19], a[124:127], v[44:47]
    ds_read_b64_tr_b16 a[72:73], v227 offset:64
    buffer_load_dwordx4 v230, s[56:59], s34 offen offset:2048 sc1 lds
    v_mfma_f32_16x16x32_bf16 v[156:159], a[20:23], a[124:127], v[156:159]
    ds_read_b64_tr_b16 a[74:75], v227 offset:1856
    v_mfma_f32_16x16x32_bf16 v[152:155], a[20:23], a[120:123], v[152:155]
    ds_read_b64_tr_b16 a[76:77], v227 offset:7360
    v_mfma_f32_16x16x32_bf16 v[148:151], a[20:23], a[116:119], v[148:151]
    ds_read_b64_tr_b16 a[78:79], v227 offset:9152
    v_mfma_f32_16x16x32_bf16 v[144:147], a[20:23], a[112:115], v[144:147]
    v_mfma_f32_16x16x32_bf16 v[48:51], a[24:27], a[112:115], v[48:51]
    ds_read_b64_tr_b16 a[80:81], v227 offset:96
    v_mfma_f32_16x16x32_bf16 v[52:55], a[24:27], a[116:119], v[52:55]
    ds_read_b64_tr_b16 a[82:83], v227 offset:1888
    buffer_load_dwordx4 v230, s[56:59], s34 offen offset:3072 sc1 lds
    v_mfma_f32_16x16x32_bf16 v[56:59], a[24:27], a[120:123], v[56:59]
    ds_read_b64_tr_b16 a[84:85], v227 offset:7392
    v_mfma_f32_16x16x32_bf16 v[60:63], a[24:27], a[124:127], v[60:63]
    ds_read_b64_tr_b16 a[86:87], v227 offset:9184
    s_add_u32 s34, s34, 16384
    v_mfma_f32_16x16x32_bf16 v[172:175], a[28:31], a[124:127], v[172:175]
    v_mfma_f32_16x16x32_bf16 v[168:171], a[28:31], a[120:123], v[168:171]
    ds_read_b64_tr_b16 a[88:89], v227 offset:128
    s_add_u32 m0, s37, s33
    v_mfma_f32_16x16x32_bf16 v[164:167], a[28:31], a[116:119], v[164:167]
    ds_read_b64_tr_b16 a[90:91], v227 offset:1920
    v_mfma_f32_16x16x32_bf16 v[160:163], a[28:31], a[112:115], v[160:163]
    ds_read_b64_tr_b16 a[92:93], v227 offset:7424
    v_mfma_f32_16x16x32_bf16 v[64:67], a[32:35], a[112:115], v[64:67]
    ds_read_b64_tr_b16 a[94:95], v227 offset:9216
    v_mfma_f32_16x16x32_bf16 v[68:71], a[32:35], a[116:119], v[68:71]
    buffer_load_dwordx4 v232, s[28:31], s35 offen offset:0 lds
    v_mfma_f32_16x16x32_bf16 v[72:75], a[32:35], a[120:123], v[72:75]
    ds_read_b64_tr_b16 a[96:97], v227 offset:160
    v_mfma_f32_16x16x32_bf16 v[76:79], a[32:35], a[124:127], v[76:79]
    ds_read_b64_tr_b16 a[98:99], v227 offset:1952
    v_mfma_f32_16x16x32_bf16 v[188:191], a[36:39], a[124:127], v[188:191]
    ds_read_b64_tr_b16 a[100:101], v227 offset:7456
    v_mfma_f32_16x16x32_bf16 v[184:187], a[36:39], a[120:123], v[184:187]
    ds_read_b64_tr_b16 a[102:103], v227 offset:9248
    v_mfma_f32_16x16x32_bf16 v[180:183], a[36:39], a[116:119], v[180:183]
    v_mfma_f32_16x16x32_bf16 v[176:179], a[36:39], a[112:115], v[176:179]
    ds_read_b64_tr_b16 a[104:105], v227 offset:192
    buffer_load_dwordx4 v233, s[28:31], s35 offen offset:1024 lds
    v_mfma_f32_16x16x32_bf16 v[80:83], a[40:43], a[112:115], v[80:83]
    ds_read_b64_tr_b16 a[106:107], v227 offset:1984
    v_mfma_f32_16x16x32_bf16 v[84:87], a[40:43], a[116:119], v[84:87]
    ds_read_b64_tr_b16 a[108:109], v227 offset:7488
    v_mfma_f32_16x16x32_bf16 v[88:91], a[40:43], a[120:123], v[88:91]
    ds_read_b64_tr_b16 a[110:111], v227 offset:9280
    v_mfma_f32_16x16x32_bf16 v[92:95], a[40:43], a[124:127], v[92:95]
    v_mfma_f32_16x16x32_bf16 v[204:207], a[44:47], a[124:127], v[204:207]
    v_mfma_f32_16x16x32_bf16 v[200:203], a[44:47], a[120:123], v[200:203]
    buffer_load_dwordx4 v234, s[28:31], s35 offen offset:2048 lds
    v_mfma_f32_16x16x32_bf16 v[196:199], a[44:47], a[116:119], v[196:199]
    v_mfma_f32_16x16x32_bf16 v[192:195], a[44:47], a[112:115], v[192:195]
    v_mfma_f32_16x16x32_bf16 v[96:99], a[48:51], a[112:115], v[96:99]
    v_mfma_f32_16x16x32_bf16 v[100:103], a[48:51], a[116:119], v[100:103]
    v_mfma_f32_16x16x32_bf16 v[104:107], a[48:51], a[120:123], v[104:107]
    v_mfma_f32_16x16x32_bf16 v[108:111], a[48:51], a[124:127], v[108:111]
    buffer_load_dwordx4 v235, s[28:31], s35 offen offset:3072 lds
    v_mfma_f32_16x16x32_bf16 v[220:223], a[52:55], a[124:127], v[220:223]
    v_mfma_f32_16x16x32_bf16 v[216:219], a[52:55], a[120:123], v[216:219]
    s_add_u32 s35, s35, 229376
    s_add_u32 s37, s37, 30848
    s_cmp_eq_u32 s37, 154240
    s_cselect_b32 s37, 0, s37
    v_mfma_f32_16x16x32_bf16 v[212:215], a[52:55], a[116:119], v[212:215]
    v_mfma_f32_16x16x32_bf16 v[208:211], a[52:55], a[112:115], v[208:211]
    s_add_u32 s36, s36, 30848
    s_cmp_eq_u32 s36, 154240
    s_cselect_b32 s36, 0, s36
    s_waitcnt lgkmcnt(0)
    v_mfma_f32_16x16x32_bf16 v[0:3], a[56:59], a[128:131], v[0:3]
    v_mfma_f32_16x16x32_bf16 v[4:7], a[56:59], a[132:135], v[4:7]
    v_mfma_f32_16x16x32_bf16 v[8:11], a[56:59], a[136:139], v[8:11]
    v_mfma_f32_16x16x32_bf16 v[12:15], a[56:59], a[140:143], v[12:15]
    s_waitcnt vmcnt(16)
    s_barrier
    v_add_u32 v226, s36, v228
    v_add_u32 v227, s36, v229
    v_mfma_f32_16x16x32_bf16 v[124:127], a[60:63], a[140:143], v[124:127]
    ds_read_b128 a[112:115], v226 offset:0
    v_mfma_f32_16x16x32_bf16 v[120:123], a[60:63], a[136:139], v[120:123]
    ds_read_b128 a[116:119], v226 offset:256
    s_add_u32 m0, s37, s32
    v_mfma_f32_16x16x32_bf16 v[116:119], a[60:63], a[132:135], v[116:119]
    ds_read_b128 a[120:123], v226 offset:512
    v_mfma_f32_16x16x32_bf16 v[112:115], a[60:63], a[128:131], v[112:115]
    ds_read_b128 a[124:127], v226 offset:768
    buffer_load_dwordx4 v230, s[56:59], s34 offen offset:0 sc1 lds
    v_mfma_f32_16x16x32_bf16 v[16:19], a[64:67], a[128:131], v[16:19]
    v_mfma_f32_16x16x32_bf16 v[20:23], a[64:67], a[132:135], v[20:23]
    ds_read_b64_tr_b16 a[0:1], v227 offset:0
    v_mfma_f32_16x16x32_bf16 v[24:27], a[64:67], a[136:139], v[24:27]
    ds_read_b64_tr_b16 a[2:3], v227 offset:1792
    v_mfma_f32_16x16x32_bf16 v[28:31], a[64:67], a[140:143], v[28:31]
    ds_read_b64_tr_b16 a[4:5], v227 offset:7296
    v_mfma_f32_16x16x32_bf16 v[140:143], a[68:71], a[140:143], v[140:143]
    ds_read_b64_tr_b16 a[6:7], v227 offset:9088
    v_mfma_f32_16x16x32_bf16 v[136:139], a[68:71], a[136:139], v[136:139]
    buffer_load_dwordx4 v230, s[56:59], s34 offen offset:1024 sc1 lds
    v_mfma_f32_16x16x32_bf16 v[132:135], a[68:71], a[132:135], v[132:135]
    ds_read_b64_tr_b16 a[8:9], v227 offset:32
    v_mfma_f32_16x16x32_bf16 v[128:131], a[68:71], a[128:131], v[128:131]
    ds_read_b64_tr_b16 a[10:11], v227 offset:1824
    v_mfma_f32_16x16x32_bf16 v[32:35], a[72:75], a[128:131], v[32:35]
    ds_read_b64_tr_b16 a[12:13], v227 offset:7328
    v_mfma_f32_16x16x32_bf16 v[36:39], a[72:75], a[132:135], v[36:39]
    ds_read_b64_tr_b16 a[14:15], v227 offset:9120
    v_mfma_f32_16x16x32_bf16 v[40:43], a[72:75], a[136:139], v[40:43]
    v_mfma_f32_16x16x32_bf16 v[44:47], a[72:75], a[140:143], v[44:47]
    ds_read_b64_tr_b16 a[16:17], v227 offset:64
    buffer_load_dwordx4 v230, s[56:59], s34 offen offset:2048 sc1 lds
    v_mfma_f32_16x16x32_bf16 v[156:159], a[76:79], a[140:143], v[156:159]
    ds_read_b64_tr_b16 a[18:19], v227 offset:1856
    v_mfma_f32_16x16x32_bf16 v[152:155], a[76:79], a[136:139], v[152:155]
    ds_read_b64_tr_b16 a[20:21], v227 offset:7360
    v_mfma_f32_16x16x32_bf16 v[148:151], a[76:79], a[132:135], v[148:151]
    ds_read_b64_tr_b16 a[22:23], v227 offset:9152
    v_mfma_f32_16x16x32_bf16 v[144:147], a[76:79], a[128:131], v[144:147]
    v_mfma_f32_16x16x32_bf16 v[48:51], a[80:83], a[128:131], v[48:51]
    ds_read_b64_tr_b16 a[24:25], v227 offset:96
    v_mfma_f32_16x16x32_bf16 v[52:55], a[80:83], a[132:135], v[52:55]
    ds_read_b64_tr_b16 a[26:27], v227 offset:1888
    buffer_load_dwordx4 v230, s[56:59], s34 offen offset:3072 sc1 lds
    v_mfma_f32_16x16x32_bf16 v[56:59], a[80:83], a[136:139], v[56:59]
    ds_read_b64_tr_b16 a[28:29], v227 offset:7392
    v_mfma_f32_16x16x32_bf16 v[60:63], a[80:83], a[140:143], v[60:63]
    ds_read_b64_tr_b16 a[30:31], v227 offset:9184
    s_add_u32 s34, s34, 16384
    v_mfma_f32_16x16x32_bf16 v[172:175], a[84:87], a[140:143], v[172:175]
    v_mfma_f32_16x16x32_bf16 v[168:171], a[84:87], a[136:139], v[168:171]
    ds_read_b64_tr_b16 a[32:33], v227 offset:128
    s_add_u32 m0, s37, s33
    v_mfma_f32_16x16x32_bf16 v[164:167], a[84:87], a[132:135], v[164:167]
    ds_read_b64_tr_b16 a[34:35], v227 offset:1920
    v_mfma_f32_16x16x32_bf16 v[160:163], a[84:87], a[128:131], v[160:163]
    ds_read_b64_tr_b16 a[36:37], v227 offset:7424
    v_mfma_f32_16x16x32_bf16 v[64:67], a[88:91], a[128:131], v[64:67]
    ds_read_b64_tr_b16 a[38:39], v227 offset:9216
    v_mfma_f32_16x16x32_bf16 v[68:71], a[88:91], a[132:135], v[68:71]
    buffer_load_dwordx4 v232, s[28:31], s35 offen offset:0 lds
    v_mfma_f32_16x16x32_bf16 v[72:75], a[88:91], a[136:139], v[72:75]
    ds_read_b64_tr_b16 a[40:41], v227 offset:160
    v_mfma_f32_16x16x32_bf16 v[76:79], a[88:91], a[140:143], v[76:79]
    ds_read_b64_tr_b16 a[42:43], v227 offset:1952
    v_mfma_f32_16x16x32_bf16 v[188:191], a[92:95], a[140:143], v[188:191]
    ds_read_b64_tr_b16 a[44:45], v227 offset:7456
    v_mfma_f32_16x16x32_bf16 v[184:187], a[92:95], a[136:139], v[184:187]
    ds_read_b64_tr_b16 a[46:47], v227 offset:9248
    v_mfma_f32_16x16x32_bf16 v[180:183], a[92:95], a[132:135], v[180:183]
    v_mfma_f32_16x16x32_bf16 v[176:179], a[92:95], a[128:131], v[176:179]
    ds_read_b64_tr_b16 a[48:49], v227 offset:192
    buffer_load_dwordx4 v233, s[28:31], s35 offen offset:1024 lds
    v_mfma_f32_16x16x32_bf16 v[80:83], a[96:99], a[128:131], v[80:83]
    ds_read_b64_tr_b16 a[50:51], v227 offset:1984
    v_mfma_f32_16x16x32_bf16 v[84:87], a[96:99], a[132:135], v[84:87]
    ds_read_b64_tr_b16 a[52:53], v227 offset:7488
    v_mfma_f32_16x16x32_bf16 v[88:91], a[96:99], a[136:139], v[88:91]
    ds_read_b64_tr_b16 a[54:55], v227 offset:9280
    v_mfma_f32_16x16x32_bf16 v[92:95], a[96:99], a[140:143], v[92:95]
    v_mfma_f32_16x16x32_bf16 v[204:207], a[100:103], a[140:143], v[204:207]
    v_mfma_f32_16x16x32_bf16 v[200:203], a[100:103], a[136:139], v[200:203]
    buffer_load_dwordx4 v234, s[28:31], s35 offen offset:2048 lds
    v_mfma_f32_16x16x32_bf16 v[196:199], a[100:103], a[132:135], v[196:199]
    v_mfma_f32_16x16x32_bf16 v[192:195], a[100:103], a[128:131], v[192:195]
    v_mfma_f32_16x16x32_bf16 v[96:99], a[104:107], a[128:131], v[96:99]
    v_mfma_f32_16x16x32_bf16 v[100:103], a[104:107], a[132:135], v[100:103]
    v_mfma_f32_16x16x32_bf16 v[104:107], a[104:107], a[136:139], v[104:107]
    v_mfma_f32_16x16x32_bf16 v[108:111], a[104:107], a[140:143], v[108:111]
    buffer_load_dwordx4 v235, s[28:31], s35 offen offset:3072 lds
    v_mfma_f32_16x16x32_bf16 v[220:223], a[108:111], a[140:143], v[220:223]
    v_mfma_f32_16x16x32_bf16 v[216:219], a[108:111], a[136:139], v[216:219]
    s_add_u32 s35, s35, 229376
    s_add_u32 s37, s37, 30848
    s_cmp_eq_u32 s37, 154240
    s_cselect_b32 s37, 0, s37
    v_mfma_f32_16x16x32_bf16 v[212:215], a[108:111], a[132:135], v[212:215]
    v_mfma_f32_16x16x32_bf16 v[208:211], a[108:111], a[128:131], v[208:211]
    s_add_u32 s36, s36, 30848
    s_cmp_eq_u32 s36, 154240
    s_cselect_b32 s36, 0, s36
    s_waitcnt lgkmcnt(0)
    v_mfma_f32_16x16x32_bf16 v[0:3], a[0:3], a[112:115], v[0:3]
    v_mfma_f32_16x16x32_bf16 v[4:7], a[0:3], a[116:119], v[4:7]
    v_mfma_f32_16x16x32_bf16 v[8:11], a[0:3], a[120:123], v[8:11]
    v_mfma_f32_16x16x32_bf16 v[12:15], a[0:3], a[124:127], v[12:15]
    s_waitcnt vmcnt(20)
    s_barrier
    v_add_u32 v226, s36, v228
    v_add_u32 v227, s36, v229
    v_mfma_f32_16x16x32_bf16 v[124:127], a[4:7], a[124:127], v[124:127]
    ds_read_b128 a[128:131], v226 offset:0
    v_mfma_f32_16x16x32_bf16 v[120:123], a[4:7], a[120:123], v[120:123]
    ds_read_b128 a[132:135], v226 offset:256
    s_add_u32 m0, s37, s32
    v_mfma_f32_16x16x32_bf16 v[116:119], a[4:7], a[116:119], v[116:119]
    ds_read_b128 a[136:139], v226 offset:512
    v_mfma_f32_16x16x32_bf16 v[112:115], a[4:7], a[112:115], v[112:115]
    ds_read_b128 a[140:143], v226 offset:768
    buffer_load_dwordx4 v230, s[56:59], s34 offen offset:0 sc1 lds
    v_mfma_f32_16x16x32_bf16 v[16:19], a[8:11], a[112:115], v[16:19]
    v_mfma_f32_16x16x32_bf16 v[20:23], a[8:11], a[116:119], v[20:23]
    ds_read_b64_tr_b16 a[56:57], v227 offset:0
    v_mfma_f32_16x16x32_bf16 v[24:27], a[8:11], a[120:123], v[24:27]
    ds_read_b64_tr_b16 a[58:59], v227 offset:1792
    v_mfma_f32_16x16x32_bf16 v[28:31], a[8:11], a[124:127], v[28:31]
    ds_read_b64_tr_b16 a[60:61], v227 offset:7296
    v_mfma_f32_16x16x32_bf16 v[140:143], a[12:15], a[124:127], v[140:143]
    ds_read_b64_tr_b16 a[62:63], v227 offset:9088
    v_mfma_f32_16x16x32_bf16 v[136:139], a[12:15], a[120:123], v[136:139]
    buffer_load_dwordx4 v230, s[56:59], s34 offen offset:1024 sc1 lds
    v_mfma_f32_16x16x32_bf16 v[132:135], a[12:15], a[116:119], v[132:135]
    ds_read_b64_tr_b16 a[64:65], v227 offset:32
    v_mfma_f32_16x16x32_bf16 v[128:131], a[12:15], a[112:115], v[128:131]
    ds_read_b64_tr_b16 a[66:67], v227 offset:1824
    v_mfma_f32_16x16x32_bf16 v[32:35], a[16:19], a[112:115], v[32:35]
    ds_read_b64_tr_b16 a[68:69], v227 offset:7328
    v_mfma_f32_16x16x32_bf16 v[36:39], a[16:19], a[116:119], v[36:39]
    ds_read_b64_tr_b16 a[70:71], v227 offset:9120
    v_mfma_f32_16x16x32_bf16 v[40:43], a[16:19], a[120:123], v[40:43]
    v_mfma_f32_16x16x32_bf16 v[44:47], a[16:19], a[124:127], v[44:47]
    ds_read_b64_tr_b16 a[72:73], v227 offset:64
    buffer_load_dwordx4 v230, s[56:59], s34 offen offset:2048 sc1 lds
    v_mfma_f32_16x16x32_bf16 v[156:159], a[20:23], a[124:127], v[156:159]
    ds_read_b64_tr_b16 a[74:75], v227 offset:1856
    v_mfma_f32_16x16x32_bf16 v[152:155], a[20:23], a[120:123], v[152:155]
    ds_read_b64_tr_b16 a[76:77], v227 offset:7360
    v_mfma_f32_16x16x32_bf16 v[148:151], a[20:23], a[116:119], v[148:151]
    ds_read_b64_tr_b16 a[78:79], v227 offset:9152
    v_mfma_f32_16x16x32_bf16 v[144:147], a[20:23], a[112:115], v[144:147]
    v_mfma_f32_16x16x32_bf16 v[48:51], a[24:27], a[112:115], v[48:51]
    ds_read_b64_tr_b16 a[80:81], v227 offset:96
    v_mfma_f32_16x16x32_bf16 v[52:55], a[24:27], a[116:119], v[52:55]
    ds_read_b64_tr_b16 a[82:83], v227 offset:1888
    buffer_load_dwordx4 v230, s[56:59], s34 offen offset:3072 sc1 lds
    v_mfma_f32_16x16x32_bf16 v[56:59], a[24:27], a[120:123], v[56:59]
    ds_read_b64_tr_b16 a[84:85], v227 offset:7392
    v_mfma_f32_16x16x32_bf16 v[60:63], a[24:27], a[124:127], v[60:63]
    ds_read_b64_tr_b16 a[86:87], v227 offset:9184
    s_add_u32 s34, s34, 16384
    v_mfma_f32_16x16x32_bf16 v[172:175], a[28:31], a[124:127], v[172:175]
    v_mfma_f32_16x16x32_bf16 v[168:171], a[28:31], a[120:123], v[168:171]
    ds_read_b64_tr_b16 a[88:89], v227 offset:128
    s_add_u32 m0, s37, s33
    v_mfma_f32_16x16x32_bf16 v[164:167], a[28:31], a[116:119], v[164:167]
    ds_read_b64_tr_b16 a[90:91], v227 offset:1920
    v_mfma_f32_16x16x32_bf16 v[160:163], a[28:31], a[112:115], v[160:163]
    ds_read_b64_tr_b16 a[92:93], v227 offset:7424
    v_mfma_f32_16x16x32_bf16 v[64:67], a[32:35], a[112:115], v[64:67]
    ds_read_b64_tr_b16 a[94:95], v227 offset:9216
    v_mfma_f32_16x16x32_bf16 v[68:71], a[32:35], a[116:119], v[68:71]
    buffer_load_dwordx4 v232, s[28:31], s35 offen offset:0 lds
    v_mfma_f32_16x16x32_bf16 v[72:75], a[32:35], a[120:123], v[72:75]
    ds_read_b64_tr_b16 a[96:97], v227 offset:160
    v_mfma_f32_16x16x32_bf16 v[76:79], a[32:35], a[124:127], v[76:79]
    ds_read_b64_tr_b16 a[98:99], v227 offset:1952
    v_mfma_f32_16x16x32_bf16 v[188:191], a[36:39], a[124:127], v[188:191]
    ds_read_b64_tr_b16 a[100:101], v227 offset:7456
    v_mfma_f32_16x16x32_bf16 v[184:187], a[36:39], a[120:123], v[184:187]
    ds_read_b64_tr_b16 a[102:103], v227 offset:9248
    v_mfma_f32_16x16x32_bf16 v[180:183], a[36:39], a[116:119], v[180:183]
    v_mfma_f32_16x16x32_bf16 v[176:179], a[36:39], a[112:115], v[176:179]
    ds_read_b64_tr_b16 a[104:105], v227 offset:192
    buffer_load_dwordx4 v233, s[28:31], s35 offen offset:1024 lds
    v_mfma_f32_16x16x32_bf16 v[80:83], a[40:43], a[112:115], v[80:83]
    ds_read_b64_tr_b16 a[106:107], v227 offset:1984
    v_mfma_f32_16x16x32_bf16 v[84:87], a[40:43], a[116:119], v[84:87]
    ds_read_b64_tr_b16 a[108:109], v227 offset:7488
    v_mfma_f32_16x16x32_bf16 v[88:91], a[40:43], a[120:123], v[88:91]
    ds_read_b64_tr_b16 a[110:111], v227 offset:9280
    v_mfma_f32_16x16x32_bf16 v[92:95], a[40:43], a[124:127], v[92:95]
    v_mfma_f32_16x16x32_bf16 v[204:207], a[44:47], a[124:127], v[204:207]
    v_mfma_f32_16x16x32_bf16 v[200:203], a[44:47], a[120:123], v[200:203]
    buffer_load_dwordx4 v234, s[28:31], s35 offen offset:2048 lds
    v_mfma_f32_16x16x32_bf16 v[196:199], a[44:47], a[116:119], v[196:199]
    v_mfma_f32_16x16x32_bf16 v[192:195], a[44:47], a[112:115], v[192:195]
    v_mfma_f32_16x16x32_bf16 v[96:99], a[48:51], a[112:115], v[96:99]
    v_mfma_f32_16x16x32_bf16 v[100:103], a[48:51], a[116:119], v[100:103]
    v_mfma_f32_16x16x32_bf16 v[104:107], a[48:51], a[120:123], v[104:107]
    v_mfma_f32_16x16x32_bf16 v[108:111], a[48:51], a[124:127], v[108:111]
    buffer_load_dwordx4 v235, s[28:31], s35 offen offset:3072 lds
    v_mfma_f32_16x16x32_bf16 v[220:223], a[52:55], a[124:127], v[220:223]
    v_mfma_f32_16x16x32_bf16 v[216:219], a[52:55], a[120:123], v[216:219]
    s_add_u32 s35, s35, 229376
    s_add_u32 s37, s37, 30848
    s_cmp_eq_u32 s37, 154240
    s_cselect_b32 s37, 0, s37
    v_mfma_f32_16x16x32_bf16 v[212:215], a[52:55], a[116:119], v[212:215]
    v_mfma_f32_16x16x32_bf16 v[208:211], a[52:55], a[112:115], v[208:211]
    s_add_u32 s36, s36, 30848
    s_cmp_eq_u32 s36, 154240
    s_cselect_b32 s36, 0, s36
    s_waitcnt lgkmcnt(0)
    v_mfma_f32_16x16x32_bf16 v[0:3], a[56:59], a[128:131], v[0:3]
    v_mfma_f32_16x16x32_bf16 v[4:7], a[56:59], a[132:135], v[4:7]
    v_mfma_f32_16x16x32_bf16 v[8:11], a[56:59], a[136:139], v[8:11]
    v_mfma_f32_16x16x32_bf16 v[12:15], a[56:59], a[140:143], v[12:15]
    s_waitcnt vmcnt(24)
    s_barrier
    v_add_u32 v226, s36, v228
    v_add_u32 v227, s36, v229
    v_mfma_f32_16x16x32_bf16 v[124:127], a[60:63], a[140:143], v[124:127]
    ds_read_b128 a[112:115], v226 offset:0
    v_mfma_f32_16x16x32_bf16 v[120:123], a[60:63], a[136:139], v[120:123]
    ds_read_b128 a[116:119], v226 offset:256
    s_add_u32 m0, s37, s32
    v_mfma_f32_16x16x32_bf16 v[116:119], a[60:63], a[132:135], v[116:119]
    ds_read_b128 a[120:123], v226 offset:512
    v_mfma_f32_16x16x32_bf16 v[112:115], a[60:63], a[128:131], v[112:115]
    ds_read_b128 a[124:127], v226 offset:768
    buffer_load_dwordx4 v230, s[56:59], s34 offen offset:0 sc1 lds
    v_mfma_f32_16x16x32_bf16 v[16:19], a[64:67], a[128:131], v[16:19]
    v_mfma_f32_16x16x32_bf16 v[20:23], a[64:67], a[132:135], v[20:23]
    ds_read_b64_tr_b16 a[0:1], v227 offset:0
    v_mfma_f32_16x16x32_bf16 v[24:27], a[64:67], a[136:139], v[24:27]
    ds_read_b64_tr_b16 a[2:3], v227 offset:1792
    v_mfma_f32_16x16x32_bf16 v[28:31], a[64:67], a[140:143], v[28:31]
    ds_read_b64_tr_b16 a[4:5], v227 offset:7296
    v_mfma_f32_16x16x32_bf16 v[140:143], a[68:71], a[140:143], v[140:143]
    ds_read_b64_tr_b16 a[6:7], v227 offset:9088
    v_mfma_f32_16x16x32_bf16 v[136:139], a[68:71], a[136:139], v[136:139]
    buffer_load_dwordx4 v230, s[56:59], s34 offen offset:1024 sc1 lds
    v_mfma_f32_16x16x32_bf16 v[132:135], a[68:71], a[132:135], v[132:135]
    ds_read_b64_tr_b16 a[8:9], v227 offset:32
    v_mfma_f32_16x16x32_bf16 v[128:131], a[68:71], a[128:131], v[128:131]
    ds_read_b64_tr_b16 a[10:11], v227 offset:1824
    v_mfma_f32_16x16x32_bf16 v[32:35], a[72:75], a[128:131], v[32:35]
    ds_read_b64_tr_b16 a[12:13], v227 offset:7328
    v_mfma_f32_16x16x32_bf16 v[36:39], a[72:75], a[132:135], v[36:39]
    ds_read_b64_tr_b16 a[14:15], v227 offset:9120
    v_mfma_f32_16x16x32_bf16 v[40:43], a[72:75], a[136:139], v[40:43]
    v_mfma_f32_16x16x32_bf16 v[44:47], a[72:75], a[140:143], v[44:47]
    ds_read_b64_tr_b16 a[16:17], v227 offset:64
    buffer_load_dwordx4 v230, s[56:59], s34 offen offset:2048 sc1 lds
    v_mfma_f32_16x16x32_bf16 v[156:159], a[76:79], a[140:143], v[156:159]
    ds_read_b64_tr_b16 a[18:19], v227 offset:1856
    v_mfma_f32_16x16x32_bf16 v[152:155], a[76:79], a[136:139], v[152:155]
    ds_read_b64_tr_b16 a[20:21], v227 offset:7360
    v_mfma_f32_16x16x32_bf16 v[148:151], a[76:79], a[132:135], v[148:151]
    ds_read_b64_tr_b16 a[22:23], v227 offset:9152
    v_mfma_f32_16x16x32_bf16 v[144:147], a[76:79], a[128:131], v[144:147]
    v_mfma_f32_16x16x32_bf16 v[48:51], a[80:83], a[128:131], v[48:51]
    ds_read_b64_tr_b16 a[24:25], v227 offset:96
    v_mfma_f32_16x16x32_bf16 v[52:55], a[80:83], a[132:135], v[52:55]
    ds_read_b64_tr_b16 a[26:27], v227 offset:1888
    buffer_load_dwordx4 v230, s[56:59], s34 offen offset:3072 sc1 lds
    v_mfma_f32_16x16x32_bf16 v[56:59], a[80:83], a[136:139], v[56:59]
    ds_read_b64_tr_b16 a[28:29], v227 offset:7392
    v_mfma_f32_16x16x32_bf16 v[60:63], a[80:83], a[140:143], v[60:63]
    ds_read_b64_tr_b16 a[30:31], v227 offset:9184
    s_add_u32 s34, s34, 16384
    v_mfma_f32_16x16x32_bf16 v[172:175], a[84:87], a[140:143], v[172:175]
    v_mfma_f32_16x16x32_bf16 v[168:171], a[84:87], a[136:139], v[168:171]
    ds_read_b64_tr_b16 a[32:33], v227 offset:128
    s_add_u32 m0, s37, s33
    v_mfma_f32_16x16x32_bf16 v[164:167], a[84:87], a[132:135], v[164:167]
    ds_read_b64_tr_b16 a[34:35], v227 offset:1920
    v_mfma_f32_16x16x32_bf16 v[160:163], a[84:87], a[128:131], v[160:163]
    ds_read_b64_tr_b16 a[36:37], v227 offset:7424
    v_mfma_f32_16x16x32_bf16 v[64:67], a[88:91], a[128:131], v[64:67]
    ds_read_b64_tr_b16 a[38:39], v227 offset:9216
    v_mfma_f32_16x16x32_bf16 v[68:71], a[88:91], a[132:135], v[68:71]
    buffer_load_dwordx4 v232, s[28:31], s35 offen offset:0 lds
    v_mfma_f32_16x16x32_bf16 v[72:75], a[88:91], a[136:139], v[72:75]
    ds_read_b64_tr_b16 a[40:41], v227 offset:160
    v_mfma_f32_16x16x32_bf16 v[76:79], a[88:91], a[140:143], v[76:79]
    ds_read_b64_tr_b16 a[42:43], v227 offset:1952
    v_mfma_f32_16x16x32_bf16 v[188:191], a[92:95], a[140:143], v[188:191]
    ds_read_b64_tr_b16 a[44:45], v227 offset:7456
    v_mfma_f32_16x16x32_bf16 v[184:187], a[92:95], a[136:139], v[184:187]
    ds_read_b64_tr_b16 a[46:47], v227 offset:9248
    v_mfma_f32_16x16x32_bf16 v[180:183], a[92:95], a[132:135], v[180:183]
    v_mfma_f32_16x16x32_bf16 v[176:179], a[92:95], a[128:131], v[176:179]
    ds_read_b64_tr_b16 a[48:49], v227 offset:192
    buffer_load_dwordx4 v233, s[28:31], s35 offen offset:1024 lds
    v_mfma_f32_16x16x32_bf16 v[80:83], a[96:99], a[128:131], v[80:83]
    ds_read_b64_tr_b16 a[50:51], v227 offset:1984
    v_mfma_f32_16x16x32_bf16 v[84:87], a[96:99], a[132:135], v[84:87]
    ds_read_b64_tr_b16 a[52:53], v227 offset:7488
    v_mfma_f32_16x16x32_bf16 v[88:91], a[96:99], a[136:139], v[88:91]
    ds_read_b64_tr_b16 a[54:55], v227 offset:9280
    v_mfma_f32_16x16x32_bf16 v[92:95], a[96:99], a[140:143], v[92:95]
    v_mfma_f32_16x16x32_bf16 v[204:207], a[100:103], a[140:143], v[204:207]
    v_mfma_f32_16x16x32_bf16 v[200:203], a[100:103], a[136:139], v[200:203]
    buffer_load_dwordx4 v234, s[28:31], s35 offen offset:2048 lds
    v_mfma_f32_16x16x32_bf16 v[196:199], a[100:103], a[132:135], v[196:199]
    v_mfma_f32_16x16x32_bf16 v[192:195], a[100:103], a[128:131], v[192:195]
    v_mfma_f32_16x16x32_bf16 v[96:99], a[104:107], a[128:131], v[96:99]
    v_mfma_f32_16x16x32_bf16 v[100:103], a[104:107], a[132:135], v[100:103]
    v_mfma_f32_16x16x32_bf16 v[104:107], a[104:107], a[136:139], v[104:107]
    v_mfma_f32_16x16x32_bf16 v[108:111], a[104:107], a[140:143], v[108:111]
    buffer_load_dwordx4 v235, s[28:31], s35 offen offset:3072 lds
    v_mfma_f32_16x16x32_bf16 v[220:223], a[108:111], a[140:143], v[220:223]
    v_mfma_f32_16x16x32_bf16 v[216:219], a[108:111], a[136:139], v[216:219]
    s_add_u32 s35, s35, 229376
    s_add_u32 s37, s37, 30848
    s_cmp_eq_u32 s37, 154240
    s_cselect_b32 s37, 0, s37
    v_mfma_f32_16x16x32_bf16 v[212:215], a[108:111], a[132:135], v[212:215]
    v_mfma_f32_16x16x32_bf16 v[208:211], a[108:111], a[128:131], v[208:211]
    s_add_u32 s36, s36, 30848
    s_cmp_eq_u32 s36, 154240
    s_cselect_b32 s36, 0, s36
    buffer_load_ubyte v224, v231, s[28:31], s55 offen
    buffer_load_ubyte v224, v254, s[28:31], s55 offen
    s_mov_b32 s38, 2
L_b_g1a:
    s_waitcnt lgkmcnt(0)
    v_mfma_f32_16x16x32_bf16 v[0:3], a[0:3], a[112:115], v[0:3]
    v_mfma_f32_16x16x32_bf16 v[4:7], a[0:3], a[116:119], v[4:7]
    v_mfma_f32_16x16x32_bf16 v[8:11], a[0:3], a[120:123], v[8:11]
    v_mfma_f32_16x16x32_bf16 v[12:15], a[0:3], a[124:127], v[12:15]
    s_waitcnt vmcnt(24)
    s_barrier
    v_add_u32 v226, s36, v228
    v_add_u32 v227, s36, v229
    v_mfma_f32_16x16x32_bf16 v[124:127], a[4:7], a[124:127], v[124:127]
    ds_read_b128 a[128:131], v226 offset:0
    v_mfma_f32_16x16x32_bf16 v[120:123], a[4:7], a[120:123], v[120:123]
    ds_read_b128 a[132:135], v226 offset:256
    s_add_u32 m0, s37, s32
    v_mfma_f32_16x16x32_bf16 v[116:119], a[4:7], a[116:119], v[116:119]
    ds_read_b128 a[136:139], v226 offset:512
    v_mfma_f32_16x16x32_bf16 v[112:115], a[4:7], a[112:115], v[112:115]
    ds_read_b128 a[140:143], v226 offset:768
    buffer_load_dwordx4 v230, s[56:59], s34 offen offset:0 sc1 lds
    v_mfma_f32_16x16x32_bf16 v[16:19], a[8:11], a[112:115], v[16:19]
    v_mfma_f32_16x16x32_bf16 v[20:23], a[8:11], a[116:119], v[20:23]
    ds_read_b64_tr_b16 a[56:57], v227 offset:0
    v_mfma_f32_16x16x32_bf16 v[24:27], a[8:11], a[120:123], v[24:27]
    ds_read_b64_tr_b16 a[58:59], v227 offset:1792
    v_mfma_f32_16x16x32_bf16 v[28:31], a[8:11], a[124:127], v[28:31]
    ds_read_b64_tr_b16 a[60:61], v227 offset:7296
    v_mfma_f32_16x16x32_bf16 v[140:143], a[12:15], a[124:127], v[140:143]
    ds_read_b64_tr_b16 a[62:63], v227 offset:9088
    v_mfma_f32_16x16x32_bf16 v[136:139], a[12:15], a[120:123], v[136:139]
    buffer_load_dwordx4 v230, s[56:59], s34 offen offset:1024 sc1 lds
    v_mfma_f32_16x16x32_bf16 v[132:135], a[12:15], a[116:119], v[132:135]
    ds_read_b64_tr_b16 a[64:65], v227 offset:32
    v_mfma_f32_16x16x32_bf16 v[128:131], a[12:15], a[112:115], v[128:131]
    ds_read_b64_tr_b16 a[66:67], v227 offset:1824
    v_mfma_f32_16x16x32_bf16 v[32:35], a[16:19], a[112:115], v[32:35]
    ds_read_b64_tr_b16 a[68:69], v227 offset:7328
    v_mfma_f32_16x16x32_bf16 v[36:39], a[16:19], a[116:119], v[36:39]
    ds_read_b64_tr_b16 a[70:71], v227 offset:9120
    v_mfma_f32_16x16x32_bf16 v[40:43], a[16:19], a[120:123], v[40:43]
    v_mfma_f32_16x16x32_bf16 v[44:47], a[16:19], a[124:127], v[44:47]
    ds_read_b64_tr_b16 a[72:73], v227 offset:64
    buffer_load_dwordx4 v230, s[56:59], s34 offen offset:2048 sc1 lds
    v_mfma_f32_16x16x32_bf16 v[156:159], a[20:23], a[124:127], v[156:159]
    ds_read_b64_tr_b16 a[74:75], v227 offset:1856
    v_mfma_f32_16x16x32_bf16 v[152:155], a[20:23], a[120:123], v[152:155]
    ds_read_b64_tr_b16 a[76:77], v227 offset:7360
    v_mfma_f32_16x16x32_bf16 v[148:151], a[20:23], a[116:119], v[148:151]
    ds_read_b64_tr_b16 a[78:79], v227 offset:9152
    v_mfma_f32_16x16x32_bf16 v[144:147], a[20:23], a[112:115], v[144:147]
    v_mfma_f32_16x16x32_bf16 v[48:51], a[24:27], a[112:115], v[48:51]
    ds_read_b64_tr_b16 a[80:81], v227 offset:96
    v_mfma_f32_16x16x32_bf16 v[52:55], a[24:27], a[116:119], v[52:55]
    ds_read_b64_tr_b16 a[82:83], v227 offset:1888
    buffer_load_dwordx4 v230, s[56:59], s34 offen offset:3072 sc1 lds
    v_mfma_f32_16x16x32_bf16 v[56:59], a[24:27], a[120:123], v[56:59]
    ds_read_b64_tr_b16 a[84:85], v227 offset:7392
    v_mfma_f32_16x16x32_bf16 v[60:63], a[24:27], a[124:127], v[60:63]
    ds_read_b64_tr_b16 a[86:87], v227 offset:9184
    s_add_u32 s34, s34, 16384
    v_mfma_f32_16x16x32_bf16 v[172:175], a[28:31], a[124:127], v[172:175]
    v_mfma_f32_16x16x32_bf16 v[168:171], a[28:31], a[120:123], v[168:171]
    ds_read_b64_tr_b16 a[88:89], v227 offset:128
    s_add_u32 m0, s37, s33
    v_mfma_f32_16x16x32_bf16 v[164:167], a[28:31], a[116:119], v[164:167]
    ds_read_b64_tr_b16 a[90:91], v227 offset:1920
    v_mfma_f32_16x16x32_bf16 v[160:163], a[28:31], a[112:115], v[160:163]
    ds_read_b64_tr_b16 a[92:93], v227 offset:7424
    v_mfma_f32_16x16x32_bf16 v[64:67], a[32:35], a[112:115], v[64:67]
    ds_read_b64_tr_b16 a[94:95], v227 offset:9216
    v_mfma_f32_16x16x32_bf16 v[68:71], a[32:35], a[116:119], v[68:71]
    buffer_load_dwordx4 v232, s[28:31], s35 offen offset:0 lds
    v_mfma_f32_16x16x32_bf16 v[72:75], a[32:35], a[120:123], v[72:75]
    ds_read_b64_tr_b16 a[96:97], v227 offset:160
    v_mfma_f32_16x16x32_bf16 v[76:79], a[32:35], a[124:127], v[76:79]
    ds_read_b64_tr_b16 a[98:99], v227 offset:1952
    v_mfma_f32_16x16x32_bf16 v[188:191], a[36:39], a[124:127], v[188:191]
    ds_read_b64_tr_b16 a[100:101], v227 offset:7456
    v_mfma_f32_16x16x32_bf16 v[184:187], a[36:39], a[120:123], v[184:187]
    ds_read_b64_tr_b16 a[102:103], v227 offset:9248
    v_mfma_f32_16x16x32_bf16 v[180:183], a[36:39], a[116:119], v[180:183]
    v_mfma_f32_16x16x32_bf16 v[176:179], a[36:39], a[112:115], v[176:179]
    ds_read_b64_tr_b16 a[104:105], v227 offset:192
    buffer_load_dwordx4 v233, s[28:31], s35 offen offset:1024 lds
    v_mfma_f32_16x16x32_bf16 v[80:83], a[40:43], a[112:115], v[80:83]
    ds_read_b64_tr_b16 a[106:107], v227 offset:1984
    v_mfma_f32_16x16x32_bf16 v[84:87], a[40:43], a[116:119], v[84:87]
    ds_read_b64_tr_b16 a[108:109], v227 offset:7488
    v_mfma_f32_16x16x32_bf16 v[88:91], a[40:43], a[120:123], v[88:91]
    ds_read_b64_tr_b16 a[110:111], v227 offset:9280
    v_mfma_f32_16x16x32_bf16 v[92:95], a[40:43], a[124:127], v[92:95]
    v_mfma_f32_16x16x32_bf16 v[204:207], a[44:47], a[124:127], v[204:207]
    v_mfma_f32_16x16x32_bf16 v[200:203], a[44:47], a[120:123], v[200:203]
    buffer_load_dwordx4 v234, s[28:31], s35 offen offset:2048 lds
    v_mfma_f32_16x16x32_bf16 v[196:199], a[44:47], a[116:119], v[196:199]
    v_mfma_f32_16x16x32_bf16 v[192:195], a[44:47], a[112:115], v[192:195]
    v_mfma_f32_16x16x32_bf16 v[96:99], a[48:51], a[112:115], v[96:99]
    v_mfma_f32_16x16x32_bf16 v[100:103], a[48:51], a[116:119], v[100:103]
    v_mfma_f32_16x16x32_bf16 v[104:107], a[48:51], a[120:123], v[104:107]
    v_mfma_f32_16x16x32_bf16 v[108:111], a[48:51], a[124:127], v[108:111]
    buffer_load_dwordx4 v235, s[28:31], s35 offen offset:3072 lds
    v_mfma_f32_16x16x32_bf16 v[220:223], a[52:55], a[124:127], v[220:223]
    v_mfma_f32_16x16x32_bf16 v[216:219], a[52:55], a[120:123], v[216:219]
    s_add_u32 s35, s35, 229376
    s_add_u32 s37, s37, 30848
    s_cmp_eq_u32 s37, 154240
    s_cselect_b32 s37, 0, s37
    v_mfma_f32_16x16x32_bf16 v[212:215], a[52:55], a[116:119], v[212:215]
    v_mfma_f32_16x16x32_bf16 v[208:211], a[52:55], a[112:115], v[208:211]
    s_add_u32 s36, s36, 30848
    s_cmp_eq_u32 s36, 154240
    s_cselect_b32 s36, 0, s36
    s_waitcnt lgkmcnt(0)
    v_mfma_f32_16x16x32_bf16 v[0:3], a[56:59], a[128:131], v[0:3]
    v_mfma_f32_16x16x32_bf16 v[4:7], a[56:59], a[132:135], v[4:7]
    v_mfma_f32_16x16x32_bf16 v[8:11], a[56:59], a[136:139], v[8:11]
    v_mfma_f32_16x16x32_bf16 v[12:15], a[56:59], a[140:143], v[12:15]
    s_waitcnt vmcnt(24)
    s_barrier
    v_add_u32 v226, s36, v228
    v_add_u32 v227, s36, v229
    v_mfma_f32_16x16x32_bf16 v[124:127], a[60:63], a[140:143], v[124:127]
    ds_read_b128 a[112:115], v226 offset:0
    v_mfma_f32_16x16x32_bf16 v[120:123], a[60:63], a[136:139], v[120:123]
    ds_read_b128 a[116:119], v226 offset:256
    s_add_u32 m0, s37, s32
    v_mfma_f32_16x16x32_bf16 v[116:119], a[60:63], a[132:135], v[116:119]
    ds_read_b128 a[120:123], v226 offset:512
    v_mfma_f32_16x16x32_bf16 v[112:115], a[60:63], a[128:131], v[112:115]
    ds_read_b128 a[124:127], v226 offset:768
    buffer_load_dwordx4 v230, s[56:59], s34 offen offset:0 sc1 lds
    v_mfma_f32_16x16x32_bf16 v[16:19], a[64:67], a[128:131], v[16:19]
    v_mfma_f32_16x16x32_bf16 v[20:23], a[64:67], a[132:135], v[20:23]
    ds_read_b64_tr_b16 a[0:1], v227 offset:0
    v_mfma_f32_16x16x32_bf16 v[24:27], a[64:67], a[136:139], v[24:27]
    ds_read_b64_tr_b16 a[2:3], v227 offset:1792
    v_mfma_f32_16x16x32_bf16 v[28:31], a[64:67], a[140:143], v[28:31]
    ds_read_b64_tr_b16 a[4:5], v227 offset:7296
    v_mfma_f32_16x16x32_bf16 v[140:143], a[68:71], a[140:143], v[140:143]
    ds_read_b64_tr_b16 a[6:7], v227 offset:9088
    v_mfma_f32_16x16x32_bf16 v[136:139], a[68:71], a[136:139], v[136:139]
    buffer_load_dwordx4 v230, s[56:59], s34 offen offset:1024 sc1 lds
    v_mfma_f32_16x16x32_bf16 v[132:135], a[68:71], a[132:135], v[132:135]
    ds_read_b64_tr_b16 a[8:9], v227 offset:32
    v_mfma_f32_16x16x32_bf16 v[128:131], a[68:71], a[128:131], v[128:131]
    ds_read_b64_tr_b16 a[10:11], v227 offset:1824
    v_mfma_f32_16x16x32_bf16 v[32:35], a[72:75], a[128:131], v[32:35]
    ds_read_b64_tr_b16 a[12:13], v227 offset:7328
    v_mfma_f32_16x16x32_bf16 v[36:39], a[72:75], a[132:135], v[36:39]
    ds_read_b64_tr_b16 a[14:15], v227 offset:9120
    v_mfma_f32_16x16x32_bf16 v[40:43], a[72:75], a[136:139], v[40:43]
    v_mfma_f32_16x16x32_bf16 v[44:47], a[72:75], a[140:143], v[44:47]
    ds_read_b64_tr_b16 a[16:17], v227 offset:64
    buffer_load_dwordx4 v230, s[56:59], s34 offen offset:2048 sc1 lds
    v_mfma_f32_16x16x32_bf16 v[156:159], a[76:79], a[140:143], v[156:159]
    ds_read_b64_tr_b16 a[18:19], v227 offset:1856
    v_mfma_f32_16x16x32_bf16 v[152:155], a[76:79], a[136:139], v[152:155]
    ds_read_b64_tr_b16 a[20:21], v227 offset:7360
    v_mfma_f32_16x16x32_bf16 v[148:151], a[76:79], a[132:135], v[148:151]
    ds_read_b64_tr_b16 a[22:23], v227 offset:9152
    v_mfma_f32_16x16x32_bf16 v[144:147], a[76:79], a[128:131], v[144:147]
    v_mfma_f32_16x16x32_bf16 v[48:51], a[80:83], a[128:131], v[48:51]
    ds_read_b64_tr_b16 a[24:25], v227 offset:96
    v_mfma_f32_16x16x32_bf16 v[52:55], a[80:83], a[132:135], v[52:55]
    ds_read_b64_tr_b16 a[26:27], v227 offset:1888
    buffer_load_dwordx4 v230, s[56:59], s34 offen offset:3072 sc1 lds
    v_mfma_f32_16x16x32_bf16 v[56:59], a[80:83], a[136:139], v[56:59]
    ds_read_b64_tr_b16 a[28:29], v227 offset:7392
    v_mfma_f32_16x16x32_bf16 v[60:63], a[80:83], a[140:143], v[60:63]
    ds_read_b64_tr_b16 a[30:31], v227 offset:9184
    s_add_u32 s34, s34, 16384
    v_mfma_f32_16x16x32_bf16 v[172:175], a[84:87], a[140:143], v[172:175]
    v_mfma_f32_16x16x32_bf16 v[168:171], a[84:87], a[136:139], v[168:171]
    ds_read_b64_tr_b16 a[32:33], v227 offset:128
    s_add_u32 m0, s37, s33
    v_mfma_f32_16x16x32_bf16 v[164:167], a[84:87], a[132:135], v[164:167]
    ds_read_b64_tr_b16 a[34:35], v227 offset:1920
    v_mfma_f32_16x16x32_bf16 v[160:163], a[84:87], a[128:131], v[160:163]
    ds_read_b64_tr_b16 a[36:37], v227 offset:7424
    v_mfma_f32_16x16x32_bf16 v[64:67], a[88:91], a[128:131], v[64:67]
    ds_read_b64_tr_b16 a[38:39], v227 offset:9216
    v_mfma_f32_16x16x32_bf16 v[68:71], a[88:91], a[132:135], v[68:71]
    buffer_load_dwordx4 v232, s[28:31], s35 offen offset:0 lds
    v_mfma_f32_16x16x32_bf16 v[72:75], a[88:91], a[136:139], v[72:75]
    ds_read_b64_tr_b16 a[40:41], v227 offset:160
    v_mfma_f32_16x16x32_bf16 v[76:79], a[88:91], a[140:143], v[76:79]
    ds_read_b64_tr_b16 a[42:43], v227 offset:1952
    v_mfma_f32_16x16x32_bf16 v[188:191], a[92:95], a[140:143], v[188:191]
    ds_read_b64_tr_b16 a[44:45], v227 offset:7456
    v_mfma_f32_16x16x32_bf16 v[184:187], a[92:95], a[136:139], v[184:187]
    ds_read_b64_tr_b16 a[46:47], v227 offset:9248
    v_mfma_f32_16x16x32_bf16 v[180:183], a[92:95], a[132:135], v[180:183]
    v_mfma_f32_16x16x32_bf16 v[176:179], a[92:95], a[128:131], v[176:179]
    ds_read_b64_tr_b16 a[48:49], v227 offset:192
    buffer_load_dwordx4 v233, s[28:31], s35 offen offset:1024 lds
    v_mfma_f32_16x16x32_bf16 v[80:83], a[96:99], a[128:131], v[80:83]
    ds_read_b64_tr_b16 a[50:51], v227 offset:1984
    v_mfma_f32_16x16x32_bf16 v[84:87], a[96:99], a[132:135], v[84:87]
    ds_read_b64_tr_b16 a[52:53], v227 offset:7488
    v_mfma_f32_16x16x32_bf16 v[88:91], a[96:99], a[136:139], v[88:91]
    ds_read_b64_tr_b16 a[54:55], v227 offset:9280
    v_mfma_f32_16x16x32_bf16 v[92:95], a[96:99], a[140:143], v[92:95]
    v_mfma_f32_16x16x32_bf16 v[204:207], a[100:103], a[140:143], v[204:207]
    v_mfma_f32_16x16x32_bf16 v[200:203], a[100:103], a[136:139], v[200:203]
    buffer_load_dwordx4 v234, s[28:31], s35 offen offset:2048 lds
    v_mfma_f32_16x16x32_bf16 v[196:199], a[100:103], a[132:135], v[196:199]
    v_mfma_f32_16x16x32_bf16 v[192:195], a[100:103], a[128:131], v[192:195]
    v_mfma_f32_16x16x32_bf16 v[96:99], a[104:107], a[128:131], v[96:99]
    v_mfma_f32_16x16x32_bf16 v[100:103], a[104:107], a[132:135], v[100:103]
    v_mfma_f32_16x16x32_bf16 v[104:107], a[104:107], a[136:139], v[104:107]
    v_mfma_f32_16x16x32_bf16 v[108:111], a[104:107], a[140:143], v[108:111]
    buffer_load_dwordx4 v235, s[28:31], s35 offen offset:3072 lds
    v_mfma_f32_16x16x32_bf16 v[220:223], a[108:111], a[140:143], v[220:223]
    v_mfma_f32_16x16x32_bf16 v[216:219], a[108:111], a[136:139], v[216:219]
    s_add_u32 s35, s35, 229376
    s_add_u32 s37, s37, 30848
    s_cmp_eq_u32 s37, 154240
    s_cselect_b32 s37, 0, s37
    v_mfma_f32_16x16x32_bf16 v[212:215], a[108:111], a[132:135], v[212:215]
    v_mfma_f32_16x16x32_bf16 v[208:211], a[108:111], a[128:131], v[208:211]
    s_add_u32 s36, s36, 30848
    s_cmp_eq_u32 s36, 154240
    s_cselect_b32 s36, 0, s36
    s_sub_u32 s38, s38, 1
    s_cmp_lg_u32 s38, 0
    s_cbranch_scc1 L_b_g1a
    s_waitcnt lgkmcnt(0)
    v_mfma_f32_16x16x32_bf16 v[0:3], a[0:3], a[112:115], v[0:3]
    v_mfma_f32_16x16x32_bf16 v[4:7], a[0:3], a[116:119], v[4:7]
    v_mfma_f32_16x16x32_bf16 v[8:11], a[0:3], a[120:123], v[8:11]
    v_mfma_f32_16x16x32_bf16 v[12:15], a[0:3], a[124:127], v[12:15]
    s_waitcnt vmcnt(24)
    s_barrier
    v_add_u32 v226, s36, v228
    v_add_u32 v227, s36, v229
    v_mfma_f32_16x16x32_bf16 v[124:127], a[4:7], a[124:127], v[124:127]
    ds_read_b128 a[128:131], v226 offset:0
    v_mfma_f32_16x16x32_bf16 v[120:123], a[4:7], a[120:123], v[120:123]
    ds_read_b128 a[132:135], v226 offset:256
    s_add_u32 m0, s37, s32
    v_mfma_f32_16x16x32_bf16 v[116:119], a[4:7], a[116:119], v[116:119]
    ds_read_b128 a[136:139], v226 offset:512
    v_mfma_f32_16x16x32_bf16 v[112:115], a[4:7], a[112:115], v[112:115]
    ds_read_b128 a[140:143], v226 offset:768
    buffer_load_dwordx4 v230, s[56:59], s34 offen offset:0 sc1 lds
    v_mfma_f32_16x16x32_bf16 v[16:19], a[8:11], a[112:115], v[16:19]
    v_mfma_f32_16x16x32_bf16 v[20:23], a[8:11], a[116:119], v[20:23]
    ds_read_b64_tr_b16 a[56:57], v227 offset:0
    v_mfma_f32_16x16x32_bf16 v[24:27], a[8:11], a[120:123], v[24:27]
    ds_read_b64_tr_b16 a[58:59], v227 offset:1792
    v_mfma_f32_16x16x32_bf16 v[28:31], a[8:11], a[124:127], v[28:31]
    ds_read_b64_tr_b16 a[60:61], v227 offset:7296
    v_mfma_f32_16x16x32_bf16 v[140:143], a[12:15], a[124:127], v[140:143]
    ds_read_b64_tr_b16 a[62:63], v227 offset:9088
    v_mfma_f32_16x16x32_bf16 v[136:139], a[12:15], a[120:123], v[136:139]
    buffer_load_dwordx4 v230, s[56:59], s34 offen offset:1024 sc1 lds
    v_mfma_f32_16x16x32_bf16 v[132:135], a[12:15], a[116:119], v[132:135]
    ds_read_b64_tr_b16 a[64:65], v227 offset:32
    v_mfma_f32_16x16x32_bf16 v[128:131], a[12:15], a[112:115], v[128:131]
    ds_read_b64_tr_b16 a[66:67], v227 offset:1824
    v_mfma_f32_16x16x32_bf16 v[32:35], a[16:19], a[112:115], v[32:35]
    ds_read_b64_tr_b16 a[68:69], v227 offset:7328
    v_mfma_f32_16x16x32_bf16 v[36:39], a[16:19], a[116:119], v[36:39]
    ds_read_b64_tr_b16 a[70:71], v227 offset:9120
    v_mfma_f32_16x16x32_bf16 v[40:43], a[16:19], a[120:123], v[40:43]
    v_mfma_f32_16x16x32_bf16 v[44:47], a[16:19], a[124:127], v[44:47]
    ds_read_b64_tr_b16 a[72:73], v227 offset:64
    buffer_load_dwordx4 v230, s[56:59], s34 offen offset:2048 sc1 lds
    v_mfma_f32_16x16x32_bf16 v[156:159], a[20:23], a[124:127], v[156:159]
    ds_read_b64_tr_b16 a[74:75], v227 offset:1856
    v_mfma_f32_16x16x32_bf16 v[152:155], a[20:23], a[120:123], v[152:155]
    ds_read_b64_tr_b16 a[76:77], v227 offset:7360
    v_mfma_f32_16x16x32_bf16 v[148:151], a[20:23], a[116:119], v[148:151]
    ds_read_b64_tr_b16 a[78:79], v227 offset:9152
    v_mfma_f32_16x16x32_bf16 v[144:147], a[20:23], a[112:115], v[144:147]
    v_mfma_f32_16x16x32_bf16 v[48:51], a[24:27], a[112:115], v[48:51]
    ds_read_b64_tr_b16 a[80:81], v227 offset:96
    v_mfma_f32_16x16x32_bf16 v[52:55], a[24:27], a[116:119], v[52:55]
    ds_read_b64_tr_b16 a[82:83], v227 offset:1888
    buffer_load_dwordx4 v230, s[56:59], s34 offen offset:3072 sc1 lds
    v_mfma_f32_16x16x32_bf16 v[56:59], a[24:27], a[120:123], v[56:59]
    ds_read_b64_tr_b16 a[84:85], v227 offset:7392
    v_mfma_f32_16x16x32_bf16 v[60:63], a[24:27], a[124:127], v[60:63]
    ds_read_b64_tr_b16 a[86:87], v227 offset:9184
    s_add_u32 s34, s34, 16384
    v_mfma_f32_16x16x32_bf16 v[172:175], a[28:31], a[124:127], v[172:175]
    v_mfma_f32_16x16x32_bf16 v[168:171], a[28:31], a[120:123], v[168:171]
    ds_read_b64_tr_b16 a[88:89], v227 offset:128
    s_add_u32 m0, s37, s33
    v_mfma_f32_16x16x32_bf16 v[164:167], a[28:31], a[116:119], v[164:167]
    ds_read_b64_tr_b16 a[90:91], v227 offset:1920
    v_mfma_f32_16x16x32_bf16 v[160:163], a[28:31], a[112:115], v[160:163]
    ds_read_b64_tr_b16 a[92:93], v227 offset:7424
    v_mfma_f32_16x16x32_bf16 v[64:67], a[32:35], a[112:115], v[64:67]
    ds_read_b64_tr_b16 a[94:95], v227 offset:9216
    v_mfma_f32_16x16x32_bf16 v[68:71], a[32:35], a[116:119], v[68:71]
    buffer_load_dwordx4 v232, s[28:31], s35 offen offset:0 lds
    v_mfma_f32_16x16x32_bf16 v[72:75], a[32:35], a[120:123], v[72:75]
    ds_read_b64_tr_b16 a[96:97], v227 offset:160
    v_mfma_f32_16x16x32_bf16 v[76:79], a[32:35], a[124:127], v[76:79]
    ds_read_b64_tr_b16 a[98:99], v227 offset:1952
    v_mfma_f32_16x16x32_bf16 v[188:191], a[36:39], a[124:127], v[188:191]
    ds_read_b64_tr_b16 a[100:101], v227 offset:7456
    v_mfma_f32_16x16x32_bf16 v[184:187], a[36:39], a[120:123], v[184:187]
    ds_read_b64_tr_b16 a[102:103], v227 offset:9248
    v_mfma_f32_16x16x32_bf16 v[180:183], a[36:39], a[116:119], v[180:183]
    v_mfma_f32_16x16x32_bf16 v[176:179], a[36:39], a[112:115], v[176:179]
    ds_read_b64_tr_b16 a[104:105], v227 offset:192
    buffer_load_dwordx4 v233, s[28:31], s35 offen offset:1024 lds
    v_mfma_f32_16x16x32_bf16 v[80:83], a[40:43], a[112:115], v[80:83]
    ds_read_b64_tr_b16 a[106:107], v227 offset:1984
    v_mfma_f32_16x16x32_bf16 v[84:87], a[40:43], a[116:119], v[84:87]
    ds_read_b64_tr_b16 a[108:109], v227 offset:7488
    v_mfma_f32_16x16x32_bf16 v[88:91], a[40:43], a[120:123], v[88:91]
    ds_read_b64_tr_b16 a[110:111], v227 offset:9280
    v_mfma_f32_16x16x32_bf16 v[92:95], a[40:43], a[124:127], v[92:95]
    v_mfma_f32_16x16x32_bf16 v[204:207], a[44:47], a[124:127], v[204:207]
    v_mfma_f32_16x16x32_bf16 v[200:203], a[44:47], a[120:123], v[200:203]
    buffer_load_dwordx4 v234, s[28:31], s35 offen offset:2048 lds
    v_mfma_f32_16x16x32_bf16 v[196:199], a[44:47], a[116:119], v[196:199]
    v_mfma_f32_16x16x32_bf16 v[192:195], a[44:47], a[112:115], v[192:195]
    v_mfma_f32_16x16x32_bf16 v[96:99], a[48:51], a[112:115], v[96:99]
    v_mfma_f32_16x16x32_bf16 v[100:103], a[48:51], a[116:119], v[100:103]
    v_mfma_f32_16x16x32_bf16 v[104:107], a[48:51], a[120:123], v[104:107]
    v_mfma_f32_16x16x32_bf16 v[108:111], a[48:51], a[124:127], v[108:111]
    buffer_load_dwordx4 v235, s[28:31], s35 offen offset:3072 lds
    v_mfma_f32_16x16x32_bf16 v[220:223], a[52:55], a[124:127], v[220:223]
    v_mfma_f32_16x16x32_bf16 v[216:219], a[52:55], a[120:123], v[216:219]
    s_add_u32 s35, s35, 229376
    s_add_u32 s37, s37, 30848
    s_cmp_eq_u32 s37, 154240
    s_cselect_b32 s37, 0, s37
    v_mfma_f32_16x16x32_bf16 v[212:215], a[52:55], a[116:119], v[212:215]
    v_mfma_f32_16x16x32_bf16 v[208:211], a[52:55], a[112:115], v[208:211]
    s_add_u32 s36, s36, 30848
    s_cmp_eq_u32 s36, 154240
    s_cselect_b32 s36, 0, s36
    s_waitcnt lgkmcnt(0)
    v_mfma_f32_16x16x32_bf16 v[0:3], a[56:59], a[128:131], v[0:3]
    v_mfma_f32_16x16x32_bf16 v[4:7], a[56:59], a[132:135], v[4:7]
    v_mfma_f32_16x16x32_bf16 v[8:11], a[56:59], a[136:139], v[8:11]
    v_mfma_f32_16x16x32_bf16 v[12:15], a[56:59], a[140:143], v[12:15]
    s_waitcnt vmcnt(24)
    s_barrier
    v_add_u32 v226, s36, v228
    v_add_u32 v227, s36, v229
    v_mfma_f32_16x16x32_bf16 v[124:127], a[60:63], a[140:143], v[124:127]
    ds_read_b128 a[112:115], v226 offset:0
    v_mfma_f32_16x16x32_bf16 v[120:123], a[60:63], a[136:139], v[120:123]
    ds_read_b128 a[116:119], v226 offset:256
    s_add_u32 m0, s37, s32
    v_mfma_f32_16x16x32_bf16 v[116:119], a[60:63], a[132:135], v[116:119]
    ds_read_b128 a[120:123], v226 offset:512
    v_mfma_f32_16x16x32_bf16 v[112:115], a[60:63], a[128:131], v[112:115]
    ds_read_b128 a[124:127], v226 offset:768
    buffer_load_dwordx4 v230, s[56:59], s34 offen offset:0 sc1 lds
    v_mfma_f32_16x16x32_bf16 v[16:19], a[64:67], a[128:131], v[16:19]
    v_mfma_f32_16x16x32_bf16 v[20:23], a[64:67], a[132:135], v[20:23]
    ds_read_b64_tr_b16 a[0:1], v227 offset:0
    v_mfma_f32_16x16x32_bf16 v[24:27], a[64:67], a[136:139], v[24:27]
    ds_read_b64_tr_b16 a[2:3], v227 offset:1792
    v_mfma_f32_16x16x32_bf16 v[28:31], a[64:67], a[140:143], v[28:31]
    ds_read_b64_tr_b16 a[4:5], v227 offset:7296
    v_mfma_f32_16x16x32_bf16 v[140:143], a[68:71], a[140:143], v[140:143]
    ds_read_b64_tr_b16 a[6:7], v227 offset:9088
    v_mfma_f32_16x16x32_bf16 v[136:139], a[68:71], a[136:139], v[136:139]
    buffer_load_dwordx4 v230, s[56:59], s34 offen offset:1024 sc1 lds
    v_mfma_f32_16x16x32_bf16 v[132:135], a[68:71], a[132:135], v[132:135]
    ds_read_b64_tr_b16 a[8:9], v227 offset:32
    v_mfma_f32_16x16x32_bf16 v[128:131], a[68:71], a[128:131], v[128:131]
    ds_read_b64_tr_b16 a[10:11], v227 offset:1824
    v_mfma_f32_16x16x32_bf16 v[32:35], a[72:75], a[128:131], v[32:35]
    ds_read_b64_tr_b16 a[12:13], v227 offset:7328
    v_mfma_f32_16x16x32_bf16 v[36:39], a[72:75], a[132:135], v[36:39]
    ds_read_b64_tr_b16 a[14:15], v227 offset:9120
    v_mfma_f32_16x16x32_bf16 v[40:43], a[72:75], a[136:139], v[40:43]
    v_mfma_f32_16x16x32_bf16 v[44:47], a[72:75], a[140:143], v[44:47]
    ds_read_b64_tr_b16 a[16:17], v227 offset:64
    buffer_load_dwordx4 v230, s[56:59], s34 offen offset:2048 sc1 lds
    v_mfma_f32_16x16x32_bf16 v[156:159], a[76:79], a[140:143], v[156:159]
    ds_read_b64_tr_b16 a[18:19], v227 offset:1856
    v_mfma_f32_16x16x32_bf16 v[152:155], a[76:79], a[136:139], v[152:155]
    ds_read_b64_tr_b16 a[20:21], v227 offset:7360
    v_mfma_f32_16x16x32_bf16 v[148:151], a[76:79], a[132:135], v[148:151]
    ds_read_b64_tr_b16 a[22:23], v227 offset:9152
    v_mfma_f32_16x16x32_bf16 v[144:147], a[76:79], a[128:131], v[144:147]
    v_mfma_f32_16x16x32_bf16 v[48:51], a[80:83], a[128:131], v[48:51]
    ds_read_b64_tr_b16 a[24:25], v227 offset:96
    v_mfma_f32_16x16x32_bf16 v[52:55], a[80:83], a[132:135], v[52:55]
    ds_read_b64_tr_b16 a[26:27], v227 offset:1888
    buffer_load_dwordx4 v230, s[56:59], s34 offen offset:3072 sc1 lds
    v_mfma_f32_16x16x32_bf16 v[56:59], a[80:83], a[136:139], v[56:59]
    ds_read_b64_tr_b16 a[28:29], v227 offset:7392
    v_mfma_f32_16x16x32_bf16 v[60:63], a[80:83], a[140:143], v[60:63]
    ds_read_b64_tr_b16 a[30:31], v227 offset:9184
    s_add_u32 s34, s34, 16384
    v_mfma_f32_16x16x32_bf16 v[172:175], a[84:87], a[140:143], v[172:175]
    v_mfma_f32_16x16x32_bf16 v[168:171], a[84:87], a[136:139], v[168:171]
    ds_read_b64_tr_b16 a[32:33], v227 offset:128
    s_add_u32 m0, s37, s33
    v_mfma_f32_16x16x32_bf16 v[164:167], a[84:87], a[132:135], v[164:167]
    ds_read_b64_tr_b16 a[34:35], v227 offset:1920
    v_mfma_f32_16x16x32_bf16 v[160:163], a[84:87], a[128:131], v[160:163]
    ds_read_b64_tr_b16 a[36:37], v227 offset:7424
    v_mfma_f32_16x16x32_bf16 v[64:67], a[88:91], a[128:131], v[64:67]
    ds_read_b64_tr_b16 a[38:39], v227 offset:9216
    v_mfma_f32_16x16x32_bf16 v[68:71], a[88:91], a[132:135], v[68:71]
    buffer_load_dwordx4 v232, s[28:31], s35 offen offset:0 lds
    v_mfma_f32_16x16x32_bf16 v[72:75], a[88:91], a[136:139], v[72:75]
    ds_read_b64_tr_b16 a[40:41], v227 offset:160
    v_mfma_f32_16x16x32_bf16 v[76:79], a[88:91], a[140:143], v[76:79]
    ds_read_b64_tr_b16 a[42:43], v227 offset:1952
    v_mfma_f32_16x16x32_bf16 v[188:191], a[92:95], a[140:143], v[188:191]
    ds_read_b64_tr_b16 a[44:45], v227 offset:7456
    v_mfma_f32_16x16x32_bf16 v[184:187], a[92:95], a[136:139], v[184:187]
    ds_read_b64_tr_b16 a[46:47], v227 offset:9248
    v_mfma_f32_16x16x32_bf16 v[180:183], a[92:95], a[132:135], v[180:183]
    v_mfma_f32_16x16x32_bf16 v[176:179], a[92:95], a[128:131], v[176:179]
    ds_read_b64_tr_b16 a[48:49], v227 offset:192
    buffer_load_dwordx4 v233, s[28:31], s35 offen offset:1024 lds
    v_mfma_f32_16x16x32_bf16 v[80:83], a[96:99], a[128:131], v[80:83]
    ds_read_b64_tr_b16 a[50:51], v227 offset:1984
    v_mfma_f32_16x16x32_bf16 v[84:87], a[96:99], a[132:135], v[84:87]
    ds_read_b64_tr_b16 a[52:53], v227 offset:7488
    v_mfma_f32_16x16x32_bf16 v[88:91], a[96:99], a[136:139], v[88:91]
    ds_read_b64_tr_b16 a[54:55], v227 offset:9280
    v_mfma_f32_16x16x32_bf16 v[92:95], a[96:99], a[140:143], v[92:95]
    v_mfma_f32_16x16x32_bf16 v[204:207], a[100:103], a[140:143], v[204:207]
    v_mfma_f32_16x16x32_bf16 v[200:203], a[100:103], a[136:139], v[200:203]
    buffer_load_dwordx4 v234, s[28:31], s35 offen offset:2048 lds
    v_mfma_f32_16x16x32_bf16 v[196:199], a[100:103], a[132:135], v[196:199]
    v_mfma_f32_16x16x32_bf16 v[192:195], a[100:103], a[128:131], v[192:195]
    v_mfma_f32_16x16x32_bf16 v[96:99], a[104:107], a[128:131], v[96:99]
    v_mfma_f32_16x16x32_bf16 v[100:103], a[104:107], a[132:135], v[100:103]
    v_mfma_f32_16x16x32_bf16 v[104:107], a[104:107], a[136:139], v[104:107]
    v_mfma_f32_16x16x32_bf16 v[108:111], a[104:107], a[140:143], v[108:111]
    buffer_load_dwordx4 v235, s[28:31], s35 offen offset:3072 lds
    v_mfma_f32_16x16x32_bf16 v[220:223], a[108:111], a[140:143], v[220:223]
    v_mfma_f32_16x16x32_bf16 v[216:219], a[108:111], a[136:139], v[216:219]
    s_add_u32 s35, s35, 229376
    s_add_u32 s37, s37, 30848
    s_cmp_eq_u32 s37, 154240
    s_cselect_b32 s37, 0, s37
    v_mfma_f32_16x16x32_bf16 v[212:215], a[108:111], a[132:135], v[212:215]
    v_mfma_f32_16x16x32_bf16 v[208:211], a[108:111], a[128:131], v[208:211]
    s_add_u32 s36, s36, 30848
    s_cmp_eq_u32 s36, 154240
    s_cselect_b32 s36, 0, s36
    s_mov_b32 s38, 8
L_b_g1b:
    s_waitcnt lgkmcnt(0)
    v_mfma_f32_16x16x32_bf16 v[0:3], a[0:3], a[112:115], v[0:3]
    v_mfma_f32_16x16x32_bf16 v[4:7], a[0:3], a[116:119], v[4:7]
    v_mfma_f32_16x16x32_bf16 v[8:11], a[0:3], a[120:123], v[8:11]
    v_mfma_f32_16x16x32_bf16 v[12:15], a[0:3], a[124:127], v[12:15]
    s_waitcnt vmcnt(24)
    s_barrier
    v_add_u32 v226, s36, v228
    v_add_u32 v227, s36, v229
    v_mfma_f32_16x16x32_bf16 v[124:127], a[4:7], a[124:127], v[124:127]
    ds_read_b128 a[128:131], v226 offset:0
    v_mfma_f32_16x16x32_bf16 v[120:123], a[4:7], a[120:123], v[120:123]
    ds_read_b128 a[132:135], v226 offset:256
    s_add_u32 m0, s37, s32
    v_mfma_f32_16x16x32_bf16 v[116:119], a[4:7], a[116:119], v[116:119]
    ds_read_b128 a[136:139], v226 offset:512
    v_mfma_f32_16x16x32_bf16 v[112:115], a[4:7], a[112:115], v[112:115]
    ds_read_b128 a[140:143], v226 offset:768
    buffer_load_dwordx4 v230, s[56:59], s34 offen offset:0 sc1 lds
    v_mfma_f32_16x16x32_bf16 v[16:19], a[8:11], a[112:115], v[16:19]
    v_mfma_f32_16x16x32_bf16 v[20:23], a[8:11], a[116:119], v[20:23]
    ds_read_b64_tr_b16 a[56:57], v227 offset:0
    v_mfma_f32_16x16x32_bf16 v[24:27], a[8:11], a[120:123], v[24:27]
    ds_read_b64_tr_b16 a[58:59], v227 offset:1792
    v_mfma_f32_16x16x32_bf16 v[28:31], a[8:11], a[124:127], v[28:31]
    ds_read_b64_tr_b16 a[60:61], v227 offset:7296
    v_mfma_f32_16x16x32_bf16 v[140:143], a[12:15], a[124:127], v[140:143]
    ds_read_b64_tr_b16 a[62:63], v227 offset:9088
    v_mfma_f32_16x16x32_bf16 v[136:139], a[12:15], a[120:123], v[136:139]
    buffer_load_dwordx4 v230, s[56:59], s34 offen offset:1024 sc1 lds
    v_mfma_f32_16x16x32_bf16 v[132:135], a[12:15], a[116:119], v[132:135]
    ds_read_b64_tr_b16 a[64:65], v227 offset:32
    v_mfma_f32_16x16x32_bf16 v[128:131], a[12:15], a[112:115], v[128:131]
    ds_read_b64_tr_b16 a[66:67], v227 offset:1824
    v_mfma_f32_16x16x32_bf16 v[32:35], a[16:19], a[112:115], v[32:35]
    ds_read_b64_tr_b16 a[68:69], v227 offset:7328
    v_mfma_f32_16x16x32_bf16 v[36:39], a[16:19], a[116:119], v[36:39]
    ds_read_b64_tr_b16 a[70:71], v227 offset:9120
    v_mfma_f32_16x16x32_bf16 v[40:43], a[16:19], a[120:123], v[40:43]
    v_mfma_f32_16x16x32_bf16 v[44:47], a[16:19], a[124:127], v[44:47]
    ds_read_b64_tr_b16 a[72:73], v227 offset:64
    buffer_load_dwordx4 v230, s[56:59], s34 offen offset:2048 sc1 lds
    v_mfma_f32_16x16x32_bf16 v[156:159], a[20:23], a[124:127], v[156:159]
    ds_read_b64_tr_b16 a[74:75], v227 offset:1856
    v_mfma_f32_16x16x32_bf16 v[152:155], a[20:23], a[120:123], v[152:155]
    ds_read_b64_tr_b16 a[76:77], v227 offset:7360
    v_mfma_f32_16x16x32_bf16 v[148:151], a[20:23], a[116:119], v[148:151]
    ds_read_b64_tr_b16 a[78:79], v227 offset:9152
    v_mfma_f32_16x16x32_bf16 v[144:147], a[20:23], a[112:115], v[144:147]
    v_mfma_f32_16x16x32_bf16 v[48:51], a[24:27], a[112:115], v[48:51]
    ds_read_b64_tr_b16 a[80:81], v227 offset:96
    v_mfma_f32_16x16x32_bf16 v[52:55], a[24:27], a[116:119], v[52:55]
    ds_read_b64_tr_b16 a[82:83], v227 offset:1888
    buffer_load_dwordx4 v230, s[56:59], s34 offen offset:3072 sc1 lds
    v_mfma_f32_16x16x32_bf16 v[56:59], a[24:27], a[120:123], v[56:59]
    ds_read_b64_tr_b16 a[84:85], v227 offset:7392
    v_mfma_f32_16x16x32_bf16 v[60:63], a[24:27], a[124:127], v[60:63]
    ds_read_b64_tr_b16 a[86:87], v227 offset:9184
    s_add_u32 s34, s34, 16384
    v_mfma_f32_16x16x32_bf16 v[172:175], a[28:31], a[124:127], v[172:175]
    v_mfma_f32_16x16x32_bf16 v[168:171], a[28:31], a[120:123], v[168:171]
    ds_read_b64_tr_b16 a[88:89], v227 offset:128
    s_add_u32 m0, s37, s33
    v_mfma_f32_16x16x32_bf16 v[164:167], a[28:31], a[116:119], v[164:167]
    ds_read_b64_tr_b16 a[90:91], v227 offset:1920
    v_mfma_f32_16x16x32_bf16 v[160:163], a[28:31], a[112:115], v[160:163]
    ds_read_b64_tr_b16 a[92:93], v227 offset:7424
    v_mfma_f32_16x16x32_bf16 v[64:67], a[32:35], a[112:115], v[64:67]
    ds_read_b64_tr_b16 a[94:95], v227 offset:9216
    v_mfma_f32_16x16x32_bf16 v[68:71], a[32:35], a[116:119], v[68:71]
    buffer_load_dwordx4 v232, s[28:31], s35 offen offset:0 lds
    v_mfma_f32_16x16x32_bf16 v[72:75], a[32:35], a[120:123], v[72:75]
    ds_read_b64_tr_b16 a[96:97], v227 offset:160
    v_mfma_f32_16x16x32_bf16 v[76:79], a[32:35], a[124:127], v[76:79]
    ds_read_b64_tr_b16 a[98:99], v227 offset:1952
    v_mfma_f32_16x16x32_bf16 v[188:191], a[36:39], a[124:127], v[188:191]
    ds_read_b64_tr_b16 a[100:101], v227 offset:7456
    v_mfma_f32_16x16x32_bf16 v[184:187], a[36:39], a[120:123], v[184:187]
    ds_read_b64_tr_b16 a[102:103], v227 offset:9248
    v_mfma_f32_16x16x32_bf16 v[180:183], a[36:39], a[116:119], v[180:183]
    v_mfma_f32_16x16x32_bf16 v[176:179], a[36:39], a[112:115], v[176:179]
    ds_read_b64_tr_b16 a[104:105], v227 offset:192
    buffer_load_dwordx4 v233, s[28:31], s35 offen offset:1024 lds
    v_mfma_f32_16x16x32_bf16 v[80:83], a[40:43], a[112:115], v[80:83]
    ds_read_b64_tr_b16 a[106:107], v227 offset:1984
    v_mfma_f32_16x16x32_bf16 v[84:87], a[40:43], a[116:119], v[84:87]
    ds_read_b64_tr_b16 a[108:109], v227 offset:7488
    v_mfma_f32_16x16x32_bf16 v[88:91], a[40:43], a[120:123], v[88:91]
    ds_read_b64_tr_b16 a[110:111], v227 offset:9280
    v_mfma_f32_16x16x32_bf16 v[92:95], a[40:43], a[124:127], v[92:95]
    v_mfma_f32_16x16x32_bf16 v[204:207], a[44:47], a[124:127], v[204:207]
    v_mfma_f32_16x16x32_bf16 v[200:203], a[44:47], a[120:123], v[200:203]
    buffer_load_dwordx4 v234, s[28:31], s35 offen offset:2048 lds
    v_mfma_f32_16x16x32_bf16 v[196:199], a[44:47], a[116:119], v[196:199]
    v_mfma_f32_16x16x32_bf16 v[192:195], a[44:47], a[112:115], v[192:195]
    v_mfma_f32_16x16x32_bf16 v[96:99], a[48:51], a[112:115], v[96:99]
    v_mfma_f32_16x16x32_bf16 v[100:103], a[48:51], a[116:119], v[100:103]
    v_mfma_f32_16x16x32_bf16 v[104:107], a[48:51], a[120:123], v[104:107]
    v_mfma_f32_16x16x32_bf16 v[108:111], a[48:51], a[124:127], v[108:111]
    buffer_load_dwordx4 v235, s[28:31], s35 offen offset:3072 lds
    v_mfma_f32_16x16x32_bf16 v[220:223], a[52:55], a[124:127], v[220:223]
    v_mfma_f32_16x16x32_bf16 v[216:219], a[52:55], a[120:123], v[216:219]
    s_add_u32 s35, s35, 229376
    s_add_u32 s37, s37, 30848
    s_cmp_eq_u32 s37, 154240
    s_cselect_b32 s37, 0, s37
    v_mfma_f32_16x16x32_bf16 v[212:215], a[52:55], a[116:119], v[212:215]
    v_mfma_f32_16x16x32_bf16 v[208:211], a[52:55], a[112:115], v[208:211]
    s_add_u32 s36, s36, 30848
    s_cmp_eq_u32 s36, 154240
    s_cselect_b32 s36, 0, s36
    s_waitcnt lgkmcnt(0)
    v_mfma_f32_16x16x32_bf16 v[0:3], a[56:59], a[128:131], v[0:3]
    v_mfma_f32_16x16x32_bf16 v[4:7], a[56:59], a[132:135], v[4:7]
    v_mfma_f32_16x16x32_bf16 v[8:11], a[56:59], a[136:139], v[8:11]
    v_mfma_f32_16x16x32_bf16 v[12:15], a[56:59], a[140:143], v[12:15]
    s_waitcnt vmcnt(24)
    s_barrier
    v_add_u32 v226, s36, v228
    v_add_u32 v227, s36, v229
    v_mfma_f32_16x16x32_bf16 v[124:127], a[60:63], a[140:143], v[124:127]
    ds_read_b128 a[112:115], v226 offset:0
    v_mfma_f32_16x16x32_bf16 v[120:123], a[60:63], a[136:139], v[120:123]
    ds_read_b128 a[116:119], v226 offset:256
    s_add_u32 m0, s37, s32
    v_mfma_f32_16x16x32_bf16 v[116:119], a[60:63], a[132:135], v[116:119]
    ds_read_b128 a[120:123], v226 offset:512
    v_mfma_f32_16x16x32_bf16 v[112:115], a[60:63], a[128:131], v[112:115]
    ds_read_b128 a[124:127], v226 offset:768
    buffer_load_dwordx4 v230, s[56:59], s34 offen offset:0 sc1 lds
    v_mfma_f32_16x16x32_bf16 v[16:19], a[64:67], a[128:131], v[16:19]
    v_mfma_f32_16x16x32_bf16 v[20:23], a[64:67], a[132:135], v[20:23]
    ds_read_b64_tr_b16 a[0:1], v227 offset:0
    v_mfma_f32_16x16x32_bf16 v[24:27], a[64:67], a[136:139], v[24:27]
    ds_read_b64_tr_b16 a[2:3], v227 offset:1792
    v_mfma_f32_16x16x32_bf16 v[28:31], a[64:67], a[140:143], v[28:31]
    ds_read_b64_tr_b16 a[4:5], v227 offset:7296
    v_mfma_f32_16x16x32_bf16 v[140:143], a[68:71], a[140:143], v[140:143]
    ds_read_b64_tr_b16 a[6:7], v227 offset:9088
    v_mfma_f32_16x16x32_bf16 v[136:139], a[68:71], a[136:139], v[136:139]
    buffer_load_dwordx4 v230, s[56:59], s34 offen offset:1024 sc1 lds
    v_mfma_f32_16x16x32_bf16 v[132:135], a[68:71], a[132:135], v[132:135]
    ds_read_b64_tr_b16 a[8:9], v227 offset:32
    v_mfma_f32_16x16x32_bf16 v[128:131], a[68:71], a[128:131], v[128:131]
    ds_read_b64_tr_b16 a[10:11], v227 offset:1824
    v_mfma_f32_16x16x32_bf16 v[32:35], a[72:75], a[128:131], v[32:35]
    ds_read_b64_tr_b16 a[12:13], v227 offset:7328
    v_mfma_f32_16x16x32_bf16 v[36:39], a[72:75], a[132:135], v[36:39]
    ds_read_b64_tr_b16 a[14:15], v227 offset:9120
    v_mfma_f32_16x16x32_bf16 v[40:43], a[72:75], a[136:139], v[40:43]
    v_mfma_f32_16x16x32_bf16 v[44:47], a[72:75], a[140:143], v[44:47]
    ds_read_b64_tr_b16 a[16:17], v227 offset:64
    buffer_load_dwordx4 v230, s[56:59], s34 offen offset:2048 sc1 lds
    v_mfma_f32_16x16x32_bf16 v[156:159], a[76:79], a[140:143], v[156:159]
    ds_read_b64_tr_b16 a[18:19], v227 offset:1856
    v_mfma_f32_16x16x32_bf16 v[152:155], a[76:79], a[136:139], v[152:155]
    ds_read_b64_tr_b16 a[20:21], v227 offset:7360
    v_mfma_f32_16x16x32_bf16 v[148:151], a[76:79], a[132:135], v[148:151]
    ds_read_b64_tr_b16 a[22:23], v227 offset:9152
    v_mfma_f32_16x16x32_bf16 v[144:147], a[76:79], a[128:131], v[144:147]
    v_mfma_f32_16x16x32_bf16 v[48:51], a[80:83], a[128:131], v[48:51]
    ds_read_b64_tr_b16 a[24:25], v227 offset:96
    v_mfma_f32_16x16x32_bf16 v[52:55], a[80:83], a[132:135], v[52:55]
    ds_read_b64_tr_b16 a[26:27], v227 offset:1888
    buffer_load_dwordx4 v230, s[56:59], s34 offen offset:3072 sc1 lds
    v_mfma_f32_16x16x32_bf16 v[56:59], a[80:83], a[136:139], v[56:59]
    ds_read_b64_tr_b16 a[28:29], v227 offset:7392
    v_mfma_f32_16x16x32_bf16 v[60:63], a[80:83], a[140:143], v[60:63]
    ds_read_b64_tr_b16 a[30:31], v227 offset:9184
    s_add_u32 s34, s34, 16384
    v_mfma_f32_16x16x32_bf16 v[172:175], a[84:87], a[140:143], v[172:175]
    v_mfma_f32_16x16x32_bf16 v[168:171], a[84:87], a[136:139], v[168:171]
    ds_read_b64_tr_b16 a[32:33], v227 offset:128
    s_add_u32 m0, s37, s33
    v_mfma_f32_16x16x32_bf16 v[164:167], a[84:87], a[132:135], v[164:167]
    ds_read_b64_tr_b16 a[34:35], v227 offset:1920
    v_mfma_f32_16x16x32_bf16 v[160:163], a[84:87], a[128:131], v[160:163]
    ds_read_b64_tr_b16 a[36:37], v227 offset:7424
    v_mfma_f32_16x16x32_bf16 v[64:67], a[88:91], a[128:131], v[64:67]
    ds_read_b64_tr_b16 a[38:39], v227 offset:9216
    v_mfma_f32_16x16x32_bf16 v[68:71], a[88:91], a[132:135], v[68:71]
    buffer_load_dwordx4 v232, s[28:31], s35 offen offset:0 lds
    v_mfma_f32_16x16x32_bf16 v[72:75], a[88:91], a[136:139], v[72:75]
    ds_read_b64_tr_b16 a[40:41], v227 offset:160
    v_mfma_f32_16x16x32_bf16 v[76:79], a[88:91], a[140:143], v[76:79]
    ds_read_b64_tr_b16 a[42:43], v227 offset:1952
    v_mfma_f32_16x16x32_bf16 v[188:191], a[92:95], a[140:143], v[188:191]
    ds_read_b64_tr_b16 a[44:45], v227 offset:7456
    v_mfma_f32_16x16x32_bf16 v[184:187], a[92:95], a[136:139], v[184:187]
    ds_read_b64_tr_b16 a[46:47], v227 offset:9248
    v_mfma_f32_16x16x32_bf16 v[180:183], a[92:95], a[132:135], v[180:183]
    v_mfma_f32_16x16x32_bf16 v[176:179], a[92:95], a[128:131], v[176:179]
    ds_read_b64_tr_b16 a[48:49], v227 offset:192
    buffer_load_dwordx4 v233, s[28:31], s35 offen offset:1024 lds
    v_mfma_f32_16x16x32_bf16 v[80:83], a[96:99], a[128:131], v[80:83]
    ds_read_b64_tr_b16 a[50:51], v227 offset:1984
    v_mfma_f32_16x16x32_bf16 v[84:87], a[96:99], a[132:135], v[84:87]
    ds_read_b64_tr_b16 a[52:53], v227 offset:7488
    v_mfma_f32_16x16x32_bf16 v[88:91], a[96:99], a[136:139], v[88:91]
    ds_read_b64_tr_b16 a[54:55], v227 offset:9280
    v_mfma_f32_16x16x32_bf16 v[92:95], a[96:99], a[140:143], v[92:95]
    v_mfma_f32_16x16x32_bf16 v[204:207], a[100:103], a[140:143], v[204:207]
    v_mfma_f32_16x16x32_bf16 v[200:203], a[100:103], a[136:139], v[200:203]
    buffer_load_dwordx4 v234, s[28:31], s35 offen offset:2048 lds
    v_mfma_f32_16x16x32_bf16 v[196:199], a[100:103], a[132:135], v[196:199]
    v_mfma_f32_16x16x32_bf16 v[192:195], a[100:103], a[128:131], v[192:195]
    v_mfma_f32_16x16x32_bf16 v[96:99], a[104:107], a[128:131], v[96:99]
    v_mfma_f32_16x16x32_bf16 v[100:103], a[104:107], a[132:135], v[100:103]
    v_mfma_f32_16x16x32_bf16 v[104:107], a[104:107], a[136:139], v[104:107]
    v_mfma_f32_16x16x32_bf16 v[108:111], a[104:107], a[140:143], v[108:111]
    buffer_load_dwordx4 v235, s[28:31], s35 offen offset:3072 lds
    v_mfma_f32_16x16x32_bf16 v[220:223], a[108:111], a[140:143], v[220:223]
    v_mfma_f32_16x16x32_bf16 v[216:219], a[108:111], a[136:139], v[216:219]
    s_add_u32 s35, s35, 229376
    s_add_u32 s37, s37, 30848
    s_cmp_eq_u32 s37, 154240
    s_cselect_b32 s37, 0, s37
    v_mfma_f32_16x16x32_bf16 v[212:215], a[108:111], a[132:135], v[212:215]
    v_mfma_f32_16x16x32_bf16 v[208:211], a[108:111], a[128:131], v[208:211]
    s_add_u32 s36, s36, 30848
    s_cmp_eq_u32 s36, 154240
    s_cselect_b32 s36, 0, s36
    s_sub_u32 s38, s38, 1
    s_cmp_lg_u32 s38, 0
    s_cbranch_scc1 L_b_g1b
L_b_k26:
    s_getpc_b64 s[60:61]
L_cpf_3:
    s_sub_u32 s60, s60, L_cpf_3-L_b_k26
    s_subb_u32 s61, s61, 0
    v_lshlrev_b32 v236, 7, v225
    s_lshl_b32 s62, s3, 13
    v_add_u32 v236, s62, v236
    s_cmp_lt_u32 s2, 16
    s_cselect_b32 s62, -1, 0
    v_and_b32 v236, s62, v236
    v_min_u32 v237, L_adaLN_cond__ssm_conv_h3__glu_gated_geglu__prompt_kernel_end-L_b_k26-4, v236
    global_load_dword v224, v237, s[60:61]
    s_waitcnt lgkmcnt(0)
    v_mfma_f32_16x16x32_bf16 v[0:3], a[0:3], a[112:115], v[0:3]
    v_mfma_f32_16x16x32_bf16 v[4:7], a[0:3], a[116:119], v[4:7]
    v_mfma_f32_16x16x32_bf16 v[8:11], a[0:3], a[120:123], v[8:11]
    v_mfma_f32_16x16x32_bf16 v[12:15], a[0:3], a[124:127], v[12:15]
    s_waitcnt vmcnt(24)
    s_barrier
    v_add_u32 v226, s36, v228
    v_add_u32 v227, s36, v229
    v_mfma_f32_16x16x32_bf16 v[124:127], a[4:7], a[124:127], v[124:127]
    ds_read_b128 a[128:131], v226 offset:0
    v_mfma_f32_16x16x32_bf16 v[120:123], a[4:7], a[120:123], v[120:123]
    ds_read_b128 a[132:135], v226 offset:256
    s_add_u32 m0, s37, s32
    v_mfma_f32_16x16x32_bf16 v[116:119], a[4:7], a[116:119], v[116:119]
    ds_read_b128 a[136:139], v226 offset:512
    v_mfma_f32_16x16x32_bf16 v[112:115], a[4:7], a[112:115], v[112:115]
    ds_read_b128 a[140:143], v226 offset:768
    buffer_load_dwordx4 v230, s[56:59], s34 offen offset:0 sc1 lds
    v_mfma_f32_16x16x32_bf16 v[16:19], a[8:11], a[112:115], v[16:19]
    v_mfma_f32_16x16x32_bf16 v[20:23], a[8:11], a[116:119], v[20:23]
    ds_read_b64_tr_b16 a[56:57], v227 offset:0
    v_mfma_f32_16x16x32_bf16 v[24:27], a[8:11], a[120:123], v[24:27]
    ds_read_b64_tr_b16 a[58:59], v227 offset:1792
    v_mfma_f32_16x16x32_bf16 v[28:31], a[8:11], a[124:127], v[28:31]
    ds_read_b64_tr_b16 a[60:61], v227 offset:7296
    v_mfma_f32_16x16x32_bf16 v[140:143], a[12:15], a[124:127], v[140:143]
    ds_read_b64_tr_b16 a[62:63], v227 offset:9088
    v_mfma_f32_16x16x32_bf16 v[136:139], a[12:15], a[120:123], v[136:139]
    buffer_load_dwordx4 v230, s[56:59], s34 offen offset:1024 sc1 lds
    v_mfma_f32_16x16x32_bf16 v[132:135], a[12:15], a[116:119], v[132:135]
    ds_read_b64_tr_b16 a[64:65], v227 offset:32
    v_mfma_f32_16x16x32_bf16 v[128:131], a[12:15], a[112:115], v[128:131]
    ds_read_b64_tr_b16 a[66:67], v227 offset:1824
    v_mfma_f32_16x16x32_bf16 v[32:35], a[16:19], a[112:115], v[32:35]
    ds_read_b64_tr_b16 a[68:69], v227 offset:7328
    v_mfma_f32_16x16x32_bf16 v[36:39], a[16:19], a[116:119], v[36:39]
    ds_read_b64_tr_b16 a[70:71], v227 offset:9120
    v_mfma_f32_16x16x32_bf16 v[40:43], a[16:19], a[120:123], v[40:43]
    v_mfma_f32_16x16x32_bf16 v[44:47], a[16:19], a[124:127], v[44:47]
    ds_read_b64_tr_b16 a[72:73], v227 offset:64
    buffer_load_dwordx4 v230, s[56:59], s34 offen offset:2048 sc1 lds
    v_mfma_f32_16x16x32_bf16 v[156:159], a[20:23], a[124:127], v[156:159]
    ds_read_b64_tr_b16 a[74:75], v227 offset:1856
    v_mfma_f32_16x16x32_bf16 v[152:155], a[20:23], a[120:123], v[152:155]
    ds_read_b64_tr_b16 a[76:77], v227 offset:7360
    v_mfma_f32_16x16x32_bf16 v[148:151], a[20:23], a[116:119], v[148:151]
    ds_read_b64_tr_b16 a[78:79], v227 offset:9152
    v_mfma_f32_16x16x32_bf16 v[144:147], a[20:23], a[112:115], v[144:147]
    v_mfma_f32_16x16x32_bf16 v[48:51], a[24:27], a[112:115], v[48:51]
    ds_read_b64_tr_b16 a[80:81], v227 offset:96
    v_mfma_f32_16x16x32_bf16 v[52:55], a[24:27], a[116:119], v[52:55]
    ds_read_b64_tr_b16 a[82:83], v227 offset:1888
    buffer_load_dwordx4 v230, s[56:59], s34 offen offset:3072 sc1 lds
    v_mfma_f32_16x16x32_bf16 v[56:59], a[24:27], a[120:123], v[56:59]
    ds_read_b64_tr_b16 a[84:85], v227 offset:7392
    v_mfma_f32_16x16x32_bf16 v[60:63], a[24:27], a[124:127], v[60:63]
    ds_read_b64_tr_b16 a[86:87], v227 offset:9184
    s_add_u32 s34, s34, 16384
    v_mfma_f32_16x16x32_bf16 v[172:175], a[28:31], a[124:127], v[172:175]
    v_mfma_f32_16x16x32_bf16 v[168:171], a[28:31], a[120:123], v[168:171]
    ds_read_b64_tr_b16 a[88:89], v227 offset:128
    s_add_u32 m0, s37, s33
    v_mfma_f32_16x16x32_bf16 v[164:167], a[28:31], a[116:119], v[164:167]
    ds_read_b64_tr_b16 a[90:91], v227 offset:1920
    v_mfma_f32_16x16x32_bf16 v[160:163], a[28:31], a[112:115], v[160:163]
    ds_read_b64_tr_b16 a[92:93], v227 offset:7424
    v_mfma_f32_16x16x32_bf16 v[64:67], a[32:35], a[112:115], v[64:67]
    ds_read_b64_tr_b16 a[94:95], v227 offset:9216
    v_mfma_f32_16x16x32_bf16 v[68:71], a[32:35], a[116:119], v[68:71]
    buffer_load_dwordx4 v232, s[28:31], s35 offen offset:0 lds
    v_mfma_f32_16x16x32_bf16 v[72:75], a[32:35], a[120:123], v[72:75]
    ds_read_b64_tr_b16 a[96:97], v227 offset:160
    v_mfma_f32_16x16x32_bf16 v[76:79], a[32:35], a[124:127], v[76:79]
    ds_read_b64_tr_b16 a[98:99], v227 offset:1952
    v_mfma_f32_16x16x32_bf16 v[188:191], a[36:39], a[124:127], v[188:191]
    ds_read_b64_tr_b16 a[100:101], v227 offset:7456
    v_mfma_f32_16x16x32_bf16 v[184:187], a[36:39], a[120:123], v[184:187]
    ds_read_b64_tr_b16 a[102:103], v227 offset:9248
    v_mfma_f32_16x16x32_bf16 v[180:183], a[36:39], a[116:119], v[180:183]
    v_mfma_f32_16x16x32_bf16 v[176:179], a[36:39], a[112:115], v[176:179]
    ds_read_b64_tr_b16 a[104:105], v227 offset:192
    buffer_load_dwordx4 v233, s[28:31], s35 offen offset:1024 lds
    v_mfma_f32_16x16x32_bf16 v[80:83], a[40:43], a[112:115], v[80:83]
    ds_read_b64_tr_b16 a[106:107], v227 offset:1984
    v_mfma_f32_16x16x32_bf16 v[84:87], a[40:43], a[116:119], v[84:87]
    ds_read_b64_tr_b16 a[108:109], v227 offset:7488
    v_mfma_f32_16x16x32_bf16 v[88:91], a[40:43], a[120:123], v[88:91]
    ds_read_b64_tr_b16 a[110:111], v227 offset:9280
    v_mfma_f32_16x16x32_bf16 v[92:95], a[40:43], a[124:127], v[92:95]
    v_mfma_f32_16x16x32_bf16 v[204:207], a[44:47], a[124:127], v[204:207]
    v_mfma_f32_16x16x32_bf16 v[200:203], a[44:47], a[120:123], v[200:203]
    buffer_load_dwordx4 v234, s[28:31], s35 offen offset:2048 lds
    v_mfma_f32_16x16x32_bf16 v[196:199], a[44:47], a[116:119], v[196:199]
    v_mfma_f32_16x16x32_bf16 v[192:195], a[44:47], a[112:115], v[192:195]
    v_mfma_f32_16x16x32_bf16 v[96:99], a[48:51], a[112:115], v[96:99]
    v_mfma_f32_16x16x32_bf16 v[100:103], a[48:51], a[116:119], v[100:103]
    v_mfma_f32_16x16x32_bf16 v[104:107], a[48:51], a[120:123], v[104:107]
    v_mfma_f32_16x16x32_bf16 v[108:111], a[48:51], a[124:127], v[108:111]
    buffer_load_dwordx4 v235, s[28:31], s35 offen offset:3072 lds
    v_mfma_f32_16x16x32_bf16 v[220:223], a[52:55], a[124:127], v[220:223]
    v_mfma_f32_16x16x32_bf16 v[216:219], a[52:55], a[120:123], v[216:219]
    s_add_u32 s35, s35, 229376
    s_add_u32 s37, s37, 30848
    s_cmp_eq_u32 s37, 154240
    s_cselect_b32 s37, 0, s37
    v_mfma_f32_16x16x32_bf16 v[212:215], a[52:55], a[116:119], v[212:215]
    v_mfma_f32_16x16x32_bf16 v[208:211], a[52:55], a[112:115], v[208:211]
    s_add_u32 s36, s36, 30848
    s_cmp_eq_u32 s36, 154240
    s_cselect_b32 s36, 0, s36
    s_load_dwordx2 s[40:41], s[0:1], 72
    s_and_b32 s80, s2, 1
    s_lshr_b32 s14, s2, 3
    s_bfe_u32 s81, s2, 0x10002
    s_lshl_b32 s81, s81, 3
    s_and_b32 s15, s14, 7
    s_add_u32 s81, s81, s15
    s_bfe_u32 s82, s2, 0x10001
    s_lshl_b32 s82, s82, 2
    s_lshr_b32 s15, s14, 3
    s_add_u32 s82, s82, s15
    s_waitcnt lgkmcnt(0)
    s_mul_i32 s15, s80, 3670016
    s_add_u32 s84, s40, s15
    s_addc_u32 s85, s41, 0
    s_mov_b32 s86, 3670016
    s_mov_b32 s87, 0x00020000
    s_and_b32 s14, s14, 7
    s_mul_i32 s14, s14, 224
    s_mul_i32 s15, s3, 56
    s_add_u32 s14, s14, s15
    s_lshl_b32 s14, s14, 11
    s_lshl_b32 s15, s82, 8
    s_add_u32 s14, s14, s15
    v_lshrrev_b32 v236, 1, v225
    v_lshlrev_b32 v236, 11, v236
    v_and_b32 v237, 1, v225
    v_lshlrev_b32 v237, 7, v237
    v_add_u32 v231, v236, v237
    v_add_u32 v231, s14, v231
    v_min_u32 v236, 47, v225
    v_lshrrev_b32 v237, 1, v236
    v_add_u32 v237, 32, v237
    v_lshlrev_b32 v237, 11, v237
    v_and_b32 v236, 1, v236
    v_lshlrev_b32 v236, 7, v236
    v_add_u32 v254, v236, v237
    v_add_u32 v254, s14, v254
    s_waitcnt lgkmcnt(0)
    v_mfma_f32_16x16x32_bf16 v[0:3], a[56:59], a[128:131], v[0:3]
    v_mfma_f32_16x16x32_bf16 v[4:7], a[56:59], a[132:135], v[4:7]
    v_mfma_f32_16x16x32_bf16 v[8:11], a[56:59], a[136:139], v[8:11]
    v_mfma_f32_16x16x32_bf16 v[12:15], a[56:59], a[140:143], v[12:15]
    s_waitcnt vmcnt(24)
    s_barrier
    v_add_u32 v226, s36, v228
    v_add_u32 v227, s36, v229
    v_mfma_f32_16x16x32_bf16 v[124:127], a[60:63], a[140:143], v[124:127]
    ds_read_b128 a[112:115], v226 offset:0
    v_mfma_f32_16x16x32_bf16 v[120:123], a[60:63], a[136:139], v[120:123]
    ds_read_b128 a[116:119], v226 offset:256
    buffer_load_ubyte v224, v231, s[84:87], 0 offen
    v_mfma_f32_16x16x32_bf16 v[116:119], a[60:63], a[132:135], v[116:119]
    ds_read_b128 a[120:123], v226 offset:512
    v_mfma_f32_16x16x32_bf16 v[112:115], a[60:63], a[128:131], v[112:115]
    ds_read_b128 a[124:127], v226 offset:768
    v_mfma_f32_16x16x32_bf16 v[16:19], a[64:67], a[128:131], v[16:19]
    v_mfma_f32_16x16x32_bf16 v[20:23], a[64:67], a[132:135], v[20:23]
    ds_read_b64_tr_b16 a[0:1], v227 offset:0
    buffer_load_ubyte v224, v254, s[84:87], 0 offen
    v_mfma_f32_16x16x32_bf16 v[24:27], a[64:67], a[136:139], v[24:27]
    ds_read_b64_tr_b16 a[2:3], v227 offset:1792
    v_mfma_f32_16x16x32_bf16 v[28:31], a[64:67], a[140:143], v[28:31]
    ds_read_b64_tr_b16 a[4:5], v227 offset:7296
    v_mfma_f32_16x16x32_bf16 v[140:143], a[68:71], a[140:143], v[140:143]
    ds_read_b64_tr_b16 a[6:7], v227 offset:9088
    v_mfma_f32_16x16x32_bf16 v[136:139], a[68:71], a[136:139], v[136:139]
    v_mfma_f32_16x16x32_bf16 v[132:135], a[68:71], a[132:135], v[132:135]
    ds_read_b64_tr_b16 a[8:9], v227 offset:32
    v_mfma_f32_16x16x32_bf16 v[128:131], a[68:71], a[128:131], v[128:131]
    ds_read_b64_tr_b16 a[10:11], v227 offset:1824
    v_mfma_f32_16x16x32_bf16 v[32:35], a[72:75], a[128:131], v[32:35]
    ds_read_b64_tr_b16 a[12:13], v227 offset:7328
    v_mfma_f32_16x16x32_bf16 v[36:39], a[72:75], a[132:135], v[36:39]
    ds_read_b64_tr_b16 a[14:15], v227 offset:9120
    v_mfma_f32_16x16x32_bf16 v[40:43], a[72:75], a[136:139], v[40:43]
    v_mfma_f32_16x16x32_bf16 v[44:47], a[72:75], a[140:143], v[44:47]
    ds_read_b64_tr_b16 a[16:17], v227 offset:64
    v_mfma_f32_16x16x32_bf16 v[156:159], a[76:79], a[140:143], v[156:159]
    ds_read_b64_tr_b16 a[18:19], v227 offset:1856
    v_mfma_f32_16x16x32_bf16 v[152:155], a[76:79], a[136:139], v[152:155]
    ds_read_b64_tr_b16 a[20:21], v227 offset:7360
    v_mfma_f32_16x16x32_bf16 v[148:151], a[76:79], a[132:135], v[148:151]
    ds_read_b64_tr_b16 a[22:23], v227 offset:9152
    v_mfma_f32_16x16x32_bf16 v[144:147], a[76:79], a[128:131], v[144:147]
    v_mfma_f32_16x16x32_bf16 v[48:51], a[80:83], a[128:131], v[48:51]
    ds_read_b64_tr_b16 a[24:25], v227 offset:96
    v_mfma_f32_16x16x32_bf16 v[52:55], a[80:83], a[132:135], v[52:55]
    ds_read_b64_tr_b16 a[26:27], v227 offset:1888
    v_mfma_f32_16x16x32_bf16 v[56:59], a[80:83], a[136:139], v[56:59]
    ds_read_b64_tr_b16 a[28:29], v227 offset:7392
    v_mfma_f32_16x16x32_bf16 v[60:63], a[80:83], a[140:143], v[60:63]
    ds_read_b64_tr_b16 a[30:31], v227 offset:9184
    v_mfma_f32_16x16x32_bf16 v[172:175], a[84:87], a[140:143], v[172:175]
    v_mfma_f32_16x16x32_bf16 v[168:171], a[84:87], a[136:139], v[168:171]
    ds_read_b64_tr_b16 a[32:33], v227 offset:128
    v_mfma_f32_16x16x32_bf16 v[164:167], a[84:87], a[132:135], v[164:167]
    ds_read_b64_tr_b16 a[34:35], v227 offset:1920
    v_mfma_f32_16x16x32_bf16 v[160:163], a[84:87], a[128:131], v[160:163]
    ds_read_b64_tr_b16 a[36:37], v227 offset:7424
    v_mfma_f32_16x16x32_bf16 v[64:67], a[88:91], a[128:131], v[64:67]
    ds_read_b64_tr_b16 a[38:39], v227 offset:9216
    v_mfma_f32_16x16x32_bf16 v[68:71], a[88:91], a[132:135], v[68:71]
    v_mfma_f32_16x16x32_bf16 v[72:75], a[88:91], a[136:139], v[72:75]
    ds_read_b64_tr_b16 a[40:41], v227 offset:160
    v_mfma_f32_16x16x32_bf16 v[76:79], a[88:91], a[140:143], v[76:79]
    ds_read_b64_tr_b16 a[42:43], v227 offset:1952
    v_mfma_f32_16x16x32_bf16 v[188:191], a[92:95], a[140:143], v[188:191]
    ds_read_b64_tr_b16 a[44:45], v227 offset:7456
    v_mfma_f32_16x16x32_bf16 v[184:187], a[92:95], a[136:139], v[184:187]
    ds_read_b64_tr_b16 a[46:47], v227 offset:9248
    v_mfma_f32_16x16x32_bf16 v[180:183], a[92:95], a[132:135], v[180:183]
    v_mfma_f32_16x16x32_bf16 v[176:179], a[92:95], a[128:131], v[176:179]
    ds_read_b64_tr_b16 a[48:49], v227 offset:192
    v_mfma_f32_16x16x32_bf16 v[80:83], a[96:99], a[128:131], v[80:83]
    ds_read_b64_tr_b16 a[50:51], v227 offset:1984
    v_mfma_f32_16x16x32_bf16 v[84:87], a[96:99], a[132:135], v[84:87]
    ds_read_b64_tr_b16 a[52:53], v227 offset:7488
    v_mfma_f32_16x16x32_bf16 v[88:91], a[96:99], a[136:139], v[88:91]
    ds_read_b64_tr_b16 a[54:55], v227 offset:9280
    v_mfma_f32_16x16x32_bf16 v[92:95], a[96:99], a[140:143], v[92:95]
    v_mfma_f32_16x16x32_bf16 v[204:207], a[100:103], a[140:143], v[204:207]
    v_mfma_f32_16x16x32_bf16 v[200:203], a[100:103], a[136:139], v[200:203]
    v_mfma_f32_16x16x32_bf16 v[196:199], a[100:103], a[132:135], v[196:199]
    v_mfma_f32_16x16x32_bf16 v[192:195], a[100:103], a[128:131], v[192:195]
    v_mfma_f32_16x16x32_bf16 v[96:99], a[104:107], a[128:131], v[96:99]
    v_mfma_f32_16x16x32_bf16 v[100:103], a[104:107], a[132:135], v[100:103]
    v_mfma_f32_16x16x32_bf16 v[104:107], a[104:107], a[136:139], v[104:107]
    v_mfma_f32_16x16x32_bf16 v[108:111], a[104:107], a[140:143], v[108:111]
    v_mfma_f32_16x16x32_bf16 v[220:223], a[108:111], a[140:143], v[220:223]
    v_mfma_f32_16x16x32_bf16 v[216:219], a[108:111], a[136:139], v[216:219]
    v_mfma_f32_16x16x32_bf16 v[212:215], a[108:111], a[132:135], v[212:215]
    v_mfma_f32_16x16x32_bf16 v[208:211], a[108:111], a[128:131], v[208:211]
    s_add_u32 s36, s36, 30848
    s_cmp_eq_u32 s36, 154240
    s_cselect_b32 s36, 0, s36
    s_waitcnt lgkmcnt(0)
    v_mfma_f32_16x16x32_bf16 v[0:3], a[0:3], a[112:115], v[0:3]
    v_mfma_f32_16x16x32_bf16 v[4:7], a[0:3], a[116:119], v[4:7]
    v_mfma_f32_16x16x32_bf16 v[8:11], a[0:3], a[120:123], v[8:11]
    v_mfma_f32_16x16x32_bf16 v[12:15], a[0:3], a[124:127], v[12:15]
    s_waitcnt vmcnt(18)
    s_barrier
    v_add_u32 v226, s36, v228
    v_add_u32 v227, s36, v229
    v_mfma_f32_16x16x32_bf16 v[124:127], a[4:7], a[124:127], v[124:127]
    ds_read_b128 a[128:131], v226 offset:0
    v_mfma_f32_16x16x32_bf16 v[120:123], a[4:7], a[120:123], v[120:123]
    ds_read_b128 a[132:135], v226 offset:256
    v_mfma_f32_16x16x32_bf16 v[116:119], a[4:7], a[116:119], v[116:119]
    ds_read_b128 a[136:139], v226 offset:512
    v_mfma_f32_16x16x32_bf16 v[112:115], a[4:7], a[112:115], v[112:115]
    ds_read_b128 a[140:143], v226 offset:768
    v_mfma_f32_16x16x32_bf16 v[16:19], a[8:11], a[112:115], v[16:19]
    v_mfma_f32_16x16x32_bf16 v[20:23], a[8:11], a[116:119], v[20:23]
    ds_read_b64_tr_b16 a[56:57], v227 offset:0
    v_mfma_f32_16x16x32_bf16 v[24:27], a[8:11], a[120:123], v[24:27]
    ds_read_b64_tr_b16 a[58:59], v227 offset:1792
    v_mfma_f32_16x16x32_bf16 v[28:31], a[8:11], a[124:127], v[28:31]
    ds_read_b64_tr_b16 a[60:61], v227 offset:7296
    v_mfma_f32_16x16x32_bf16 v[140:143], a[12:15], a[124:127], v[140:143]
    ds_read_b64_tr_b16 a[62:63], v227 offset:9088
    v_mfma_f32_16x16x32_bf16 v[136:139], a[12:15], a[120:123], v[136:139]
    v_mfma_f32_16x16x32_bf16 v[132:135], a[12:15], a[116:119], v[132:135]
    ds_read_b64_tr_b16 a[64:65], v227 offset:32
    v_mfma_f32_16x16x32_bf16 v[128:131], a[12:15], a[112:115], v[128:131]
    ds_read_b64_tr_b16 a[66:67], v227 offset:1824
    v_mfma_f32_16x16x32_bf16 v[32:35], a[16:19], a[112:115], v[32:35]
    ds_read_b64_tr_b16 a[68:69], v227 offset:7328
    v_mfma_f32_16x16x32_bf16 v[36:39], a[16:19], a[116:119], v[36:39]
    ds_read_b64_tr_b16 a[70:71], v227 offset:9120
    v_mfma_f32_16x16x32_bf16 v[40:43], a[16:19], a[120:123], v[40:43]
    v_mfma_f32_16x16x32_bf16 v[44:47], a[16:19], a[124:127], v[44:47]
    ds_read_b64_tr_b16 a[72:73], v227 offset:64
    v_mfma_f32_16x16x32_bf16 v[156:159], a[20:23], a[124:127], v[156:159]
    ds_read_b64_tr_b16 a[74:75], v227 offset:1856
    v_mfma_f32_16x16x32_bf16 v[152:155], a[20:23], a[120:123], v[152:155]
    ds_read_b64_tr_b16 a[76:77], v227 offset:7360
    v_mfma_f32_16x16x32_bf16 v[148:151], a[20:23], a[116:119], v[148:151]
    ds_read_b64_tr_b16 a[78:79], v227 offset:9152
    v_mfma_f32_16x16x32_bf16 v[144:147], a[20:23], a[112:115], v[144:147]
    v_mfma_f32_16x16x32_bf16 v[48:51], a[24:27], a[112:115], v[48:51]
    ds_read_b64_tr_b16 a[80:81], v227 offset:96
    v_mfma_f32_16x16x32_bf16 v[52:55], a[24:27], a[116:119], v[52:55]
    ds_read_b64_tr_b16 a[82:83], v227 offset:1888
    v_mfma_f32_16x16x32_bf16 v[56:59], a[24:27], a[120:123], v[56:59]
    ds_read_b64_tr_b16 a[84:85], v227 offset:7392
    v_mfma_f32_16x16x32_bf16 v[60:63], a[24:27], a[124:127], v[60:63]
    ds_read_b64_tr_b16 a[86:87], v227 offset:9184
    v_mfma_f32_16x16x32_bf16 v[172:175], a[28:31], a[124:127], v[172:175]
    v_mfma_f32_16x16x32_bf16 v[168:171], a[28:31], a[120:123], v[168:171]
    ds_read_b64_tr_b16 a[88:89], v227 offset:128
    v_mfma_f32_16x16x32_bf16 v[164:167], a[28:31], a[116:119], v[164:167]
    ds_read_b64_tr_b16 a[90:91], v227 offset:1920
    v_mfma_f32_16x16x32_bf16 v[160:163], a[28:31], a[112:115], v[160:163]
    ds_read_b64_tr_b16 a[92:93], v227 offset:7424
    v_mfma_f32_16x16x32_bf16 v[64:67], a[32:35], a[112:115], v[64:67]
    ds_read_b64_tr_b16 a[94:95], v227 offset:9216
    v_mfma_f32_16x16x32_bf16 v[68:71], a[32:35], a[116:119], v[68:71]
    v_mfma_f32_16x16x32_bf16 v[72:75], a[32:35], a[120:123], v[72:75]
    ds_read_b64_tr_b16 a[96:97], v227 offset:160
    v_mfma_f32_16x16x32_bf16 v[76:79], a[32:35], a[124:127], v[76:79]
    ds_read_b64_tr_b16 a[98:99], v227 offset:1952
    v_mfma_f32_16x16x32_bf16 v[188:191], a[36:39], a[124:127], v[188:191]
    ds_read_b64_tr_b16 a[100:101], v227 offset:7456
    v_mfma_f32_16x16x32_bf16 v[184:187], a[36:39], a[120:123], v[184:187]
    ds_read_b64_tr_b16 a[102:103], v227 offset:9248
    v_mfma_f32_16x16x32_bf16 v[180:183], a[36:39], a[116:119], v[180:183]
    v_mfma_f32_16x16x32_bf16 v[176:179], a[36:39], a[112:115], v[176:179]
    ds_read_b64_tr_b16 a[104:105], v227 offset:192
    v_mfma_f32_16x16x32_bf16 v[80:83], a[40:43], a[112:115], v[80:83]
    ds_read_b64_tr_b16 a[106:107], v227 offset:1984
    v_mfma_f32_16x16x32_bf16 v[84:87], a[40:43], a[116:119], v[84:87]
    ds_read_b64_tr_b16 a[108:109], v227 offset:7488
    v_mfma_f32_16x16x32_bf16 v[88:91], a[40:43], a[120:123], v[88:91]
    ds_read_b64_tr_b16 a[110:111], v227 offset:9280
    v_mfma_f32_16x16x32_bf16 v[92:95], a[40:43], a[124:127], v[92:95]
    v_mfma_f32_16x16x32_bf16 v[204:207], a[44:47], a[124:127], v[204:207]
    v_mfma_f32_16x16x32_bf16 v[200:203], a[44:47], a[120:123], v[200:203]
    v_mfma_f32_16x16x32_bf16 v[196:199], a[44:47], a[116:119], v[196:199]
    v_mfma_f32_16x16x32_bf16 v[192:195], a[44:47], a[112:115], v[192:195]
    v_mfma_f32_16x16x32_bf16 v[96:99], a[48:51], a[112:115], v[96:99]
    v_mfma_f32_16x16x32_bf16 v[100:103], a[48:51], a[116:119], v[100:103]
    v_mfma_f32_16x16x32_bf16 v[104:107], a[48:51], a[120:123], v[104:107]
    v_mfma_f32_16x16x32_bf16 v[108:111], a[48:51], a[124:127], v[108:111]
    v_mfma_f32_16x16x32_bf16 v[220:223], a[52:55], a[124:127], v[220:223]
    v_mfma_f32_16x16x32_bf16 v[216:219], a[52:55], a[120:123], v[216:219]
    v_mfma_f32_16x16x32_bf16 v[212:215], a[52:55], a[116:119], v[212:215]
    v_mfma_f32_16x16x32_bf16 v[208:211], a[52:55], a[112:115], v[208:211]
    s_add_u32 s36, s36, 30848
    s_cmp_eq_u32 s36, 154240
    s_cselect_b32 s36, 0, s36
    s_waitcnt lgkmcnt(0)
    v_mfma_f32_16x16x32_bf16 v[0:3], a[56:59], a[128:131], v[0:3]
    v_mfma_f32_16x16x32_bf16 v[4:7], a[56:59], a[132:135], v[4:7]
    v_mfma_f32_16x16x32_bf16 v[8:11], a[56:59], a[136:139], v[8:11]
    v_mfma_f32_16x16x32_bf16 v[12:15], a[56:59], a[140:143], v[12:15]
    s_waitcnt vmcnt(10)
    s_barrier
    v_add_u32 v226, s36, v228
    v_add_u32 v227, s36, v229
    v_mfma_f32_16x16x32_bf16 v[124:127], a[60:63], a[140:143], v[124:127]
    ds_read_b128 a[112:115], v226 offset:0
    v_mfma_f32_16x16x32_bf16 v[120:123], a[60:63], a[136:139], v[120:123]
    ds_read_b128 a[116:119], v226 offset:256
    v_mfma_f32_16x16x32_bf16 v[116:119], a[60:63], a[132:135], v[116:119]
    ds_read_b128 a[120:123], v226 offset:512
    v_mfma_f32_16x16x32_bf16 v[112:115], a[60:63], a[128:131], v[112:115]
    ds_read_b128 a[124:127], v226 offset:768
    v_mfma_f32_16x16x32_bf16 v[16:19], a[64:67], a[128:131], v[16:19]
    v_mfma_f32_16x16x32_bf16 v[20:23], a[64:67], a[132:135], v[20:23]
    ds_read_b64_tr_b16 a[0:1], v227 offset:0
    v_mfma_f32_16x16x32_bf16 v[24:27], a[64:67], a[136:139], v[24:27]
    ds_read_b64_tr_b16 a[2:3], v227 offset:1792
    v_mfma_f32_16x16x32_bf16 v[28:31], a[64:67], a[140:143], v[28:31]
    ds_read_b64_tr_b16 a[4:5], v227 offset:7296
    v_mfma_f32_16x16x32_bf16 v[140:143], a[68:71], a[140:143], v[140:143]
    ds_read_b64_tr_b16 a[6:7], v227 offset:9088
    v_mfma_f32_16x16x32_bf16 v[136:139], a[68:71], a[136:139], v[136:139]
    v_mfma_f32_16x16x32_bf16 v[132:135], a[68:71], a[132:135], v[132:135]
    ds_read_b64_tr_b16 a[8:9], v227 offset:32
    v_mfma_f32_16x16x32_bf16 v[128:131], a[68:71], a[128:131], v[128:131]
    ds_read_b64_tr_b16 a[10:11], v227 offset:1824
    v_mfma_f32_16x16x32_bf16 v[32:35], a[72:75], a[128:131], v[32:35]
    ds_read_b64_tr_b16 a[12:13], v227 offset:7328
    v_mfma_f32_16x16x32_bf16 v[36:39], a[72:75], a[132:135], v[36:39]
    ds_read_b64_tr_b16 a[14:15], v227 offset:9120
    v_mfma_f32_16x16x32_bf16 v[40:43], a[72:75], a[136:139], v[40:43]
    v_mfma_f32_16x16x32_bf16 v[44:47], a[72:75], a[140:143], v[44:47]
    ds_read_b64_tr_b16 a[16:17], v227 offset:64
    v_mfma_f32_16x16x32_bf16 v[156:159], a[76:79], a[140:143], v[156:159]
    ds_read_b64_tr_b16 a[18:19], v227 offset:1856
    v_mfma_f32_16x16x32_bf16 v[152:155], a[76:79], a[136:139], v[152:155]
    ds_read_b64_tr_b16 a[20:21], v227 offset:7360
    v_mfma_f32_16x16x32_bf16 v[148:151], a[76:79], a[132:135], v[148:151]
    ds_read_b64_tr_b16 a[22:23], v227 offset:9152
    v_mfma_f32_16x16x32_bf16 v[144:147], a[76:79], a[128:131], v[144:147]
    v_mfma_f32_16x16x32_bf16 v[48:51], a[80:83], a[128:131], v[48:51]
    ds_read_b64_tr_b16 a[24:25], v227 offset:96
    v_mfma_f32_16x16x32_bf16 v[52:55], a[80:83], a[132:135], v[52:55]
    ds_read_b64_tr_b16 a[26:27], v227 offset:1888
    v_mfma_f32_16x16x32_bf16 v[56:59], a[80:83], a[136:139], v[56:59]
    ds_read_b64_tr_b16 a[28:29], v227 offset:7392
    v_mfma_f32_16x16x32_bf16 v[60:63], a[80:83], a[140:143], v[60:63]
    ds_read_b64_tr_b16 a[30:31], v227 offset:9184
    v_mfma_f32_16x16x32_bf16 v[172:175], a[84:87], a[140:143], v[172:175]
    v_mfma_f32_16x16x32_bf16 v[168:171], a[84:87], a[136:139], v[168:171]
    ds_read_b64_tr_b16 a[32:33], v227 offset:128
    v_mfma_f32_16x16x32_bf16 v[164:167], a[84:87], a[132:135], v[164:167]
    ds_read_b64_tr_b16 a[34:35], v227 offset:1920
    v_mfma_f32_16x16x32_bf16 v[160:163], a[84:87], a[128:131], v[160:163]
    ds_read_b64_tr_b16 a[36:37], v227 offset:7424
    v_mfma_f32_16x16x32_bf16 v[64:67], a[88:91], a[128:131], v[64:67]
    ds_read_b64_tr_b16 a[38:39], v227 offset:9216
    v_mfma_f32_16x16x32_bf16 v[68:71], a[88:91], a[132:135], v[68:71]
    v_mfma_f32_16x16x32_bf16 v[72:75], a[88:91], a[136:139], v[72:75]
    ds_read_b64_tr_b16 a[40:41], v227 offset:160
    v_mfma_f32_16x16x32_bf16 v[76:79], a[88:91], a[140:143], v[76:79]
    ds_read_b64_tr_b16 a[42:43], v227 offset:1952
    v_mfma_f32_16x16x32_bf16 v[188:191], a[92:95], a[140:143], v[188:191]
    ds_read_b64_tr_b16 a[44:45], v227 offset:7456
    v_mfma_f32_16x16x32_bf16 v[184:187], a[92:95], a[136:139], v[184:187]
    ds_read_b64_tr_b16 a[46:47], v227 offset:9248
    v_mfma_f32_16x16x32_bf16 v[180:183], a[92:95], a[132:135], v[180:183]
    v_mfma_f32_16x16x32_bf16 v[176:179], a[92:95], a[128:131], v[176:179]
    ds_read_b64_tr_b16 a[48:49], v227 offset:192
    v_mfma_f32_16x16x32_bf16 v[80:83], a[96:99], a[128:131], v[80:83]
    ds_read_b64_tr_b16 a[50:51], v227 offset:1984
    v_mfma_f32_16x16x32_bf16 v[84:87], a[96:99], a[132:135], v[84:87]
    ds_read_b64_tr_b16 a[52:53], v227 offset:7488
    v_mfma_f32_16x16x32_bf16 v[88:91], a[96:99], a[136:139], v[88:91]
    ds_read_b64_tr_b16 a[54:55], v227 offset:9280
    v_mfma_f32_16x16x32_bf16 v[92:95], a[96:99], a[140:143], v[92:95]
    v_mfma_f32_16x16x32_bf16 v[204:207], a[100:103], a[140:143], v[204:207]
    v_mfma_f32_16x16x32_bf16 v[200:203], a[100:103], a[136:139], v[200:203]
    v_mfma_f32_16x16x32_bf16 v[196:199], a[100:103], a[132:135], v[196:199]
    v_mfma_f32_16x16x32_bf16 v[192:195], a[100:103], a[128:131], v[192:195]
    v_mfma_f32_16x16x32_bf16 v[96:99], a[104:107], a[128:131], v[96:99]
    v_mfma_f32_16x16x32_bf16 v[100:103], a[104:107], a[132:135], v[100:103]
    v_mfma_f32_16x16x32_bf16 v[104:107], a[104:107], a[136:139], v[104:107]
    v_mfma_f32_16x16x32_bf16 v[108:111], a[104:107], a[140:143], v[108:111]
    v_mfma_f32_16x16x32_bf16 v[220:223], a[108:111], a[140:143], v[220:223]
    v_mfma_f32_16x16x32_bf16 v[216:219], a[108:111], a[136:139], v[216:219]
    v_mfma_f32_16x16x32_bf16 v[212:215], a[108:111], a[132:135], v[212:215]
    v_mfma_f32_16x16x32_bf16 v[208:211], a[108:111], a[128:131], v[208:211]
    s_add_u32 s36, s36, 30848
    s_cmp_eq_u32 s36, 154240
    s_cselect_b32 s36, 0, s36
    s_waitcnt lgkmcnt(0)
    v_mfma_f32_16x16x32_bf16 v[0:3], a[0:3], a[112:115], v[0:3]
    v_mfma_f32_16x16x32_bf16 v[4:7], a[0:3], a[116:119], v[4:7]
    v_mfma_f32_16x16x32_bf16 v[8:11], a[0:3], a[120:123], v[8:11]
    v_mfma_f32_16x16x32_bf16 v[12:15], a[0:3], a[124:127], v[12:15]
    s_waitcnt vmcnt(2)
    s_barrier
    v_add_u32 v226, s36, v228
    v_add_u32 v227, s36, v229
    v_mfma_f32_16x16x32_bf16 v[124:127], a[4:7], a[124:127], v[124:127]
    ds_read_b128 a[128:131], v226 offset:0
    v_mfma_f32_16x16x32_bf16 v[120:123], a[4:7], a[120:123], v[120:123]
    ds_read_b128 a[132:135], v226 offset:256
    v_mfma_f32_16x16x32_bf16 v[116:119], a[4:7], a[116:119], v[116:119]
    ds_read_b128 a[136:139], v226 offset:512
    v_mfma_f32_16x16x32_bf16 v[112:115], a[4:7], a[112:115], v[112:115]
    ds_read_b128 a[140:143], v226 offset:768
    v_mfma_f32_16x16x32_bf16 v[16:19], a[8:11], a[112:115], v[16:19]
    v_mfma_f32_16x16x32_bf16 v[20:23], a[8:11], a[116:119], v[20:23]
    ds_read_b64_tr_b16 a[56:57], v227 offset:0
    v_mfma_f32_16x16x32_bf16 v[24:27], a[8:11], a[120:123], v[24:27]
    ds_read_b64_tr_b16 a[58:59], v227 offset:1792
    v_mfma_f32_16x16x32_bf16 v[28:31], a[8:11], a[124:127], v[28:31]
    ds_read_b64_tr_b16 a[60:61], v227 offset:7296
    v_mfma_f32_16x16x32_bf16 v[140:143], a[12:15], a[124:127], v[140:143]
    ds_read_b64_tr_b16 a[62:63], v227 offset:9088
    v_mfma_f32_16x16x32_bf16 v[136:139], a[12:15], a[120:123], v[136:139]
    v_mfma_f32_16x16x32_bf16 v[132:135], a[12:15], a[116:119], v[132:135]
    ds_read_b64_tr_b16 a[64:65], v227 offset:32
    v_mfma_f32_16x16x32_bf16 v[128:131], a[12:15], a[112:115], v[128:131]
    ds_read_b64_tr_b16 a[66:67], v227 offset:1824
    v_mfma_f32_16x16x32_bf16 v[32:35], a[16:19], a[112:115], v[32:35]
    ds_read_b64_tr_b16 a[68:69], v227 offset:7328
    v_mfma_f32_16x16x32_bf16 v[36:39], a[16:19], a[116:119], v[36:39]
    ds_read_b64_tr_b16 a[70:71], v227 offset:9120
    v_mfma_f32_16x16x32_bf16 v[40:43], a[16:19], a[120:123], v[40:43]
    v_mfma_f32_16x16x32_bf16 v[44:47], a[16:19], a[124:127], v[44:47]
    ds_read_b64_tr_b16 a[72:73], v227 offset:64
    v_mfma_f32_16x16x32_bf16 v[156:159], a[20:23], a[124:127], v[156:159]
    ds_read_b64_tr_b16 a[74:75], v227 offset:1856
    v_mfma_f32_16x16x32_bf16 v[152:155], a[20:23], a[120:123], v[152:155]
    ds_read_b64_tr_b16 a[76:77], v227 offset:7360
    v_mfma_f32_16x16x32_bf16 v[148:151], a[20:23], a[116:119], v[148:151]
    ds_read_b64_tr_b16 a[78:79], v227 offset:9152
    v_mfma_f32_16x16x32_bf16 v[144:147], a[20:23], a[112:115], v[144:147]
    v_mfma_f32_16x16x32_bf16 v[48:51], a[24:27], a[112:115], v[48:51]
    ds_read_b64_tr_b16 a[80:81], v227 offset:96
    v_mfma_f32_16x16x32_bf16 v[52:55], a[24:27], a[116:119], v[52:55]
    ds_read_b64_tr_b16 a[82:83], v227 offset:1888
    v_mfma_f32_16x16x32_bf16 v[56:59], a[24:27], a[120:123], v[56:59]
    ds_read_b64_tr_b16 a[84:85], v227 offset:7392
    v_mfma_f32_16x16x32_bf16 v[60:63], a[24:27], a[124:127], v[60:63]
    ds_read_b64_tr_b16 a[86:87], v227 offset:9184
    v_mfma_f32_16x16x32_bf16 v[172:175], a[28:31], a[124:127], v[172:175]
    v_mfma_f32_16x16x32_bf16 v[168:171], a[28:31], a[120:123], v[168:171]
    ds_read_b64_tr_b16 a[88:89], v227 offset:128
    v_mfma_f32_16x16x32_bf16 v[164:167], a[28:31], a[116:119], v[164:167]
    ds_read_b64_tr_b16 a[90:91], v227 offset:1920
    v_mfma_f32_16x16x32_bf16 v[160:163], a[28:31], a[112:115], v[160:163]
    ds_read_b64_tr_b16 a[92:93], v227 offset:7424
    v_mfma_f32_16x16x32_bf16 v[64:67], a[32:35], a[112:115], v[64:67]
    ds_read_b64_tr_b16 a[94:95], v227 offset:9216
    v_mfma_f32_16x16x32_bf16 v[68:71], a[32:35], a[116:119], v[68:71]
    v_mfma_f32_16x16x32_bf16 v[72:75], a[32:35], a[120:123], v[72:75]
    ds_read_b64_tr_b16 a[96:97], v227 offset:160
    v_mfma_f32_16x16x32_bf16 v[76:79], a[32:35], a[124:127], v[76:79]
    ds_read_b64_tr_b16 a[98:99], v227 offset:1952
    v_mfma_f32_16x16x32_bf16 v[188:191], a[36:39], a[124:127], v[188:191]
    ds_read_b64_tr_b16 a[100:101], v227 offset:7456
    v_mfma_f32_16x16x32_bf16 v[184:187], a[36:39], a[120:123], v[184:187]
    ds_read_b64_tr_b16 a[102:103], v227 offset:9248
    v_mfma_f32_16x16x32_bf16 v[180:183], a[36:39], a[116:119], v[180:183]
    v_mfma_f32_16x16x32_bf16 v[176:179], a[36:39], a[112:115], v[176:179]
    ds_read_b64_tr_b16 a[104:105], v227 offset:192
    v_mfma_f32_16x16x32_bf16 v[80:83], a[40:43], a[112:115], v[80:83]
    ds_read_b64_tr_b16 a[106:107], v227 offset:1984
    v_mfma_f32_16x16x32_bf16 v[84:87], a[40:43], a[116:119], v[84:87]
    ds_read_b64_tr_b16 a[108:109], v227 offset:7488
    v_mfma_f32_16x16x32_bf16 v[88:91], a[40:43], a[120:123], v[88:91]
    ds_read_b64_tr_b16 a[110:111], v227 offset:9280
    v_mfma_f32_16x16x32_bf16 v[92:95], a[40:43], a[124:127], v[92:95]
    v_mfma_f32_16x16x32_bf16 v[204:207], a[44:47], a[124:127], v[204:207]
    v_mfma_f32_16x16x32_bf16 v[200:203], a[44:47], a[120:123], v[200:203]
    v_mfma_f32_16x16x32_bf16 v[196:199], a[44:47], a[116:119], v[196:199]
    v_mfma_f32_16x16x32_bf16 v[192:195], a[44:47], a[112:115], v[192:195]
    v_mfma_f32_16x16x32_bf16 v[96:99], a[48:51], a[112:115], v[96:99]
    v_mfma_f32_16x16x32_bf16 v[100:103], a[48:51], a[116:119], v[100:103]
    v_mfma_f32_16x16x32_bf16 v[104:107], a[48:51], a[120:123], v[104:107]
    v_mfma_f32_16x16x32_bf16 v[108:111], a[48:51], a[124:127], v[108:111]
    v_mfma_f32_16x16x32_bf16 v[220:223], a[52:55], a[124:127], v[220:223]
    v_mfma_f32_16x16x32_bf16 v[216:219], a[52:55], a[120:123], v[216:219]
    v_mfma_f32_16x16x32_bf16 v[212:215], a[52:55], a[116:119], v[212:215]
    v_mfma_f32_16x16x32_bf16 v[208:211], a[52:55], a[112:115], v[208:211]
    s_add_u32 s36, s36, 30848
    s_cmp_eq_u32 s36, 154240
    s_cselect_b32 s36, 0, s36
    s_lshl_b32 s14, s3, 8
    v_add_u32 v236, s14, v225
    v_lshrrev_b32 v237, 4, v236
    v_and_b32 v238, 3, v237
    v_lshlrev_b32 v238, 2, v238
    v_and_b32 v239, 15, v236
    v_xor_b32 v238, v238, v239
    v_lshlrev_b32 v238, 4, v238
    v_lshlrev_b32 v237, 11, v237
    v_add_u32 v244, v237, v238
    s_lshl_b32 s14, s3, 8
    v_add_u32 v236, s14, v225
    v_add_u32 v236, 64, v236
    v_lshrrev_b32 v237, 4, v236
    v_and_b32 v238, 3, v237
    v_lshlrev_b32 v238, 2, v238
    v_and_b32 v239, 15, v236
    v_xor_b32 v238, v238, v239
    v_lshlrev_b32 v238, 4, v238
    v_lshlrev_b32 v237, 11, v237
    v_add_u32 v245, v237, v238
    v_subrev_u32 v245, 1024, v245
    s_lshl_b32 s14, s3, 8
    v_add_u32 v236, s14, v225
    v_add_u32 v236, 128, v236
    v_lshrrev_b32 v237, 4, v236
    v_and_b32 v238, 3, v237
    v_lshlrev_b32 v238, 2, v238
    v_and_b32 v239, 15, v236
    v_xor_b32 v238, v238, v239
    v_lshlrev_b32 v238, 4, v238
    v_lshlrev_b32 v237, 11, v237
    v_add_u32 v246, v237, v238
    v_subrev_u32 v246, 2048, v246
    s_lshl_b32 s14, s3, 8
    v_add_u32 v236, s14, v225
    v_add_u32 v236, 192, v236
    v_lshrrev_b32 v237, 4, v236
    v_and_b32 v238, 3, v237
    v_lshlrev_b32 v238, 2, v238
    v_and_b32 v239, 15, v236
    v_xor_b32 v238, v238, v239
    v_lshlrev_b32 v238, 4, v238
    v_lshlrev_b32 v237, 11, v237
    v_add_u32 v247, v237, v238
    v_subrev_u32 v247, 3072, v247
    s_lshl_b32 s83, s82, 8
    s_lshl_b32 s33, s3, 12
    s_add_u32 s33, s33, 16384
    s_waitcnt lgkmcnt(0)
    v_mfma_f32_16x16x32_bf16 v[0:3], a[56:59], a[128:131], v[0:3]
    v_mfma_f32_16x16x32_bf16 v[4:7], a[56:59], a[132:135], v[4:7]
    v_mfma_f32_16x16x32_bf16 v[8:11], a[56:59], a[136:139], v[8:11]
    v_mfma_f32_16x16x32_bf16 v[12:15], a[56:59], a[140:143], v[12:15]
    s_barrier
    v_mfma_f32_16x16x32_bf16 v[124:127], a[60:63], a[140:143], v[124:127]
    v_mfma_f32_16x16x32_bf16 v[120:123], a[60:63], a[136:139], v[120:123]
    v_mfma_f32_16x16x32_bf16 v[116:119], a[60:63], a[132:135], v[116:119]
    v_mfma_f32_16x16x32_bf16 v[112:115], a[60:63], a[128:131], v[112:115]
    v_mfma_f32_16x16x32_bf16 v[16:19], a[64:67], a[128:131], v[16:19]
    v_mfma_f32_16x16x32_bf16 v[20:23], a[64:67], a[132:135], v[20:23]
    v_mfma_f32_16x16x32_bf16 v[24:27], a[64:67], a[136:139], v[24:27]
    v_mfma_f32_16x16x32_bf16 v[28:31], a[64:67], a[140:143], v[28:31]
    v_mfma_f32_16x16x32_bf16 v[140:143], a[68:71], a[140:143], v[140:143]
    v_mfma_f32_16x16x32_bf16 v[136:139], a[68:71], a[136:139], v[136:139]
    v_mfma_f32_16x16x32_bf16 v[132:135], a[68:71], a[132:135], v[132:135]
    v_mfma_f32_16x16x32_bf16 v[128:131], a[68:71], a[128:131], v[128:131]
    v_mfma_f32_16x16x32_bf16 v[32:35], a[72:75], a[128:131], v[32:35]
    v_mfma_f32_16x16x32_bf16 v[36:39], a[72:75], a[132:135], v[36:39]
    v_mfma_f32_16x16x32_bf16 v[40:43], a[72:75], a[136:139], v[40:43]
    v_mfma_f32_16x16x32_bf16 v[44:47], a[72:75], a[140:143], v[44:47]
    v_mfma_f32_16x16x32_bf16 v[156:159], a[76:79], a[140:143], v[156:159]
    v_mfma_f32_16x16x32_bf16 v[152:155], a[76:79], a[136:139], v[152:155]
    v_mfma_f32_16x16x32_bf16 v[148:151], a[76:79], a[132:135], v[148:151]
    v_mfma_f32_16x16x32_bf16 v[144:147], a[76:79], a[128:131], v[144:147]
    v_mfma_f32_16x16x32_bf16 v[48:51], a[80:83], a[128:131], v[48:51]
    v_mfma_f32_16x16x32_bf16 v[52:55], a[80:83], a[132:135], v[52:55]
    v_mfma_f32_16x16x32_bf16 v[56:59], a[80:83], a[136:139], v[56:59]
    v_mfma_f32_16x16x32_bf16 v[60:63], a[80:83], a[140:143], v[60:63]
    v_mfma_f32_16x16x32_bf16 v[172:175], a[84:87], a[140:143], v[172:175]
    v_mfma_f32_16x16x32_bf16 v[168:171], a[84:87], a[136:139], v[168:171]
    v_mfma_f32_16x16x32_bf16 v[164:167], a[84:87], a[132:135], v[164:167]
    v_mfma_f32_16x16x32_bf16 v[160:163], a[84:87], a[128:131], v[160:163]
    v_mfma_f32_16x16x32_bf16 v[64:67], a[88:91], a[128:131], v[64:67]
    v_mfma_f32_16x16x32_bf16 v[68:71], a[88:91], a[132:135], v[68:71]
    v_mfma_f32_16x16x32_bf16 v[72:75], a[88:91], a[136:139], v[72:75]
    v_mfma_f32_16x16x32_bf16 v[76:79], a[88:91], a[140:143], v[76:79]
    v_mfma_f32_16x16x32_bf16 v[188:191], a[92:95], a[140:143], v[188:191]
    v_mfma_f32_16x16x32_bf16 v[184:187], a[92:95], a[136:139], v[184:187]
    v_mfma_f32_16x16x32_bf16 v[180:183], a[92:95], a[132:135], v[180:183]
    v_mfma_f32_16x16x32_bf16 v[176:179], a[92:95], a[128:131], v[176:179]
    v_mfma_f32_16x16x32_bf16 v[80:83], a[96:99], a[128:131], v[80:83]
    v_mfma_f32_16x16x32_bf16 v[84:87], a[96:99], a[132:135], v[84:87]
    v_mfma_f32_16x16x32_bf16 v[88:91], a[96:99], a[136:139], v[88:91]
    v_mfma_f32_16x16x32_bf16 v[92:95], a[96:99], a[140:143], v[92:95]
    v_mfma_f32_16x16x32_bf16 v[204:207], a[100:103], a[140:143], v[204:207]
    v_mfma_f32_16x16x32_bf16 v[200:203], a[100:103], a[136:139], v[200:203]
    v_mfma_f32_16x16x32_bf16 v[196:199], a[100:103], a[132:135], v[196:199]
    v_mfma_f32_16x16x32_bf16 v[192:195], a[100:103], a[128:131], v[192:195]
    v_mfma_f32_16x16x32_bf16 v[96:99], a[104:107], a[128:131], v[96:99]
    v_mfma_f32_16x16x32_bf16 v[100:103], a[104:107], a[132:135], v[100:103]
    v_mfma_f32_16x16x32_bf16 v[104:107], a[104:107], a[136:139], v[104:107]
    v_mfma_f32_16x16x32_bf16 v[108:111], a[104:107], a[140:143], v[108:111]
    v_mfma_f32_16x16x32_bf16 v[220:223], a[108:111], a[140:143], v[220:223]
    v_mfma_f32_16x16x32_bf16 v[216:219], a[108:111], a[136:139], v[216:219]
    v_mfma_f32_16x16x32_bf16 v[212:215], a[108:111], a[132:135], v[212:215]
    v_mfma_f32_16x16x32_bf16 v[208:211], a[108:111], a[128:131], v[208:211]
    s_add_u32 s36, s36, 30848
    s_cmp_eq_u32 s36, 154240
    s_cselect_b32 s36, 0, s36
    s_add_u32 s16, s4, 16777216
    s_addc_u32 s17, s5, 0
    s_mov_b32 s18, 14680064
    s_mov_b32 s19, 0x00020000
    s_lshl_b32 s14, s6, 1
    s_lshr_b32 s15, s3, 1
    s_add_u32 s14, s14, s15
    s_mul_i32 s14, s14, 917504
    s_mul_i32 s15, s7, 28672
    s_add_u32 s14, s14, s15
    s_and_b32 s15, s3, 1
    s_lshl_b32 s15, s15, 10
    s_add_u32 s14, s14, s15
    v_lshrrev_b32 v236, 5, v225
    v_lshlrev_b32 v236, 11, v236
    v_and_b32 v237, 31, v225
    v_lshlrev_b32 v237, 4, v237
    v_add_u32 v226, v236, v237
    v_add_u32 v226, s14, v226
    v_mov_b32 v228, 0xbdd2d3e8
    v_mov_b32 v229, 0xbdd2d3e8
    v_mov_b32 v230, 0xc0135761
    v_mov_b32 v231, 0xc0135761
    v_mov_b32 v238, 1.0
    v_mov_b32 v239, 1.0
    v_pk_mul_f32 v[232:233], v[0:1], v[0:1]
    v_pk_mul_f32 v[240:241], v[2:3], v[2:3]
    v_pk_fma_f32 v[232:233], v[232:233], v[228:229], v[230:231]
    v_pk_fma_f32 v[240:241], v[240:241], v[228:229], v[230:231]
    v_pk_mul_f32 v[232:233], v[232:233], v[0:1]
    v_pk_mul_f32 v[240:241], v[240:241], v[2:3]
    v_exp_f32 v232, v232
    v_exp_f32 v233, v233
    v_exp_f32 v240, v240
    v_exp_f32 v241, v241
    v_pk_mul_f32 v[234:235], v[0:1], v[112:113]
    v_pk_add_f32 v[232:233], v[232:233], v[238:239]
    v_pk_add_f32 v[240:241], v[240:241], v[238:239]
    v_pk_mul_f32 v[242:243], v[2:3], v[114:115]
    v_rcp_f32 v232, v232
    v_rcp_f32 v233, v233
    v_rcp_f32 v240, v240
    v_rcp_f32 v241, v241
    v_pk_mul_f32 v[232:233], v[232:233], v[234:235]
    v_pk_mul_f32 v[240:241], v[240:241], v[242:243]
    v_cvt_pk_bf16_f32 v248, v232, v233
    v_cvt_pk_bf16_f32 v249, v240, v241
    s_mov_b32 s37, 0
    s_add_u32 m0, s37, s33
    s_nop 0
    buffer_load_dwordx4 v244, s[84:87], s83 offen offset:0 lds
    v_pk_mul_f32 v[232:233], v[4:5], v[4:5]
    v_pk_mul_f32 v[240:241], v[6:7], v[6:7]
    v_pk_fma_f32 v[232:233], v[232:233], v[228:229], v[230:231]
    v_pk_fma_f32 v[240:241], v[240:241], v[228:229], v[230:231]
    v_pk_mul_f32 v[232:233], v[232:233], v[4:5]
    v_pk_mul_f32 v[240:241], v[240:241], v[6:7]
    v_exp_f32 v232, v232
    v_exp_f32 v233, v233
    v_exp_f32 v240, v240
    v_exp_f32 v241, v241
    v_pk_mul_f32 v[234:235], v[4:5], v[116:117]
    v_pk_add_f32 v[232:233], v[232:233], v[238:239]
    v_pk_add_f32 v[240:241], v[240:241], v[238:239]
    v_pk_mul_f32 v[242:243], v[6:7], v[118:119]
    v_rcp_f32 v232, v232
    v_rcp_f32 v233, v233
    v_rcp_f32 v240, v240
    v_rcp_f32 v241, v241
    v_pk_mul_f32 v[232:233], v[232:233], v[234:235]
    v_pk_mul_f32 v[240:241], v[240:241], v[242:243]
    v_cvt_pk_bf16_f32 v250, v232, v233
    v_cvt_pk_bf16_f32 v251, v240, v241
    buffer_load_dwordx4 v245, s[84:87], s83 offen offset:1024 lds
    v_permlane16_swap_b32 v248, v250
    v_permlane16_swap_b32 v249, v251
    s_mov_b32 s14, 0
    buffer_store_dwordx4 v[248:251], v226, s[16:19], s14 offen offset:0 sc1
    v_pk_mul_f32 v[232:233], v[8:9], v[8:9]
    v_pk_mul_f32 v[240:241], v[10:11], v[10:11]
    v_pk_fma_f32 v[232:233], v[232:233], v[228:229], v[230:231]
    v_pk_fma_f32 v[240:241], v[240:241], v[228:229], v[230:231]
    v_pk_mul_f32 v[232:233], v[232:233], v[8:9]
    v_pk_mul_f32 v[240:241], v[240:241], v[10:11]
    v_exp_f32 v232, v232
    v_exp_f32 v233, v233
    v_exp_f32 v240, v240
    v_exp_f32 v241, v241
    v_pk_mul_f32 v[234:235], v[8:9], v[120:121]
    v_pk_add_f32 v[232:233], v[232:233], v[238:239]
    v_pk_add_f32 v[240:241], v[240:241], v[238:239]
    v_pk_mul_f32 v[242:243], v[10:11], v[122:123]
    v_rcp_f32 v232, v232
    v_rcp_f32 v233, v233
    v_rcp_f32 v240, v240
    v_rcp_f32 v241, v241
    v_pk_mul_f32 v[232:233], v[232:233], v[234:235]
    v_pk_mul_f32 v[240:241], v[240:241], v[242:243]
    v_cvt_pk_bf16_f32 v252, v232, v233
    v_cvt_pk_bf16_f32 v253, v240, v241
    buffer_load_dwordx4 v246, s[84:87], s83 offen offset:2048 lds
    v_pk_mul_f32 v[232:233], v[12:13], v[12:13]
    v_pk_mul_f32 v[240:241], v[14:15], v[14:15]
    v_pk_fma_f32 v[232:233], v[232:233], v[228:229], v[230:231]
    v_pk_fma_f32 v[240:241], v[240:241], v[228:229], v[230:231]
    v_pk_mul_f32 v[232:233], v[232:233], v[12:13]
    v_pk_mul_f32 v[240:241], v[240:241], v[14:15]
    v_exp_f32 v232, v232
    v_exp_f32 v233, v233
    v_exp_f32 v240, v240
    v_exp_f32 v241, v241
    v_pk_mul_f32 v[234:235], v[12:13], v[124:125]
    v_pk_add_f32 v[232:233], v[232:233], v[238:239]
    v_pk_add_f32 v[240:241], v[240:241], v[238:239]
    v_pk_mul_f32 v[242:243], v[14:15], v[126:127]
    v_rcp_f32 v232, v232
    v_rcp_f32 v233, v233
    v_rcp_f32 v240, v240
    v_rcp_f32 v241, v241
    v_pk_mul_f32 v[232:233], v[232:233], v[234:235]
    v_pk_mul_f32 v[240:241], v[240:241], v[242:243]
    v_cvt_pk_bf16_f32 v254, v232, v233
    v_cvt_pk_bf16_f32 v255, v240, v241
    buffer_load_dwordx4 v247, s[84:87], s83 offen offset:3072 lds
    v_permlane16_swap_b32 v252, v254
    v_permlane16_swap_b32 v253, v255
    s_mov_b32 s14, 0
    buffer_store_dwordx4 v[252:255], v226, s[16:19], s14 offen offset:512 sc1
    v_pk_mul_f32 v[232:233], v[16:17], v[16:17]
    v_pk_mul_f32 v[240:241], v[18:19], v[18:19]
    v_pk_fma_f32 v[232:233], v[232:233], v[228:229], v[230:231]
    v_pk_fma_f32 v[240:241], v[240:241], v[228:229], v[230:231]
    v_pk_mul_f32 v[232:233], v[232:233], v[16:17]
    v_pk_mul_f32 v[240:241], v[240:241], v[18:19]
    v_exp_f32 v232, v232
    v_exp_f32 v233, v233
    v_exp_f32 v240, v240
    v_exp_f32 v241, v241
    v_pk_mul_f32 v[234:235], v[16:17], v[128:129]
    v_pk_add_f32 v[232:233], v[232:233], v[238:239]
    v_pk_add_f32 v[240:241], v[240:241], v[238:239]
    v_pk_mul_f32 v[242:243], v[18:19], v[130:131]
    v_rcp_f32 v232, v232
    v_rcp_f32 v233, v233
    v_rcp_f32 v240, v240
    v_rcp_f32 v241, v241
    v_pk_mul_f32 v[232:233], v[232:233], v[234:235]
    v_pk_mul_f32 v[240:241], v[240:241], v[242:243]
    v_cvt_pk_bf16_f32 v248, v232, v233
    v_cvt_pk_bf16_f32 v249, v240, v241
    s_add_u32 s83, s83, 131072
    s_mov_b32 s37, 32768
    s_add_u32 m0, s37, s33
    s_nop 0
    buffer_load_dwordx4 v244, s[84:87], s83 offen offset:0 lds
    v_pk_mul_f32 v[232:233], v[20:21], v[20:21]
    v_pk_mul_f32 v[240:241], v[22:23], v[22:23]
    v_pk_fma_f32 v[232:233], v[232:233], v[228:229], v[230:231]
    v_pk_fma_f32 v[240:241], v[240:241], v[228:229], v[230:231]
    v_pk_mul_f32 v[232:233], v[232:233], v[20:21]
    v_pk_mul_f32 v[240:241], v[240:241], v[22:23]
    v_exp_f32 v232, v232
    v_exp_f32 v233, v233
    v_exp_f32 v240, v240
    v_exp_f32 v241, v241
    v_pk_mul_f32 v[234:235], v[20:21], v[132:133]
    v_pk_add_f32 v[232:233], v[232:233], v[238:239]
    v_pk_add_f32 v[240:241], v[240:241], v[238:239]
    v_pk_mul_f32 v[242:243], v[22:23], v[134:135]
    v_rcp_f32 v232, v232
    v_rcp_f32 v233, v233
    v_rcp_f32 v240, v240
    v_rcp_f32 v241, v241
    v_pk_mul_f32 v[232:233], v[232:233], v[234:235]
    v_pk_mul_f32 v[240:241], v[240:241], v[242:243]
    v_cvt_pk_bf16_f32 v250, v232, v233
    v_cvt_pk_bf16_f32 v251, v240, v241
    buffer_load_dwordx4 v245, s[84:87], s83 offen offset:1024 lds
    v_permlane16_swap_b32 v248, v250
    v_permlane16_swap_b32 v249, v251
    s_mov_b32 s14, 4096
    buffer_store_dwordx4 v[248:251], v226, s[16:19], s14 offen offset:0 sc1
    v_pk_mul_f32 v[232:233], v[24:25], v[24:25]
    v_pk_mul_f32 v[240:241], v[26:27], v[26:27]
    v_pk_fma_f32 v[232:233], v[232:233], v[228:229], v[230:231]
    v_pk_fma_f32 v[240:241], v[240:241], v[228:229], v[230:231]
    v_pk_mul_f32 v[232:233], v[232:233], v[24:25]
    v_pk_mul_f32 v[240:241], v[240:241], v[26:27]
    v_exp_f32 v232, v232
    v_exp_f32 v233, v233
    v_exp_f32 v240, v240
    v_exp_f32 v241, v241
    v_pk_mul_f32 v[234:235], v[24:25], v[136:137]
    v_pk_add_f32 v[232:233], v[232:233], v[238:239]
    v_pk_add_f32 v[240:241], v[240:241], v[238:239]
    v_pk_mul_f32 v[242:243], v[26:27], v[138:139]
    v_rcp_f32 v232, v232
    v_rcp_f32 v233, v233
    v_rcp_f32 v240, v240
    v_rcp_f32 v241, v241
    v_pk_mul_f32 v[232:233], v[232:233], v[234:235]
    v_pk_mul_f32 v[240:241], v[240:241], v[242:243]
    v_cvt_pk_bf16_f32 v252, v232, v233
    v_cvt_pk_bf16_f32 v253, v240, v241
    buffer_load_dwordx4 v246, s[84:87], s83 offen offset:2048 lds
    v_pk_mul_f32 v[232:233], v[28:29], v[28:29]
    v_pk_mul_f32 v[240:241], v[30:31], v[30:31]
    v_pk_fma_f32 v[232:233], v[232:233], v[228:229], v[230:231]
    v_pk_fma_f32 v[240:241], v[240:241], v[228:229], v[230:231]
    v_pk_mul_f32 v[232:233], v[232:233], v[28:29]
    v_pk_mul_f32 v[240:241], v[240:241], v[30:31]
    v_exp_f32 v232, v232
    v_exp_f32 v233, v233
    v_exp_f32 v240, v240
    v_exp_f32 v241, v241
    v_pk_mul_f32 v[234:235], v[28:29], v[140:141]
    v_pk_add_f32 v[232:233], v[232:233], v[238:239]
    v_pk_add_f32 v[240:241], v[240:241], v[238:239]
    v_pk_mul_f32 v[242:243], v[30:31], v[142:143]
    v_rcp_f32 v232, v232
    v_rcp_f32 v233, v233
    v_rcp_f32 v240, v240
    v_rcp_f32 v241, v241
    v_pk_mul_f32 v[232:233], v[232:233], v[234:235]
    v_pk_mul_f32 v[240:241], v[240:241], v[242:243]
    v_cvt_pk_bf16_f32 v254, v232, v233
    v_cvt_pk_bf16_f32 v255, v240, v241
    buffer_load_dwordx4 v247, s[84:87], s83 offen offset:3072 lds
    v_permlane16_swap_b32 v252, v254
    v_permlane16_swap_b32 v253, v255
    s_mov_b32 s14, 4096
    buffer_store_dwordx4 v[252:255], v226, s[16:19], s14 offen offset:512 sc1
    v_pk_mul_f32 v[232:233], v[32:33], v[32:33]
    v_pk_mul_f32 v[240:241], v[34:35], v[34:35]
    v_pk_fma_f32 v[232:233], v[232:233], v[228:229], v[230:231]
    v_pk_fma_f32 v[240:241], v[240:241], v[228:229], v[230:231]
    v_pk_mul_f32 v[232:233], v[232:233], v[32:33]
    v_pk_mul_f32 v[240:241], v[240:241], v[34:35]
    v_exp_f32 v232, v232
    v_exp_f32 v233, v233
    v_exp_f32 v240, v240
    v_exp_f32 v241, v241
    v_pk_mul_f32 v[234:235], v[32:33], v[144:145]
    v_pk_add_f32 v[232:233], v[232:233], v[238:239]
    v_pk_add_f32 v[240:241], v[240:241], v[238:239]
    v_pk_mul_f32 v[242:243], v[34:35], v[146:147]
    v_rcp_f32 v232, v232
    v_rcp_f32 v233, v233
    v_rcp_f32 v240, v240
    v_rcp_f32 v241, v241
    v_pk_mul_f32 v[232:233], v[232:233], v[234:235]
    v_pk_mul_f32 v[240:241], v[240:241], v[242:243]
    v_cvt_pk_bf16_f32 v248, v232, v233
    v_cvt_pk_bf16_f32 v249, v240, v241
    s_add_u32 s83, s83, 131072
    s_mov_b32 s37, 65536
    s_add_u32 m0, s37, s33
    s_nop 0
    buffer_load_dwordx4 v244, s[84:87], s83 offen offset:0 lds
    v_pk_mul_f32 v[232:233], v[36:37], v[36:37]
    v_pk_mul_f32 v[240:241], v[38:39], v[38:39]
    v_pk_fma_f32 v[232:233], v[232:233], v[228:229], v[230:231]
    v_pk_fma_f32 v[240:241], v[240:241], v[228:229], v[230:231]
    v_pk_mul_f32 v[232:233], v[232:233], v[36:37]
    v_pk_mul_f32 v[240:241], v[240:241], v[38:39]
    v_exp_f32 v232, v232
    v_exp_f32 v233, v233
    v_exp_f32 v240, v240
    v_exp_f32 v241, v241
    v_pk_mul_f32 v[234:235], v[36:37], v[148:149]
    v_pk_add_f32 v[232:233], v[232:233], v[238:239]
    v_pk_add_f32 v[240:241], v[240:241], v[238:239]
    v_pk_mul_f32 v[242:243], v[38:39], v[150:151]
    v_rcp_f32 v232, v232
    v_rcp_f32 v233, v233
    v_rcp_f32 v240, v240
    v_rcp_f32 v241, v241
    v_pk_mul_f32 v[232:233], v[232:233], v[234:235]
    v_pk_mul_f32 v[240:241], v[240:241], v[242:243]
    v_cvt_pk_bf16_f32 v250, v232, v233
    v_cvt_pk_bf16_f32 v251, v240, v241
    buffer_load_dwordx4 v245, s[84:87], s83 offen offset:1024 lds
    v_permlane16_swap_b32 v248, v250
    v_permlane16_swap_b32 v249, v251
    s_mov_b32 s14, 8192
    buffer_store_dwordx4 v[248:251], v226, s[16:19], s14 offen offset:0 sc1
    v_pk_mul_f32 v[232:233], v[40:41], v[40:41]
    v_pk_mul_f32 v[240:241], v[42:43], v[42:43]
    v_pk_fma_f32 v[232:233], v[232:233], v[228:229], v[230:231]
    v_pk_fma_f32 v[240:241], v[240:241], v[228:229], v[230:231]
    v_pk_mul_f32 v[232:233], v[232:233], v[40:41]
    v_pk_mul_f32 v[240:241], v[240:241], v[42:43]
    v_exp_f32 v232, v232
    v_exp_f32 v233, v233
    v_exp_f32 v240, v240
    v_exp_f32 v241, v241
    v_pk_mul_f32 v[234:235], v[40:41], v[152:153]
    v_pk_add_f32 v[232:233], v[232:233], v[238:239]
    v_pk_add_f32 v[240:241], v[240:241], v[238:239]
    v_pk_mul_f32 v[242:243], v[42:43], v[154:155]
    v_rcp_f32 v232, v232
    v_rcp_f32 v233, v233
    v_rcp_f32 v240, v240
    v_rcp_f32 v241, v241
    v_pk_mul_f32 v[232:233], v[232:233], v[234:235]
    v_pk_mul_f32 v[240:241], v[240:241], v[242:243]
    v_cvt_pk_bf16_f32 v252, v232, v233
    v_cvt_pk_bf16_f32 v253, v240, v241
    buffer_load_dwordx4 v246, s[84:87], s83 offen offset:2048 lds
    v_pk_mul_f32 v[232:233], v[44:45], v[44:45]
    v_pk_mul_f32 v[240:241], v[46:47], v[46:47]
    v_pk_fma_f32 v[232:233], v[232:233], v[228:229], v[230:231]
    v_pk_fma_f32 v[240:241], v[240:241], v[228:229], v[230:231]
    v_pk_mul_f32 v[232:233], v[232:233], v[44:45]
    v_pk_mul_f32 v[240:241], v[240:241], v[46:47]
    v_exp_f32 v232, v232
    v_exp_f32 v233, v233
    v_exp_f32 v240, v240
    v_exp_f32 v241, v241
    v_pk_mul_f32 v[234:235], v[44:45], v[156:157]
    v_pk_add_f32 v[232:233], v[232:233], v[238:239]
    v_pk_add_f32 v[240:241], v[240:241], v[238:239]
    v_pk_mul_f32 v[242:243], v[46:47], v[158:159]
    v_rcp_f32 v232, v232
    v_rcp_f32 v233, v233
    v_rcp_f32 v240, v240
    v_rcp_f32 v241, v241
    v_pk_mul_f32 v[232:233], v[232:233], v[234:235]
    v_pk_mul_f32 v[240:241], v[240:241], v[242:243]
    v_cvt_pk_bf16_f32 v254, v232, v233
    v_cvt_pk_bf16_f32 v255, v240, v241
    buffer_load_dwordx4 v247, s[84:87], s83 offen offset:3072 lds
    v_permlane16_swap_b32 v252, v254
    v_permlane16_swap_b32 v253, v255
    s_mov_b32 s14, 8192
    buffer_store_dwordx4 v[252:255], v226, s[16:19], s14 offen offset:512 sc1
    v_pk_mul_f32 v[232:233], v[48:49], v[48:49]
    v_pk_mul_f32 v[240:241], v[50:51], v[50:51]
    v_pk_fma_f32 v[232:233], v[232:233], v[228:229], v[230:231]
    v_pk_fma_f32 v[240:241], v[240:241], v[228:229], v[230:231]
    v_pk_mul_f32 v[232:233], v[232:233], v[48:49]
    v_pk_mul_f32 v[240:241], v[240:241], v[50:51]
    v_exp_f32 v232, v232
    v_exp_f32 v233, v233
    v_exp_f32 v240, v240
    v_exp_f32 v241, v241
    v_pk_mul_f32 v[234:235], v[48:49], v[160:161]
    v_pk_add_f32 v[232:233], v[232:233], v[238:239]
    v_pk_add_f32 v[240:241], v[240:241], v[238:239]
    v_pk_mul_f32 v[242:243], v[50:51], v[162:163]
    v_rcp_f32 v232, v232
    v_rcp_f32 v233, v233
    v_rcp_f32 v240, v240
    v_rcp_f32 v241, v241
    v_pk_mul_f32 v[232:233], v[232:233], v[234:235]
    v_pk_mul_f32 v[240:241], v[240:241], v[242:243]
    v_cvt_pk_bf16_f32 v248, v232, v233
    v_cvt_pk_bf16_f32 v249, v240, v241
    s_add_u32 s83, s83, 131072
    s_mov_b32 s37, 98304
    s_add_u32 m0, s37, s33
    s_nop 0
    buffer_load_dwordx4 v244, s[84:87], s83 offen offset:0 lds
    v_pk_mul_f32 v[232:233], v[52:53], v[52:53]
    v_pk_mul_f32 v[240:241], v[54:55], v[54:55]
    v_pk_fma_f32 v[232:233], v[232:233], v[228:229], v[230:231]
    v_pk_fma_f32 v[240:241], v[240:241], v[228:229], v[230:231]
    v_pk_mul_f32 v[232:233], v[232:233], v[52:53]
    v_pk_mul_f32 v[240:241], v[240:241], v[54:55]
    v_exp_f32 v232, v232
    v_exp_f32 v233, v233
    v_exp_f32 v240, v240
    v_exp_f32 v241, v241
    v_pk_mul_f32 v[234:235], v[52:53], v[164:165]
    v_pk_add_f32 v[232:233], v[232:233], v[238:239]
    v_pk_add_f32 v[240:241], v[240:241], v[238:239]
    v_pk_mul_f32 v[242:243], v[54:55], v[166:167]
    v_rcp_f32 v232, v232
    v_rcp_f32 v233, v233
    v_rcp_f32 v240, v240
    v_rcp_f32 v241, v241
    v_pk_mul_f32 v[232:233], v[232:233], v[234:235]
    v_pk_mul_f32 v[240:241], v[240:241], v[242:243]
    v_cvt_pk_bf16_f32 v250, v232, v233
    v_cvt_pk_bf16_f32 v251, v240, v241
    buffer_load_dwordx4 v245, s[84:87], s83 offen offset:1024 lds
    v_permlane16_swap_b32 v248, v250
    v_permlane16_swap_b32 v249, v251
    s_mov_b32 s14, 12288
    buffer_store_dwordx4 v[248:251], v226, s[16:19], s14 offen offset:0 sc1
    v_pk_mul_f32 v[232:233], v[56:57], v[56:57]
    v_pk_mul_f32 v[240:241], v[58:59], v[58:59]
    v_pk_fma_f32 v[232:233], v[232:233], v[228:229], v[230:231]
    v_pk_fma_f32 v[240:241], v[240:241], v[228:229], v[230:231]
    v_pk_mul_f32 v[232:233], v[232:233], v[56:57]
    v_pk_mul_f32 v[240:241], v[240:241], v[58:59]
    v_exp_f32 v232, v232
    v_exp_f32 v233, v233
    v_exp_f32 v240, v240
    v_exp_f32 v241, v241
    v_pk_mul_f32 v[234:235], v[56:57], v[168:169]
    v_pk_add_f32 v[232:233], v[232:233], v[238:239]
    v_pk_add_f32 v[240:241], v[240:241], v[238:239]
    v_pk_mul_f32 v[242:243], v[58:59], v[170:171]
    v_rcp_f32 v232, v232
    v_rcp_f32 v233, v233
    v_rcp_f32 v240, v240
    v_rcp_f32 v241, v241
    v_pk_mul_f32 v[232:233], v[232:233], v[234:235]
    v_pk_mul_f32 v[240:241], v[240:241], v[242:243]
    v_cvt_pk_bf16_f32 v252, v232, v233
    v_cvt_pk_bf16_f32 v253, v240, v241
    buffer_load_dwordx4 v246, s[84:87], s83 offen offset:2048 lds
    v_pk_mul_f32 v[232:233], v[60:61], v[60:61]
    v_pk_mul_f32 v[240:241], v[62:63], v[62:63]
    v_pk_fma_f32 v[232:233], v[232:233], v[228:229], v[230:231]
    v_pk_fma_f32 v[240:241], v[240:241], v[228:229], v[230:231]
    v_pk_mul_f32 v[232:233], v[232:233], v[60:61]
    v_pk_mul_f32 v[240:241], v[240:241], v[62:63]
    v_exp_f32 v232, v232
    v_exp_f32 v233, v233
    v_exp_f32 v240, v240
    v_exp_f32 v241, v241
    v_pk_mul_f32 v[234:235], v[60:61], v[172:173]
    v_pk_add_f32 v[232:233], v[232:233], v[238:239]
    v_pk_add_f32 v[240:241], v[240:241], v[238:239]
    v_pk_mul_f32 v[242:243], v[62:63], v[174:175]
    v_rcp_f32 v232, v232
    v_rcp_f32 v233, v233
    v_rcp_f32 v240, v240
    v_rcp_f32 v241, v241
    v_pk_mul_f32 v[232:233], v[232:233], v[234:235]
    v_pk_mul_f32 v[240:241], v[240:241], v[242:243]
    v_cvt_pk_bf16_f32 v254, v232, v233
    v_cvt_pk_bf16_f32 v255, v240, v241
    buffer_load_dwordx4 v247, s[84:87], s83 offen offset:3072 lds
    v_permlane16_swap_b32 v252, v254
    v_permlane16_swap_b32 v253, v255
    s_mov_b32 s14, 12288
    buffer_store_dwordx4 v[252:255], v226, s[16:19], s14 offen offset:512 sc1
    v_pk_mul_f32 v[232:233], v[64:65], v[64:65]
    v_pk_mul_f32 v[240:241], v[66:67], v[66:67]
    v_pk_fma_f32 v[232:233], v[232:233], v[228:229], v[230:231]
    v_pk_fma_f32 v[240:241], v[240:241], v[228:229], v[230:231]
    v_pk_mul_f32 v[232:233], v[232:233], v[64:65]
    v_pk_mul_f32 v[240:241], v[240:241], v[66:67]
    v_exp_f32 v232, v232
    v_exp_f32 v233, v233
    v_exp_f32 v240, v240
    v_exp_f32 v241, v241
    v_pk_mul_f32 v[234:235], v[64:65], v[176:177]
    v_pk_add_f32 v[232:233], v[232:233], v[238:239]
    v_pk_add_f32 v[240:241], v[240:241], v[238:239]
    v_pk_mul_f32 v[242:243], v[66:67], v[178:179]
    v_rcp_f32 v232, v232
    v_rcp_f32 v233, v233
    v_rcp_f32 v240, v240
    v_rcp_f32 v241, v241
    v_pk_mul_f32 v[232:233], v[232:233], v[234:235]
    v_pk_mul_f32 v[240:241], v[240:241], v[242:243]
    v_cvt_pk_bf16_f32 v248, v232, v233
    v_cvt_pk_bf16_f32 v249, v240, v241
    s_add_u32 s83, s83, 131072
    s_mov_b32 s37, 131072
    s_add_u32 m0, s37, s33
    s_nop 0
    buffer_load_dwordx4 v244, s[84:87], s83 offen offset:0 lds
    v_pk_mul_f32 v[232:233], v[68:69], v[68:69]
    v_pk_mul_f32 v[240:241], v[70:71], v[70:71]
    v_pk_fma_f32 v[232:233], v[232:233], v[228:229], v[230:231]
    v_pk_fma_f32 v[240:241], v[240:241], v[228:229], v[230:231]
    v_pk_mul_f32 v[232:233], v[232:233], v[68:69]
    v_pk_mul_f32 v[240:241], v[240:241], v[70:71]
    v_exp_f32 v232, v232
    v_exp_f32 v233, v233
    v_exp_f32 v240, v240
    v_exp_f32 v241, v241
    v_pk_mul_f32 v[234:235], v[68:69], v[180:181]
    v_pk_add_f32 v[232:233], v[232:233], v[238:239]
    v_pk_add_f32 v[240:241], v[240:241], v[238:239]
    v_pk_mul_f32 v[242:243], v[70:71], v[182:183]
    v_rcp_f32 v232, v232
    v_rcp_f32 v233, v233
    v_rcp_f32 v240, v240
    v_rcp_f32 v241, v241
    v_pk_mul_f32 v[232:233], v[232:233], v[234:235]
    v_pk_mul_f32 v[240:241], v[240:241], v[242:243]
    v_cvt_pk_bf16_f32 v250, v232, v233
    v_cvt_pk_bf16_f32 v251, v240, v241
    buffer_load_dwordx4 v245, s[84:87], s83 offen offset:1024 lds
    v_permlane16_swap_b32 v248, v250
    v_permlane16_swap_b32 v249, v251
    s_mov_b32 s14, 16384
    buffer_store_dwordx4 v[248:251], v226, s[16:19], s14 offen offset:0 sc1
    v_pk_mul_f32 v[232:233], v[72:73], v[72:73]
    v_pk_mul_f32 v[240:241], v[74:75], v[74:75]
    v_pk_fma_f32 v[232:233], v[232:233], v[228:229], v[230:231]
    v_pk_fma_f32 v[240:241], v[240:241], v[228:229], v[230:231]
    v_pk_mul_f32 v[232:233], v[232:233], v[72:73]
    v_pk_mul_f32 v[240:241], v[240:241], v[74:75]
    v_exp_f32 v232, v232
    v_exp_f32 v233, v233
    v_exp_f32 v240, v240
    v_exp_f32 v241, v241
    v_pk_mul_f32 v[234:235], v[72:73], v[184:185]
    v_pk_add_f32 v[232:233], v[232:233], v[238:239]
    v_pk_add_f32 v[240:241], v[240:241], v[238:239]
    v_pk_mul_f32 v[242:243], v[74:75], v[186:187]
    v_rcp_f32 v232, v232
    v_rcp_f32 v233, v233
    v_rcp_f32 v240, v240
    v_rcp_f32 v241, v241
    v_pk_mul_f32 v[232:233], v[232:233], v[234:235]
    v_pk_mul_f32 v[240:241], v[240:241], v[242:243]
    v_cvt_pk_bf16_f32 v252, v232, v233
    v_cvt_pk_bf16_f32 v253, v240, v241
    buffer_load_dwordx4 v246, s[84:87], s83 offen offset:2048 lds
    v_pk_mul_f32 v[232:233], v[76:77], v[76:77]
    v_pk_mul_f32 v[240:241], v[78:79], v[78:79]
    v_pk_fma_f32 v[232:233], v[232:233], v[228:229], v[230:231]
    v_pk_fma_f32 v[240:241], v[240:241], v[228:229], v[230:231]
    v_pk_mul_f32 v[232:233], v[232:233], v[76:77]
    v_pk_mul_f32 v[240:241], v[240:241], v[78:79]
    v_exp_f32 v232, v232
    v_exp_f32 v233, v233
    v_exp_f32 v240, v240
    v_exp_f32 v241, v241
    v_pk_mul_f32 v[234:235], v[76:77], v[188:189]
    v_pk_add_f32 v[232:233], v[232:233], v[238:239]
    v_pk_add_f32 v[240:241], v[240:241], v[238:239]
    v_pk_mul_f32 v[242:243], v[78:79], v[190:191]
    v_rcp_f32 v232, v232
    v_rcp_f32 v233, v233
    v_rcp_f32 v240, v240
    v_rcp_f32 v241, v241
    v_pk_mul_f32 v[232:233], v[232:233], v[234:235]
    v_pk_mul_f32 v[240:241], v[240:241], v[242:243]
    v_cvt_pk_bf16_f32 v254, v232, v233
    v_cvt_pk_bf16_f32 v255, v240, v241
    buffer_load_dwordx4 v247, s[84:87], s83 offen offset:3072 lds
    v_permlane16_swap_b32 v252, v254
    v_permlane16_swap_b32 v253, v255
    s_mov_b32 s14, 16384
    buffer_store_dwordx4 v[252:255], v226, s[16:19], s14 offen offset:512 sc1
    v_pk_mul_f32 v[232:233], v[80:81], v[80:81]
    v_pk_mul_f32 v[240:241], v[82:83], v[82:83]
    v_pk_fma_f32 v[232:233], v[232:233], v[228:229], v[230:231]
    v_pk_fma_f32 v[240:241], v[240:241], v[228:229], v[230:231]
    v_pk_mul_f32 v[232:233], v[232:233], v[80:81]
    v_pk_mul_f32 v[240:241], v[240:241], v[82:83]
    v_exp_f32 v232, v232
    v_exp_f32 v233, v233
    v_exp_f32 v240, v240
    v_exp_f32 v241, v241
    v_pk_mul_f32 v[234:235], v[80:81], v[192:193]
    v_pk_add_f32 v[232:233], v[232:233], v[238:239]
    v_pk_add_f32 v[240:241], v[240:241], v[238:239]
    v_pk_mul_f32 v[242:243], v[82:83], v[194:195]
    v_rcp_f32 v232, v232
    v_rcp_f32 v233, v233
    v_rcp_f32 v240, v240
    v_rcp_f32 v241, v241
    v_pk_mul_f32 v[232:233], v[232:233], v[234:235]
    v_pk_mul_f32 v[240:241], v[240:241], v[242:243]
    v_cvt_pk_bf16_f32 v248, v232, v233
    v_cvt_pk_bf16_f32 v249, v240, v241
    s_add_u32 s83, s83, 131072
    v_pk_mul_f32 v[232:233], v[84:85], v[84:85]
    v_pk_mul_f32 v[240:241], v[86:87], v[86:87]
    v_pk_fma_f32 v[232:233], v[232:233], v[228:229], v[230:231]
    v_pk_fma_f32 v[240:241], v[240:241], v[228:229], v[230:231]
    v_pk_mul_f32 v[232:233], v[232:233], v[84:85]
    v_pk_mul_f32 v[240:241], v[240:241], v[86:87]
    v_exp_f32 v232, v232
    v_exp_f32 v233, v233
    v_exp_f32 v240, v240
    v_exp_f32 v241, v241
    v_pk_mul_f32 v[234:235], v[84:85], v[196:197]
    v_pk_add_f32 v[232:233], v[232:233], v[238:239]
    v_pk_add_f32 v[240:241], v[240:241], v[238:239]
    v_pk_mul_f32 v[242:243], v[86:87], v[198:199]
    v_rcp_f32 v232, v232
    v_rcp_f32 v233, v233
    v_rcp_f32 v240, v240
    v_rcp_f32 v241, v241
    v_pk_mul_f32 v[232:233], v[232:233], v[234:235]
    v_pk_mul_f32 v[240:241], v[240:241], v[242:243]
    v_cvt_pk_bf16_f32 v250, v232, v233
    v_cvt_pk_bf16_f32 v251, v240, v241
    s_nop 0
    v_permlane16_swap_b32 v248, v250
    v_permlane16_swap_b32 v249, v251
    s_mov_b32 s14, 20480
    buffer_store_dwordx4 v[248:251], v226, s[16:19], s14 offen offset:0 sc1
    v_pk_mul_f32 v[232:233], v[88:89], v[88:89]
    v_pk_mul_f32 v[240:241], v[90:91], v[90:91]
    v_pk_fma_f32 v[232:233], v[232:233], v[228:229], v[230:231]
    v_pk_fma_f32 v[240:241], v[240:241], v[228:229], v[230:231]
    v_pk_mul_f32 v[232:233], v[232:233], v[88:89]
    v_pk_mul_f32 v[240:241], v[240:241], v[90:91]
    v_exp_f32 v232, v232
    v_exp_f32 v233, v233
    v_exp_f32 v240, v240
    v_exp_f32 v241, v241
    v_pk_mul_f32 v[234:235], v[88:89], v[200:201]
    v_pk_add_f32 v[232:233], v[232:233], v[238:239]
    v_pk_add_f32 v[240:241], v[240:241], v[238:239]
    v_pk_mul_f32 v[242:243], v[90:91], v[202:203]
    v_rcp_f32 v232, v232
    v_rcp_f32 v233, v233
    v_rcp_f32 v240, v240
    v_rcp_f32 v241, v241
    v_pk_mul_f32 v[232:233], v[232:233], v[234:235]
    v_pk_mul_f32 v[240:241], v[240:241], v[242:243]
    v_cvt_pk_bf16_f32 v252, v232, v233
    v_cvt_pk_bf16_f32 v253, v240, v241
    v_pk_mul_f32 v[232:233], v[92:93], v[92:93]
    v_pk_mul_f32 v[240:241], v[94:95], v[94:95]
    v_pk_fma_f32 v[232:233], v[232:233], v[228:229], v[230:231]
    v_pk_fma_f32 v[240:241], v[240:241], v[228:229], v[230:231]
    v_pk_mul_f32 v[232:233], v[232:233], v[92:93]
    v_pk_mul_f32 v[240:241], v[240:241], v[94:95]
    v_exp_f32 v232, v232
    v_exp_f32 v233, v233
    v_exp_f32 v240, v240
    v_exp_f32 v241, v241
    v_pk_mul_f32 v[234:235], v[92:93], v[204:205]
    v_pk_add_f32 v[232:233], v[232:233], v[238:239]
    v_pk_add_f32 v[240:241], v[240:241], v[238:239]
    v_pk_mul_f32 v[242:243], v[94:95], v[206:207]
    v_rcp_f32 v232, v232
    v_rcp_f32 v233, v233
    v_rcp_f32 v240, v240
    v_rcp_f32 v241, v241
    v_pk_mul_f32 v[232:233], v[232:233], v[234:235]
    v_pk_mul_f32 v[240:241], v[240:241], v[242:243]
    v_cvt_pk_bf16_f32 v254, v232, v233
    v_cvt_pk_bf16_f32 v255, v240, v241
    s_nop 0
    v_permlane16_swap_b32 v252, v254
    v_permlane16_swap_b32 v253, v255
    s_mov_b32 s14, 20480
    buffer_store_dwordx4 v[252:255], v226, s[16:19], s14 offen offset:512 sc1
    v_pk_mul_f32 v[232:233], v[96:97], v[96:97]
    v_pk_mul_f32 v[240:241], v[98:99], v[98:99]
    v_pk_fma_f32 v[232:233], v[232:233], v[228:229], v[230:231]
    v_pk_fma_f32 v[240:241], v[240:241], v[228:229], v[230:231]
    v_pk_mul_f32 v[232:233], v[232:233], v[96:97]
    v_pk_mul_f32 v[240:241], v[240:241], v[98:99]
    v_exp_f32 v232, v232
    v_exp_f32 v233, v233
    v_exp_f32 v240, v240
    v_exp_f32 v241, v241
    v_pk_mul_f32 v[234:235], v[96:97], v[208:209]
    v_pk_add_f32 v[232:233], v[232:233], v[238:239]
    v_pk_add_f32 v[240:241], v[240:241], v[238:239]
    v_pk_mul_f32 v[242:243], v[98:99], v[210:211]
    v_rcp_f32 v232, v232
    v_rcp_f32 v233, v233
    v_rcp_f32 v240, v240
    v_rcp_f32 v241, v241
    v_pk_mul_f32 v[232:233], v[232:233], v[234:235]
    v_pk_mul_f32 v[240:241], v[240:241], v[242:243]
    v_cvt_pk_bf16_f32 v248, v232, v233
    v_cvt_pk_bf16_f32 v249, v240, v241
    v_pk_mul_f32 v[232:233], v[100:101], v[100:101]
    v_pk_mul_f32 v[240:241], v[102:103], v[102:103]
    v_pk_fma_f32 v[232:233], v[232:233], v[228:229], v[230:231]
    v_pk_fma_f32 v[240:241], v[240:241], v[228:229], v[230:231]
    v_pk_mul_f32 v[232:233], v[232:233], v[100:101]
    v_pk_mul_f32 v[240:241], v[240:241], v[102:103]
    v_exp_f32 v232, v232
    v_exp_f32 v233, v233
    v_exp_f32 v240, v240
    v_exp_f32 v241, v241
    v_pk_mul_f32 v[234:235], v[100:101], v[212:213]
    v_pk_add_f32 v[232:233], v[232:233], v[238:239]
    v_pk_add_f32 v[240:241], v[240:241], v[238:239]
    v_pk_mul_f32 v[242:243], v[102:103], v[214:215]
    v_rcp_f32 v232, v232
    v_rcp_f32 v233, v233
    v_rcp_f32 v240, v240
    v_rcp_f32 v241, v241
    v_pk_mul_f32 v[232:233], v[232:233], v[234:235]
    v_pk_mul_f32 v[240:241], v[240:241], v[242:243]
    v_cvt_pk_bf16_f32 v250, v232, v233
    v_cvt_pk_bf16_f32 v251, v240, v241
    s_nop 0
    v_permlane16_swap_b32 v248, v250
    v_permlane16_swap_b32 v249, v251
    s_mov_b32 s14, 24576
    buffer_store_dwordx4 v[248:251], v226, s[16:19], s14 offen offset:0 sc1
    v_pk_mul_f32 v[232:233], v[104:105], v[104:105]
    v_pk_mul_f32 v[240:241], v[106:107], v[106:107]
    v_pk_fma_f32 v[232:233], v[232:233], v[228:229], v[230:231]
    v_pk_fma_f32 v[240:241], v[240:241], v[228:229], v[230:231]
    v_pk_mul_f32 v[232:233], v[232:233], v[104:105]
    v_pk_mul_f32 v[240:241], v[240:241], v[106:107]
    v_exp_f32 v232, v232
    v_exp_f32 v233, v233
    v_exp_f32 v240, v240
    v_exp_f32 v241, v241
    v_pk_mul_f32 v[234:235], v[104:105], v[216:217]
    v_pk_add_f32 v[232:233], v[232:233], v[238:239]
    v_pk_add_f32 v[240:241], v[240:241], v[238:239]
    v_pk_mul_f32 v[242:243], v[106:107], v[218:219]
    v_rcp_f32 v232, v232
    v_rcp_f32 v233, v233
    v_rcp_f32 v240, v240
    v_rcp_f32 v241, v241
    v_pk_mul_f32 v[232:233], v[232:233], v[234:235]
    v_pk_mul_f32 v[240:241], v[240:241], v[242:243]
    v_cvt_pk_bf16_f32 v252, v232, v233
    v_cvt_pk_bf16_f32 v253, v240, v241
    v_pk_mul_f32 v[232:233], v[108:109], v[108:109]
    v_pk_mul_f32 v[240:241], v[110:111], v[110:111]
    v_pk_fma_f32 v[232:233], v[232:233], v[228:229], v[230:231]
    v_pk_fma_f32 v[240:241], v[240:241], v[228:229], v[230:231]
    v_pk_mul_f32 v[232:233], v[232:233], v[108:109]
    v_pk_mul_f32 v[240:241], v[240:241], v[110:111]
    v_exp_f32 v232, v232
    v_exp_f32 v233, v233
    v_exp_f32 v240, v240
    v_exp_f32 v241, v241
    v_pk_mul_f32 v[234:235], v[108:109], v[220:221]
    v_pk_add_f32 v[232:233], v[232:233], v[238:239]
    v_pk_add_f32 v[240:241], v[240:241], v[238:239]
    v_pk_mul_f32 v[242:243], v[110:111], v[222:223]
    v_rcp_f32 v232, v232
    v_rcp_f32 v233, v233
    v_rcp_f32 v240, v240
    v_rcp_f32 v241, v241
    v_pk_mul_f32 v[232:233], v[232:233], v[234:235]
    v_pk_mul_f32 v[240:241], v[240:241], v[242:243]
    v_cvt_pk_bf16_f32 v254, v232, v233
    v_cvt_pk_bf16_f32 v255, v240, v241
    s_nop 0
    v_permlane16_swap_b32 v252, v254
    v_permlane16_swap_b32 v253, v255
    s_mov_b32 s14, 24576
    buffer_store_dwordx4 v[252:255], v226, s[16:19], s14 offen offset:512 sc1
    s_lshl_b32 s14, s6, 1
    s_lshr_b32 s15, s7, 4
    s_add_u32 s14, s14, s15
    s_add_u32 s14, s14, 8
    s_lshl_b32 s14, s14, 7
    s_waitcnt vmcnt(0)
    s_barrier
    s_cmp_lg_u32 s3, 0
    s_cbranch_scc1 L_sig_5532
    v_mov_b32 v236, 1
    v_mov_b32 v237, 0
    v_cmp_eq_u32 vcc, 0, v225
    s_nop 1
    s_and_saveexec_b64 s[76:77], vcc
    buffer_atomic_add v236, v237, s[8:11], s14 offen sc1
    s_mov_b64 exec, s[76:77]
L_sig_5532:
    v_mov_b32 v100, v225
    v_mov_b32 v112, v244
    v_mov_b32 v113, v245
    v_mov_b32 v114, v246
    v_mov_b32 v115, v247
    s_mul_i32 s14, s81, 917504
    s_mul_i32 s15, s80, 458752
    s_add_u32 s14, s14, s15
    s_add_u32 s56, s4, 16777216
    s_addc_u32 s57, s5, 0
    s_add_u32 s56, s56, s14
    s_addc_u32 s57, s57, 0
    s_mov_b32 s58, 458752
    s_mov_b32 s59, 0x00020000
    v_lshlrev_b32 v110, 4, v100
    v_add_u32 v110, s32, v110
    s_mov_b32 s34, 0
    s_load_dwordx2 s[40:41], s[0:1], 96
    v_mov_b32 v0, 0
    v_mov_b32 v1, 0
    v_mov_b32 v2, 0
    v_mov_b32 v3, 0
    v_mov_b32 v4, 0
    v_mov_b32 v5, 0
    v_mov_b32 v6, 0
    v_mov_b32 v7, 0
    v_mov_b32 v8, 0
    v_mov_b32 v9, 0
    v_mov_b32 v10, 0
    v_mov_b32 v11, 0
    v_mov_b32 v12, 0
    v_mov_b32 v13, 0
    v_mov_b32 v14, 0
    v_mov_b32 v15, 0
    v_mov_b32 v16, 0
    v_mov_b32 v17, 0
    v_mov_b32 v18, 0
    v_mov_b32 v19, 0
    v_mov_b32 v20, 0
    v_mov_b32 v21, 0
    v_mov_b32 v22, 0
    v_mov_b32 v23, 0
    v_mov_b32 v24, 0
    v_mov_b32 v25, 0
    v_mov_b32 v26, 0
    v_mov_b32 v27, 0
    v_mov_b32 v28, 0
    v_mov_b32 v29, 0
    v_mov_b32 v30, 0
    v_mov_b32 v31, 0
    v_mov_b32 v32, 0
    v_mov_b32 v33, 0
    v_mov_b32 v34, 0
    v_mov_b32 v35, 0
    v_mov_b32 v36, 0
    v_mov_b32 v37, 0
    v_mov_b32 v38, 0
    v_mov_b32 v39, 0
    v_mov_b32 v40, 0
    v_mov_b32 v41, 0
    v_mov_b32 v42, 0
    v_mov_b32 v43, 0
    v_mov_b32 v44, 0
    v_mov_b32 v45, 0
    v_mov_b32 v46, 0
    v_mov_b32 v47, 0
    v_mov_b32 v48, 0
    v_mov_b32 v49, 0
    v_mov_b32 v50, 0
    v_mov_b32 v51, 0
    v_mov_b32 v52, 0
    v_mov_b32 v53, 0
    v_mov_b32 v54, 0
    v_mov_b32 v55, 0
    v_mov_b32 v56, 0
    v_mov_b32 v57, 0
    v_mov_b32 v58, 0
    v_mov_b32 v59, 0
    v_mov_b32 v60, 0
    v_mov_b32 v61, 0
    v_mov_b32 v62, 0
    v_mov_b32 v63, 0
    v_lshrrev_b32 v116, 5, v100
    v_lshlrev_b32 v116, 11, v116
    v_and_b32 v117, 31, v100
    v_lshlrev_b32 v117, 4, v117
    v_add_u32 v106, v116, v117
    s_lshr_b32 s14, s3, 1
    s_lshl_b32 s14, s14, 10
    s_lshl_b32 s15, s80, 9
    s_add_u32 s52, s14, s15
    s_xor_b32 s15, s15, 512
    s_add_u32 s53, s14, s15
    v_add_u32 v107, s53, v106
    v_add_u32 v106, s52, v106
    v_lshrrev_b32 v116, 5, v100
    v_lshlrev_b32 v116, 3, v116
    v_bfe_u32 v117, v100, 2, 2
    v_add_u32 v116, v116, v117
    v_lshlrev_b32 v116, 8, v116
    s_and_b32 s15, s3, 1
    s_lshl_b32 s15, s15, 1
    v_xor_b32 v117, s15, v117
    v_lshlrev_b32 v117, 6, v117
    v_bfe_u32 v118, v100, 4, 1
    v_lshlrev_b32 v118, 5, v118
    v_add_u32 v116, v116, v118
    v_and_b32 v118, 1, v100
    v_lshlrev_b32 v118, 4, v118
    v_add_u32 v116, v116, v118
    v_bfe_u32 v118, v100, 1, 1
    v_lshlrev_b32 v118, 3, v118
    v_add_u32 v116, v116, v118
    v_add_u32 v116, 16384, v116
    v_add_u32 v108, v116, v117
    v_xor_b32 v117, 64, v117
    v_add_u32 v109, v116, v117
    s_lshr_b32 s14, s3, 1
    s_and_b32 s15, s3, 1
    s_lshl_b32 s52, s81, 7
    s_lshl_b32 s53, s14, 6
    s_add_u32 s52, s52, s53
    s_lshl_b32 s53, s80, 5
    s_add_u32 s52, s52, s53
    s_lshl_b32 s52, s52, 11
    s_lshl_b32 s53, s82, 8
    s_add_u32 s52, s52, s53
    s_lshl_b32 s53, s15, 7
    s_add_u32 s52, s52, s53
    v_and_b32 v116, 31, v100
    v_lshlrev_b32 v116, 11, v116
    v_lshrrev_b32 v117, 5, v100
    v_lshlrev_b32 v117, 4, v117
    v_add_u32 v93, v116, v117
    v_add_u32 v93, s52, v93
    s_add_u32 s24, s4, 33554432
    s_addc_u32 s25, s5, 0
    s_mov_b32 s26, 49152
    s_mov_b32 s27, 0x00020000
    s_lshl_b32 s52, s82, 9
    s_lshl_b32 s53, s15, 8
    s_add_u32 s52, s52, s53
    s_add_u32 s52, s52, 20480
    s_add_u32 s53, s52, 24576
    v_lshrrev_b32 v116, 5, v100
    v_lshlrev_b32 v116, 5, v116
    s_mov_b32 s54, 0x20000
L_b_gbchk:
    buffer_load_dwordx4 v[128:131], v116, s[24:27], s52 offen offset:0 sc1
    buffer_load_dwordx4 v[160:163], v116, s[24:27], s53 offen offset:0 sc1
    buffer_load_dwordx4 v[132:135], v116, s[24:27], s52 offen offset:16 sc1
    buffer_load_dwordx4 v[164:167], v116, s[24:27], s53 offen offset:16 sc1
    buffer_load_dwordx4 v[136:139], v116, s[24:27], s52 offen offset:64 sc1
    buffer_load_dwordx4 v[168:171], v116, s[24:27], s53 offen offset:64 sc1
    buffer_load_dwordx4 v[140:143], v116, s[24:27], s52 offen offset:80 sc1
    buffer_load_dwordx4 v[172:175], v116, s[24:27], s53 offen offset:80 sc1
    buffer_load_dwordx4 v[144:147], v116, s[24:27], s52 offen offset:128 sc1
    buffer_load_dwordx4 v[176:179], v116, s[24:27], s53 offen offset:128 sc1
    buffer_load_dwordx4 v[148:151], v116, s[24:27], s52 offen offset:144 sc1
    buffer_load_dwordx4 v[180:183], v116, s[24:27], s53 offen offset:144 sc1
    buffer_load_dwordx4 v[152:155], v116, s[24:27], s52 offen offset:192 sc1
    buffer_load_dwordx4 v[184:187], v116, s[24:27], s53 offen offset:192 sc1
    buffer_load_dwordx4 v[156:159], v116, s[24:27], s52 offen offset:208 sc1
    buffer_load_dwordx4 v[188:191], v116, s[24:27], s53 offen offset:208 sc1
    s_waitcnt vmcnt(0) lgkmcnt(0)
    v_max3_u32 v98, v128, v129, v130
    v_max3_u32 v98, v98, v131, v132
    v_max3_u32 v98, v98, v133, v134
    v_max3_u32 v98, v98, v135, v136
    v_max3_u32 v98, v98, v137, v138
    v_max3_u32 v98, v98, v139, v140
    v_max3_u32 v98, v98, v141, v142
    v_max3_u32 v98, v98, v143, v144
    v_max3_u32 v98, v98, v145, v146
    v_max3_u32 v98, v98, v147, v148
    v_max3_u32 v98, v98, v149, v150
    v_max3_u32 v98, v98, v151, v152
    v_max3_u32 v98, v98, v153, v154
    v_max3_u32 v98, v98, v155, v156
    v_max3_u32 v98, v98, v157, v158
    v_max3_u32 v98, v98, v159, v160
    v_max3_u32 v98, v98, v161, v162
    v_max3_u32 v98, v98, v163, v164
    v_max3_u32 v98, v98, v165, v166
    v_max3_u32 v98, v98, v167, v168
    v_max3_u32 v98, v98, v169, v170
    v_max3_u32 v98, v98, v171, v172
    v_max3_u32 v98, v98, v173, v174
    v_max3_u32 v98, v98, v175, v176
    v_max3_u32 v98, v98, v177, v178
    v_max3_u32 v98, v98, v179, v180
    v_max3_u32 v98, v98, v181, v182
    v_max3_u32 v98, v98, v183, v184
    v_max3_u32 v98, v98, v185, v186
    v_max3_u32 v98, v98, v187, v188
    v_max3_u32 v98, v98, v189, v190
    v_max_u32 v98, v98, v191
    v_cmp_eq_u32 vcc, -1, v98
    s_nop 1
    s_cmp_eq_u64 vcc, 0
    s_cbranch_scc1 L_b_gbok
    s_sub_u32 s54, s54, 1
    s_cmp_lg_u32 s54, 0
    s_cbranch_scc1 L_b_gbchk
L_b_gbok:
    v_add_f32 v128, v128, v160
    v_add_f32 v129, v129, v161
    v_cvt_pk_bf16_f32 v98, v128, v129
    v_lshlrev_b32 v128, 16, v98
    v_and_b32 v129, 0xffff0000, v98
    v_add_f32 v130, v130, v162
    v_add_f32 v131, v131, v163
    v_cvt_pk_bf16_f32 v98, v130, v131
    v_lshlrev_b32 v130, 16, v98
    v_and_b32 v131, 0xffff0000, v98
    v_add_f32 v132, v132, v164
    v_add_f32 v133, v133, v165
    v_cvt_pk_bf16_f32 v98, v132, v133
    v_lshlrev_b32 v132, 16, v98
    v_and_b32 v133, 0xffff0000, v98
    v_add_f32 v134, v134, v166
    v_add_f32 v135, v135, v167
    v_cvt_pk_bf16_f32 v98, v134, v135
    v_lshlrev_b32 v134, 16, v98
    v_and_b32 v135, 0xffff0000, v98
    v_add_f32 v136, v136, v168
    v_add_f32 v137, v137, v169
    v_cvt_pk_bf16_f32 v98, v136, v137
    v_lshlrev_b32 v136, 16, v98
    v_and_b32 v137, 0xffff0000, v98
    v_add_f32 v138, v138, v170
    v_add_f32 v139, v139, v171
    v_cvt_pk_bf16_f32 v98, v138, v139
    v_lshlrev_b32 v138, 16, v98
    v_and_b32 v139, 0xffff0000, v98
    v_add_f32 v140, v140, v172
    v_add_f32 v141, v141, v173
    v_cvt_pk_bf16_f32 v98, v140, v141
    v_lshlrev_b32 v140, 16, v98
    v_and_b32 v141, 0xffff0000, v98
    v_add_f32 v142, v142, v174
    v_add_f32 v143, v143, v175
    v_cvt_pk_bf16_f32 v98, v142, v143
    v_lshlrev_b32 v142, 16, v98
    v_and_b32 v143, 0xffff0000, v98
    v_add_f32 v144, v144, v176
    v_add_f32 v145, v145, v177
    v_cvt_pk_bf16_f32 v98, v144, v145
    v_lshlrev_b32 v144, 16, v98
    v_and_b32 v145, 0xffff0000, v98
    v_add_f32 v146, v146, v178
    v_add_f32 v147, v147, v179
    v_cvt_pk_bf16_f32 v98, v146, v147
    v_lshlrev_b32 v146, 16, v98
    v_and_b32 v147, 0xffff0000, v98
    v_add_f32 v148, v148, v180
    v_add_f32 v149, v149, v181
    v_cvt_pk_bf16_f32 v98, v148, v149
    v_lshlrev_b32 v148, 16, v98
    v_and_b32 v149, 0xffff0000, v98
    v_add_f32 v150, v150, v182
    v_add_f32 v151, v151, v183
    v_cvt_pk_bf16_f32 v98, v150, v151
    v_lshlrev_b32 v150, 16, v98
    v_and_b32 v151, 0xffff0000, v98
    v_add_f32 v152, v152, v184
    v_add_f32 v153, v153, v185
    v_cvt_pk_bf16_f32 v98, v152, v153
    v_lshlrev_b32 v152, 16, v98
    v_and_b32 v153, 0xffff0000, v98
    v_add_f32 v154, v154, v186
    v_add_f32 v155, v155, v187
    v_cvt_pk_bf16_f32 v98, v154, v155
    v_lshlrev_b32 v154, 16, v98
    v_and_b32 v155, 0xffff0000, v98
    v_add_f32 v156, v156, v188
    v_add_f32 v157, v157, v189
    v_cvt_pk_bf16_f32 v98, v156, v157
    v_lshlrev_b32 v156, 16, v98
    v_and_b32 v157, 0xffff0000, v98
    v_add_f32 v158, v158, v190
    v_add_f32 v159, v159, v191
    v_cvt_pk_bf16_f32 v98, v158, v159
    v_lshlrev_b32 v158, 16, v98
    v_and_b32 v159, 0xffff0000, v98
    s_mov_b32 s16, s40
    s_mov_b32 s17, s41
    s_mov_b32 s18, 4194304
    s_mov_b32 s19, 0x00020000
    s_add_u32 s20, s4, 8388608
    s_addc_u32 s21, s5, 0
    s_mov_b32 s22, 4194304
    s_mov_b32 s23, 0x00020000
    s_lshr_b32 s14, s81, 1
    s_lshl_b32 s14, s14, 1
    s_add_u32 s14, s14, s80
    s_add_u32 s14, s14, 8
    s_lshl_b32 s14, s14, 7
    s_cmp_lg_u32 s3, 0
    s_cbranch_scc1 L_poll_5840_done
    v_mov_b32 v117, 0
    s_mov_b32 s78, 0x20000
L_poll_5840:
    buffer_load_dword v116, v117, s[8:11], s14 offen sc1
    s_waitcnt vmcnt(0)
    v_readfirstlane_b32 s79, v116
    s_nop 1
    s_cmp_ge_u32 s79, 16
    s_cbranch_scc1 L_poll_5840_done
    s_sleep 1
    s_sub_u32 s78, s78, 1
    s_cmp_lg_u32 s78, 0
    s_cbranch_scc1 L_poll_5840
L_poll_5840_done:
    s_barrier
    s_mov_b32 s37, 0
    s_add_u32 m0, s37, s32
    s_nop 0
    buffer_load_dwordx4 v110, s[56:59], s34 offen offset:0 sc1 lds
    buffer_load_dwordx4 v110, s[56:59], s34 offen offset:1024 sc1 lds
    buffer_load_dwordx4 v110, s[56:59], s34 offen offset:2048 sc1 lds
    buffer_load_dwordx4 v110, s[56:59], s34 offen offset:3072 sc1 lds
    s_add_u32 s34, s34, 16384
    s_mov_b32 s37, 32768
    s_add_u32 m0, s37, s32
    s_nop 0
    buffer_load_dwordx4 v110, s[56:59], s34 offen offset:0 sc1 lds
    buffer_load_dwordx4 v110, s[56:59], s34 offen offset:1024 sc1 lds
    buffer_load_dwordx4 v110, s[56:59], s34 offen offset:2048 sc1 lds
    buffer_load_dwordx4 v110, s[56:59], s34 offen offset:3072 sc1 lds
    s_add_u32 s34, s34, 16384
    s_mov_b32 s37, 65536
    s_add_u32 m0, s37, s32
    s_nop 0
    buffer_load_dwordx4 v110, s[56:59], s34 offen offset:0 sc1 lds
    buffer_load_dwordx4 v110, s[56:59], s34 offen offset:1024 sc1 lds
    buffer_load_dwordx4 v110, s[56:59], s34 offen offset:2048 sc1 lds
    buffer_load_dwordx4 v110, s[56:59], s34 offen offset:3072 sc1 lds
    s_add_u32 s34, s34, 16384
    s_mov_b32 s37, 98304
    s_add_u32 m0, s37, s32
    s_nop 0
    buffer_load_dwordx4 v110, s[56:59], s34 offen offset:0 sc1 lds
    buffer_load_dwordx4 v110, s[56:59], s34 offen offset:1024 sc1 lds
    buffer_load_dwordx4 v110, s[56:59], s34 offen offset:2048 sc1 lds
    buffer_load_dwordx4 v110, s[56:59], s34 offen offset:3072 sc1 lds
    s_add_u32 s34, s34, 16384
    s_mov_b32 s37, 131072
    s_add_u32 m0, s37, s32
    s_nop 0
    buffer_load_dwordx4 v110, s[56:59], s34 offen offset:0 sc1 lds
    buffer_load_dwordx4 v110, s[56:59], s34 offen offset:1024 sc1 lds
    buffer_load_dwordx4 v110, s[56:59], s34 offen offset:2048 sc1 lds
    buffer_load_dwordx4 v110, s[56:59], s34 offen offset:3072 sc1 lds
    s_add_u32 s34, s34, 16384
    buffer_load_dwordx4 v[64:67], v93, s[20:23], 0 offen offset:0 sc1
    buffer_load_dwordx4 v[68:71], v93, s[20:23], 0 offen offset:32 sc1
    buffer_load_dwordx4 v[72:75], v93, s[20:23], 0 offen offset:64 sc1
    buffer_load_dwordx4 v[76:79], v93, s[20:23], 0 offen offset:96 sc1
    s_waitcnt vmcnt(20)
    s_barrier
    v_mov_b32 v102, v106
    v_mov_b32 v103, v107
    v_mov_b32 v104, v108
    v_mov_b32 v105, v109
    ds_read_b64_tr_b16 a[32:33], v104 offset:0
    ds_read_b64_tr_b16 a[34:35], v104 offset:1024
    ds_read_b64_tr_b16 a[36:37], v105 offset:0
    ds_read_b64_tr_b16 a[38:39], v105 offset:1024
    ds_read_b128 a[0:3], v102 offset:0
    ds_read_b128 a[4:7], v103 offset:0
    ds_read_b64_tr_b16 a[40:41], v104 offset:4096
    ds_read_b64_tr_b16 a[42:43], v104 offset:5120
    ds_read_b64_tr_b16 a[44:45], v105 offset:4096
    ds_read_b64_tr_b16 a[46:47], v105 offset:5120
    ds_read_b128 a[8:11], v102 offset:4096
    ds_read_b128 a[12:15], v103 offset:4096
    ds_read_b64_tr_b16 a[48:49], v104 offset:8192
    ds_read_b64_tr_b16 a[50:51], v104 offset:9216
    ds_read_b64_tr_b16 a[52:53], v105 offset:8192
    ds_read_b64_tr_b16 a[54:55], v105 offset:9216
    ds_read_b128 a[16:19], v102 offset:8192
    ds_read_b128 a[20:23], v103 offset:8192
    ds_read_b64_tr_b16 a[56:57], v104 offset:12288
    ds_read_b64_tr_b16 a[58:59], v104 offset:13312
    ds_read_b64_tr_b16 a[60:61], v105 offset:12288
    ds_read_b64_tr_b16 a[62:63], v105 offset:13312
    ds_read_b128 a[24:27], v102 offset:12288
    ds_read_b128 a[28:31], v103 offset:12288
    s_mov_b32 s36, 32768
    s_mov_b32 s37, 0
    s_waitcnt lgkmcnt(0)
    v_mfma_f32_32x32x16_bf16 v[0:15], a[32:35], a[0:3], v[0:15]
    v_add_u32 v102, s36, v106
    v_add_u32 v103, s36, v107
    v_add_u32 v104, s36, v108
    v_add_u32 v105, s36, v109
    s_add_u32 m0, s37, s32
    v_mfma_f32_32x32x16_bf16 v[32:47], a[32:35], a[4:7], v[32:47]
    s_waitcnt vmcnt(16)
    s_barrier
    v_mfma_f32_32x32x16_bf16 v[16:31], a[36:39], a[0:3], v[16:31]
    buffer_load_dwordx4 v110, s[56:59], s34 offen offset:0 sc1 lds
    ds_read_b64_tr_b16 a[96:97], v104 offset:0
    ds_read_b64_tr_b16 a[98:99], v104 offset:1024
    v_mfma_f32_32x32x16_bf16 v[48:63], a[36:39], a[4:7], v[48:63]
    ds_read_b64_tr_b16 a[100:101], v105 offset:0
    ds_read_b64_tr_b16 a[102:103], v105 offset:1024
    v_mfma_f32_32x32x16_bf16 v[0:15], a[40:43], a[8:11], v[0:15]
    buffer_load_dwordx4 v110, s[56:59], s34 offen offset:1024 sc1 lds
    ds_read_b128 a[64:67], v102 offset:0
    ds_read_b128 a[68:71], v103 offset:0
    v_mfma_f32_32x32x16_bf16 v[32:47], a[40:43], a[12:15], v[32:47]
    buffer_load_dwordx4 v110, s[56:59], s34 offen offset:2048 sc1 lds
    ds_read_b64_tr_b16 a[104:105], v104 offset:4096
    ds_read_b64_tr_b16 a[106:107], v104 offset:5120
    v_mfma_f32_32x32x16_bf16 v[16:31], a[44:47], a[8:11], v[16:31]
    ds_read_b64_tr_b16 a[108:109], v105 offset:4096
    ds_read_b64_tr_b16 a[110:111], v105 offset:5120
    v_mfma_f32_32x32x16_bf16 v[48:63], a[44:47], a[12:15], v[48:63]
    buffer_load_dwordx4 v110, s[56:59], s34 offen offset:3072 sc1 lds
    s_add_u32 s34, s34, 16384
    ds_read_b128 a[72:75], v102 offset:4096
    ds_read_b128 a[76:79], v103 offset:4096
    v_mfma_f32_32x32x16_bf16 v[0:15], a[48:51], a[16:19], v[0:15]
    s_add_u32 m0, s37, s33
    ds_read_b64_tr_b16 a[112:113], v104 offset:8192
    ds_read_b64_tr_b16 a[114:115], v104 offset:9216
    v_mfma_f32_32x32x16_bf16 v[32:47], a[48:51], a[20:23], v[32:47]
    ds_read_b64_tr_b16 a[116:117], v105 offset:8192
    ds_read_b64_tr_b16 a[118:119], v105 offset:9216
    v_mfma_f32_32x32x16_bf16 v[16:31], a[52:55], a[16:19], v[16:31]
    buffer_load_dwordx4 v112, s[84:87], s83 offen offset:0 lds
    ds_read_b128 a[80:83], v102 offset:8192
    ds_read_b128 a[84:87], v103 offset:8192
    v_mfma_f32_32x32x16_bf16 v[48:63], a[52:55], a[20:23], v[48:63]
    buffer_load_dwordx4 v113, s[84:87], s83 offen offset:1024 lds
    ds_read_b64_tr_b16 a[120:121], v104 offset:12288
    ds_read_b64_tr_b16 a[122:123], v104 offset:13312
    v_mfma_f32_32x32x16_bf16 v[0:15], a[56:59], a[24:27], v[0:15]
    ds_read_b64_tr_b16 a[124:125], v105 offset:12288
    ds_read_b64_tr_b16 a[126:127], v105 offset:13312
    v_mfma_f32_32x32x16_bf16 v[32:47], a[56:59], a[28:31], v[32:47]
    buffer_load_dwordx4 v114, s[84:87], s83 offen offset:2048 lds
    ds_read_b128 a[88:91], v102 offset:12288
    ds_read_b128 a[92:95], v103 offset:12288
    v_mfma_f32_32x32x16_bf16 v[16:31], a[60:63], a[24:27], v[16:31]
    buffer_load_dwordx4 v115, s[84:87], s83 offen offset:3072 lds
    s_add_u32 s83, s83, 131072
    s_add_u32 s37, s37, 32768
    s_cmp_eq_u32 s37, 163840
    s_cselect_b32 s37, 0, s37
    v_mfma_f32_32x32x16_bf16 v[48:63], a[60:63], a[28:31], v[48:63]
    s_add_u32 s36, s36, 32768
    s_cmp_eq_u32 s36, 163840
    s_cselect_b32 s36, 0, s36
    s_waitcnt lgkmcnt(0)
    v_mfma_f32_32x32x16_bf16 v[0:15], a[96:99], a[64:67], v[0:15]
    v_add_u32 v102, s36, v106
    v_add_u32 v103, s36, v107
    v_add_u32 v104, s36, v108
    v_add_u32 v105, s36, v109
    s_add_u32 m0, s37, s32
    v_mfma_f32_32x32x16_bf16 v[32:47], a[96:99], a[68:71], v[32:47]
    s_waitcnt vmcnt(20)
    s_barrier
    v_mfma_f32_32x32x16_bf16 v[16:31], a[100:103], a[64:67], v[16:31]
    buffer_load_dwordx4 v110, s[56:59], s34 offen offset:0 sc1 lds
    ds_read_b64_tr_b16 a[32:33], v104 offset:0
    ds_read_b64_tr_b16 a[34:35], v104 offset:1024
    v_mfma_f32_32x32x16_bf16 v[48:63], a[100:103], a[68:71], v[48:63]
    ds_read_b64_tr_b16 a[36:37], v105 offset:0
    ds_read_b64_tr_b16 a[38:39], v105 offset:1024
    v_mfma_f32_32x32x16_bf16 v[0:15], a[104:107], a[72:75], v[0:15]
    buffer_load_dwordx4 v110, s[56:59], s34 offen offset:1024 sc1 lds
    ds_read_b128 a[0:3], v102 offset:0
    ds_read_b128 a[4:7], v103 offset:0
    v_mfma_f32_32x32x16_bf16 v[32:47], a[104:107], a[76:79], v[32:47]
    buffer_load_dwordx4 v110, s[56:59], s34 offen offset:2048 sc1 lds
    ds_read_b64_tr_b16 a[40:41], v104 offset:4096
    ds_read_b64_tr_b16 a[42:43], v104 offset:5120
    v_mfma_f32_32x32x16_bf16 v[16:31], a[108:111], a[72:75], v[16:31]
    ds_read_b64_tr_b16 a[44:45], v105 offset:4096
    ds_read_b64_tr_b16 a[46:47], v105 offset:5120
    v_mfma_f32_32x32x16_bf16 v[48:63], a[108:111], a[76:79], v[48:63]
    buffer_load_dwordx4 v110, s[56:59], s34 offen offset:3072 sc1 lds
    s_add_u32 s34, s34, 16384
    ds_read_b128 a[8:11], v102 offset:4096
    ds_read_b128 a[12:15], v103 offset:4096
    v_mfma_f32_32x32x16_bf16 v[0:15], a[112:115], a[80:83], v[0:15]
    s_add_u32 m0, s37, s33
    ds_read_b64_tr_b16 a[48:49], v104 offset:8192
    ds_read_b64_tr_b16 a[50:51], v104 offset:9216
    v_mfma_f32_32x32x16_bf16 v[32:47], a[112:115], a[84:87], v[32:47]
    ds_read_b64_tr_b16 a[52:53], v105 offset:8192
    ds_read_b64_tr_b16 a[54:55], v105 offset:9216
    v_mfma_f32_32x32x16_bf16 v[16:31], a[116:119], a[80:83], v[16:31]
    buffer_load_dwordx4 v112, s[84:87], s83 offen offset:0 lds
    ds_read_b128 a[16:19], v102 offset:8192
    ds_read_b128 a[20:23], v103 offset:8192
    v_mfma_f32_32x32x16_bf16 v[48:63], a[116:119], a[84:87], v[48:63]
    buffer_load_dwordx4 v113, s[84:87], s83 offen offset:1024 lds
    ds_read_b64_tr_b16 a[56:57], v104 offset:12288
    ds_read_b64_tr_b16 a[58:59], v104 offset:13312
    v_mfma_f32_32x32x16_bf16 v[0:15], a[120:123], a[88:91], v[0:15]
    ds_read_b64_tr_b16 a[60:61], v105 offset:12288
    ds_read_b64_tr_b16 a[62:63], v105 offset:13312
    v_mfma_f32_32x32x16_bf16 v[32:47], a[120:123], a[92:95], v[32:47]
    buffer_load_dwordx4 v114, s[84:87], s83 offen offset:2048 lds
    ds_read_b128 a[24:27], v102 offset:12288
    ds_read_b128 a[28:31], v103 offset:12288
    v_mfma_f32_32x32x16_bf16 v[16:31], a[124:127], a[88:91], v[16:31]
    buffer_load_dwordx4 v115, s[84:87], s83 offen offset:3072 lds
    s_add_u32 s83, s83, 131072
    s_add_u32 s37, s37, 32768
    s_cmp_eq_u32 s37, 163840
    s_cselect_b32 s37, 0, s37
    v_mfma_f32_32x32x16_bf16 v[48:63], a[124:127], a[92:95], v[48:63]
    s_add_u32 s36, s36, 32768
    s_cmp_eq_u32 s36, 163840
    s_cselect_b32 s36, 0, s36
    s_waitcnt lgkmcnt(0)
    v_mfma_f32_32x32x16_bf16 v[0:15], a[32:35], a[0:3], v[0:15]
    v_add_u32 v102, s36, v106
    v_add_u32 v103, s36, v107
    v_add_u32 v104, s36, v108
    v_add_u32 v105, s36, v109
    s_add_u32 m0, s37, s32
    v_mfma_f32_32x32x16_bf16 v[32:47], a[32:35], a[4:7], v[32:47]
    s_waitcnt vmcnt(24)
    s_barrier
    v_mfma_f32_32x32x16_bf16 v[16:31], a[36:39], a[0:3], v[16:31]
    buffer_load_dwordx4 v110, s[56:59], s34 offen offset:0 sc1 lds
    ds_read_b64_tr_b16 a[96:97], v104 offset:0
    ds_read_b64_tr_b16 a[98:99], v104 offset:1024
    v_mfma_f32_32x32x16_bf16 v[48:63], a[36:39], a[4:7], v[48:63]
    ds_read_b64_tr_b16 a[100:101], v105 offset:0
    ds_read_b64_tr_b16 a[102:103], v105 offset:1024
    v_mfma_f32_32x32x16_bf16 v[0:15], a[40:43], a[8:11], v[0:15]
    buffer_load_dwordx4 v110, s[56:59], s34 offen offset:1024 sc1 lds
    ds_read_b128 a[64:67], v102 offset:0
    ds_read_b128 a[68:71], v103 offset:0
    v_mfma_f32_32x32x16_bf16 v[32:47], a[40:43], a[12:15], v[32:47]
    buffer_load_dwordx4 v110, s[56:59], s34 offen offset:2048 sc1 lds
    ds_read_b64_tr_b16 a[104:105], v104 offset:4096
    ds_read_b64_tr_b16 a[106:107], v104 offset:5120
    v_mfma_f32_32x32x16_bf16 v[16:31], a[44:47], a[8:11], v[16:31]
    ds_read_b64_tr_b16 a[108:109], v105 offset:4096
    ds_read_b64_tr_b16 a[110:111], v105 offset:5120
    v_mfma_f32_32x32x16_bf16 v[48:63], a[44:47], a[12:15], v[48:63]
    buffer_load_dwordx4 v110, s[56:59], s34 offen offset:3072 sc1 lds
    s_add_u32 s34, s34, 16384
    ds_read_b128 a[72:75], v102 offset:4096
    ds_read_b128 a[76:79], v103 offset:4096
    v_mfma_f32_32x32x16_bf16 v[0:15], a[48:51], a[16:19], v[0:15]
    s_add_u32 m0, s37, s33
    ds_read_b64_tr_b16 a[112:113], v104 offset:8192
    ds_read_b64_tr_b16 a[114:115], v104 offset:9216
    v_mfma_f32_32x32x16_bf16 v[32:47], a[48:51], a[20:23], v[32:47]
    ds_read_b64_tr_b16 a[116:117], v105 offset:8192
    ds_read_b64_tr_b16 a[118:119], v105 offset:9216
    v_mfma_f32_32x32x16_bf16 v[16:31], a[52:55], a[16:19], v[16:31]
    buffer_load_dwordx4 v112, s[84:87], s83 offen offset:0 lds
    ds_read_b128 a[80:83], v102 offset:8192
    ds_read_b128 a[84:87], v103 offset:8192
    v_mfma_f32_32x32x16_bf16 v[48:63], a[52:55], a[20:23], v[48:63]
    buffer_load_dwordx4 v113, s[84:87], s83 offen offset:1024 lds
    ds_read_b64_tr_b16 a[120:121], v104 offset:12288
    ds_read_b64_tr_b16 a[122:123], v104 offset:13312
    v_mfma_f32_32x32x16_bf16 v[0:15], a[56:59], a[24:27], v[0:15]
    ds_read_b64_tr_b16 a[124:125], v105 offset:12288
    ds_read_b64_tr_b16 a[126:127], v105 offset:13312
    v_mfma_f32_32x32x16_bf16 v[32:47], a[56:59], a[28:31], v[32:47]
    buffer_load_dwordx4 v114, s[84:87], s83 offen offset:2048 lds
    ds_read_b128 a[88:91], v102 offset:12288
    ds_read_b128 a[92:95], v103 offset:12288
    v_mfma_f32_32x32x16_bf16 v[16:31], a[60:63], a[24:27], v[16:31]
    buffer_load_dwordx4 v115, s[84:87], s83 offen offset:3072 lds
    s_add_u32 s83, s83, 131072
    s_add_u32 s37, s37, 32768
    s_cmp_eq_u32 s37, 163840
    s_cselect_b32 s37, 0, s37
    v_mfma_f32_32x32x16_bf16 v[48:63], a[60:63], a[28:31], v[48:63]
    s_add_u32 s36, s36, 32768
    s_cmp_eq_u32 s36, 163840
    s_cselect_b32 s36, 0, s36
    s_waitcnt lgkmcnt(0)
    v_mfma_f32_32x32x16_bf16 v[0:15], a[96:99], a[64:67], v[0:15]
    v_add_u32 v102, s36, v106
    v_add_u32 v103, s36, v107
    v_add_u32 v104, s36, v108
    v_add_u32 v105, s36, v109
    s_add_u32 m0, s37, s32
    v_mfma_f32_32x32x16_bf16 v[32:47], a[96:99], a[68:71], v[32:47]
    s_waitcnt vmcnt(24)
    s_barrier
    v_mfma_f32_32x32x16_bf16 v[16:31], a[100:103], a[64:67], v[16:31]
    buffer_load_dwordx4 v110, s[56:59], s34 offen offset:0 sc1 lds
    ds_read_b64_tr_b16 a[32:33], v104 offset:0
    ds_read_b64_tr_b16 a[34:35], v104 offset:1024
    v_mfma_f32_32x32x16_bf16 v[48:63], a[100:103], a[68:71], v[48:63]
    ds_read_b64_tr_b16 a[36:37], v105 offset:0
    ds_read_b64_tr_b16 a[38:39], v105 offset:1024
    v_mfma_f32_32x32x16_bf16 v[0:15], a[104:107], a[72:75], v[0:15]
    buffer_load_dwordx4 v110, s[56:59], s34 offen offset:1024 sc1 lds
    ds_read_b128 a[0:3], v102 offset:0
    ds_read_b128 a[4:7], v103 offset:0
    v_mfma_f32_32x32x16_bf16 v[32:47], a[104:107], a[76:79], v[32:47]
    buffer_load_dwordx4 v110, s[56:59], s34 offen offset:2048 sc1 lds
    ds_read_b64_tr_b16 a[40:41], v104 offset:4096
    ds_read_b64_tr_b16 a[42:43], v104 offset:5120
    v_mfma_f32_32x32x16_bf16 v[16:31], a[108:111], a[72:75], v[16:31]
    ds_read_b64_tr_b16 a[44:45], v105 offset:4096
    ds_read_b64_tr_b16 a[46:47], v105 offset:5120
    v_mfma_f32_32x32x16_bf16 v[48:63], a[108:111], a[76:79], v[48:63]
    buffer_load_dwordx4 v110, s[56:59], s34 offen offset:3072 sc1 lds
    s_add_u32 s34, s34, 16384
    ds_read_b128 a[8:11], v102 offset:4096
    ds_read_b128 a[12:15], v103 offset:4096
    v_mfma_f32_32x32x16_bf16 v[0:15], a[112:115], a[80:83], v[0:15]
    s_add_u32 m0, s37, s33
    ds_read_b64_tr_b16 a[48:49], v104 offset:8192
    ds_read_b64_tr_b16 a[50:51], v104 offset:9216
    v_mfma_f32_32x32x16_bf16 v[32:47], a[112:115], a[84:87], v[32:47]
    ds_read_b64_tr_b16 a[52:53], v105 offset:8192
    ds_read_b64_tr_b16 a[54:55], v105 offset:9216
    v_mfma_f32_32x32x16_bf16 v[16:31], a[116:119], a[80:83], v[16:31]
    buffer_load_dwordx4 v112, s[84:87], s83 offen offset:0 lds
    ds_read_b128 a[16:19], v102 offset:8192
    ds_read_b128 a[20:23], v103 offset:8192
    v_mfma_f32_32x32x16_bf16 v[48:63], a[116:119], a[84:87], v[48:63]
    buffer_load_dwordx4 v113, s[84:87], s83 offen offset:1024 lds
    ds_read_b64_tr_b16 a[56:57], v104 offset:12288
    ds_read_b64_tr_b16 a[58:59], v104 offset:13312
    v_mfma_f32_32x32x16_bf16 v[0:15], a[120:123], a[88:91], v[0:15]
    ds_read_b64_tr_b16 a[60:61], v105 offset:12288
    ds_read_b64_tr_b16 a[62:63], v105 offset:13312
    v_mfma_f32_32x32x16_bf16 v[32:47], a[120:123], a[92:95], v[32:47]
    buffer_load_dwordx4 v114, s[84:87], s83 offen offset:2048 lds
    ds_read_b128 a[24:27], v102 offset:12288
    ds_read_b128 a[28:31], v103 offset:12288
    v_mfma_f32_32x32x16_bf16 v[16:31], a[124:127], a[88:91], v[16:31]
    buffer_load_dwordx4 v115, s[84:87], s83 offen offset:3072 lds
    s_add_u32 s83, s83, 131072
    s_add_u32 s37, s37, 32768
    s_cmp_eq_u32 s37, 163840
    s_cselect_b32 s37, 0, s37
    v_mfma_f32_32x32x16_bf16 v[48:63], a[124:127], a[92:95], v[48:63]
    s_add_u32 s36, s36, 32768
    s_cmp_eq_u32 s36, 163840
    s_cselect_b32 s36, 0, s36
    s_mov_b32 s38, 9
L_b_g2:
    s_waitcnt lgkmcnt(0)
    v_mfma_f32_32x32x16_bf16 v[0:15], a[32:35], a[0:3], v[0:15]
    v_add_u32 v102, s36, v106
    v_add_u32 v103, s36, v107
    v_add_u32 v104, s36, v108
    v_add_u32 v105, s36, v109
    s_add_u32 m0, s37, s32
    v_mfma_f32_32x32x16_bf16 v[32:47], a[32:35], a[4:7], v[32:47]
    s_waitcnt vmcnt(24)
    s_barrier
    v_mfma_f32_32x32x16_bf16 v[16:31], a[36:39], a[0:3], v[16:31]
    buffer_load_dwordx4 v110, s[56:59], s34 offen offset:0 sc1 lds
    ds_read_b64_tr_b16 a[96:97], v104 offset:0
    ds_read_b64_tr_b16 a[98:99], v104 offset:1024
    v_mfma_f32_32x32x16_bf16 v[48:63], a[36:39], a[4:7], v[48:63]
    ds_read_b64_tr_b16 a[100:101], v105 offset:0
    ds_read_b64_tr_b16 a[102:103], v105 offset:1024
    v_mfma_f32_32x32x16_bf16 v[0:15], a[40:43], a[8:11], v[0:15]
    buffer_load_dwordx4 v110, s[56:59], s34 offen offset:1024 sc1 lds
    ds_read_b128 a[64:67], v102 offset:0
    ds_read_b128 a[68:71], v103 offset:0
    v_mfma_f32_32x32x16_bf16 v[32:47], a[40:43], a[12:15], v[32:47]
    buffer_load_dwordx4 v110, s[56:59], s34 offen offset:2048 sc1 lds
    ds_read_b64_tr_b16 a[104:105], v104 offset:4096
    ds_read_b64_tr_b16 a[106:107], v104 offset:5120
    v_mfma_f32_32x32x16_bf16 v[16:31], a[44:47], a[8:11], v[16:31]
    ds_read_b64_tr_b16 a[108:109], v105 offset:4096
    ds_read_b64_tr_b16 a[110:111], v105 offset:5120
    v_mfma_f32_32x32x16_bf16 v[48:63], a[44:47], a[12:15], v[48:63]
    buffer_load_dwordx4 v110, s[56:59], s34 offen offset:3072 sc1 lds
    s_add_u32 s34, s34, 16384
    ds_read_b128 a[72:75], v102 offset:4096
    ds_read_b128 a[76:79], v103 offset:4096
    v_mfma_f32_32x32x16_bf16 v[0:15], a[48:51], a[16:19], v[0:15]
    s_add_u32 m0, s37, s33
    ds_read_b64_tr_b16 a[112:113], v104 offset:8192
    ds_read_b64_tr_b16 a[114:115], v104 offset:9216
    v_mfma_f32_32x32x16_bf16 v[32:47], a[48:51], a[20:23], v[32:47]
    ds_read_b64_tr_b16 a[116:117], v105 offset:8192
    ds_read_b64_tr_b16 a[118:119], v105 offset:9216
    v_mfma_f32_32x32x16_bf16 v[16:31], a[52:55], a[16:19], v[16:31]
    buffer_load_dwordx4 v112, s[84:87], s83 offen offset:0 lds
    ds_read_b128 a[80:83], v102 offset:8192
    ds_read_b128 a[84:87], v103 offset:8192
    v_mfma_f32_32x32x16_bf16 v[48:63], a[52:55], a[20:23], v[48:63]
    buffer_load_dwordx4 v113, s[84:87], s83 offen offset:1024 lds
    ds_read_b64_tr_b16 a[120:121], v104 offset:12288
    ds_read_b64_tr_b16 a[122:123], v104 offset:13312
    v_mfma_f32_32x32x16_bf16 v[0:15], a[56:59], a[24:27], v[0:15]
    ds_read_b64_tr_b16 a[124:125], v105 offset:12288
    ds_read_b64_tr_b16 a[126:127], v105 offset:13312
    v_mfma_f32_32x32x16_bf16 v[32:47], a[56:59], a[28:31], v[32:47]
    buffer_load_dwordx4 v114, s[84:87], s83 offen offset:2048 lds
    ds_read_b128 a[88:91], v102 offset:12288
    ds_read_b128 a[92:95], v103 offset:12288
    v_mfma_f32_32x32x16_bf16 v[16:31], a[60:63], a[24:27], v[16:31]
    buffer_load_dwordx4 v115, s[84:87], s83 offen offset:3072 lds
    s_add_u32 s83, s83, 131072
    s_add_u32 s37, s37, 32768
    s_cmp_eq_u32 s37, 163840
    s_cselect_b32 s37, 0, s37
    v_mfma_f32_32x32x16_bf16 v[48:63], a[60:63], a[28:31], v[48:63]
    s_add_u32 s36, s36, 32768
    s_cmp_eq_u32 s36, 163840
    s_cselect_b32 s36, 0, s36
    s_waitcnt lgkmcnt(0)
    v_mfma_f32_32x32x16_bf16 v[0:15], a[96:99], a[64:67], v[0:15]
    v_add_u32 v102, s36, v106
    v_add_u32 v103, s36, v107
    v_add_u32 v104, s36, v108
    v_add_u32 v105, s36, v109
    s_add_u32 m0, s37, s32
    v_mfma_f32_32x32x16_bf16 v[32:47], a[96:99], a[68:71], v[32:47]
    s_waitcnt vmcnt(24)
    s_barrier
    v_mfma_f32_32x32x16_bf16 v[16:31], a[100:103], a[64:67], v[16:31]
    buffer_load_dwordx4 v110, s[56:59], s34 offen offset:0 sc1 lds
    ds_read_b64_tr_b16 a[32:33], v104 offset:0
    ds_read_b64_tr_b16 a[34:35], v104 offset:1024
    v_mfma_f32_32x32x16_bf16 v[48:63], a[100:103], a[68:71], v[48:63]
    ds_read_b64_tr_b16 a[36:37], v105 offset:0
    ds_read_b64_tr_b16 a[38:39], v105 offset:1024
    v_mfma_f32_32x32x16_bf16 v[0:15], a[104:107], a[72:75], v[0:15]
    buffer_load_dwordx4 v110, s[56:59], s34 offen offset:1024 sc1 lds
    ds_read_b128 a[0:3], v102 offset:0
    ds_read_b128 a[4:7], v103 offset:0
    v_mfma_f32_32x32x16_bf16 v[32:47], a[104:107], a[76:79], v[32:47]
    buffer_load_dwordx4 v110, s[56:59], s34 offen offset:2048 sc1 lds
    ds_read_b64_tr_b16 a[40:41], v104 offset:4096
    ds_read_b64_tr_b16 a[42:43], v104 offset:5120
    v_mfma_f32_32x32x16_bf16 v[16:31], a[108:111], a[72:75], v[16:31]
    ds_read_b64_tr_b16 a[44:45], v105 offset:4096
    ds_read_b64_tr_b16 a[46:47], v105 offset:5120
    v_mfma_f32_32x32x16_bf16 v[48:63], a[108:111], a[76:79], v[48:63]
    buffer_load_dwordx4 v110, s[56:59], s34 offen offset:3072 sc1 lds
    s_add_u32 s34, s34, 16384
    ds_read_b128 a[8:11], v102 offset:4096
    ds_read_b128 a[12:15], v103 offset:4096
    v_mfma_f32_32x32x16_bf16 v[0:15], a[112:115], a[80:83], v[0:15]
    s_add_u32 m0, s37, s33
    ds_read_b64_tr_b16 a[48:49], v104 offset:8192
    ds_read_b64_tr_b16 a[50:51], v104 offset:9216
    v_mfma_f32_32x32x16_bf16 v[32:47], a[112:115], a[84:87], v[32:47]
    ds_read_b64_tr_b16 a[52:53], v105 offset:8192
    ds_read_b64_tr_b16 a[54:55], v105 offset:9216
    v_mfma_f32_32x32x16_bf16 v[16:31], a[116:119], a[80:83], v[16:31]
    buffer_load_dwordx4 v112, s[84:87], s83 offen offset:0 lds
    ds_read_b128 a[16:19], v102 offset:8192
    ds_read_b128 a[20:23], v103 offset:8192
    v_mfma_f32_32x32x16_bf16 v[48:63], a[116:119], a[84:87], v[48:63]
    buffer_load_dwordx4 v113, s[84:87], s83 offen offset:1024 lds
    ds_read_b64_tr_b16 a[56:57], v104 offset:12288
    ds_read_b64_tr_b16 a[58:59], v104 offset:13312
    v_mfma_f32_32x32x16_bf16 v[0:15], a[120:123], a[88:91], v[0:15]
    ds_read_b64_tr_b16 a[60:61], v105 offset:12288
    ds_read_b64_tr_b16 a[62:63], v105 offset:13312
    v_mfma_f32_32x32x16_bf16 v[32:47], a[120:123], a[92:95], v[32:47]
    buffer_load_dwordx4 v114, s[84:87], s83 offen offset:2048 lds
    ds_read_b128 a[24:27], v102 offset:12288
    ds_read_b128 a[28:31], v103 offset:12288
    v_mfma_f32_32x32x16_bf16 v[16:31], a[124:127], a[88:91], v[16:31]
    buffer_load_dwordx4 v115, s[84:87], s83 offen offset:3072 lds
    s_add_u32 s83, s83, 131072
    s_add_u32 s37, s37, 32768
    s_cmp_eq_u32 s37, 163840
    s_cselect_b32 s37, 0, s37
    v_mfma_f32_32x32x16_bf16 v[48:63], a[124:127], a[92:95], v[48:63]
    s_add_u32 s36, s36, 32768
    s_cmp_eq_u32 s36, 163840
    s_cselect_b32 s36, 0, s36
    s_sub_u32 s38, s38, 1
    s_cmp_lg_u32 s38, 0
    s_cbranch_scc1 L_b_g2
    s_waitcnt lgkmcnt(0)
    v_mfma_f32_32x32x16_bf16 v[0:15], a[32:35], a[0:3], v[0:15]
    v_add_u32 v102, s36, v106
    v_add_u32 v103, s36, v107
    v_add_u32 v104, s36, v108
    v_add_u32 v105, s36, v109
    s_add_u32 m0, s37, s32
    v_mfma_f32_32x32x16_bf16 v[32:47], a[32:35], a[4:7], v[32:47]
    s_waitcnt vmcnt(24)
    s_barrier
    v_mfma_f32_32x32x16_bf16 v[16:31], a[36:39], a[0:3], v[16:31]
    buffer_load_dwordx4 v110, s[56:59], s34 offen offset:0 sc1 lds
    ds_read_b64_tr_b16 a[96:97], v104 offset:0
    ds_read_b64_tr_b16 a[98:99], v104 offset:1024
    v_mfma_f32_32x32x16_bf16 v[48:63], a[36:39], a[4:7], v[48:63]
    ds_read_b64_tr_b16 a[100:101], v105 offset:0
    ds_read_b64_tr_b16 a[102:103], v105 offset:1024
    v_mfma_f32_32x32x16_bf16 v[0:15], a[40:43], a[8:11], v[0:15]
    buffer_load_dwordx4 v110, s[56:59], s34 offen offset:1024 sc1 lds
    ds_read_b128 a[64:67], v102 offset:0
    ds_read_b128 a[68:71], v103 offset:0
    v_mfma_f32_32x32x16_bf16 v[32:47], a[40:43], a[12:15], v[32:47]
    buffer_load_dwordx4 v110, s[56:59], s34 offen offset:2048 sc1 lds
    ds_read_b64_tr_b16 a[104:105], v104 offset:4096
    ds_read_b64_tr_b16 a[106:107], v104 offset:5120
    v_mfma_f32_32x32x16_bf16 v[16:31], a[44:47], a[8:11], v[16:31]
    ds_read_b64_tr_b16 a[108:109], v105 offset:4096
    ds_read_b64_tr_b16 a[110:111], v105 offset:5120
    v_mfma_f32_32x32x16_bf16 v[48:63], a[44:47], a[12:15], v[48:63]
    buffer_load_dwordx4 v110, s[56:59], s34 offen offset:3072 sc1 lds
    s_add_u32 s34, s34, 16384
    ds_read_b128 a[72:75], v102 offset:4096
    ds_read_b128 a[76:79], v103 offset:4096
    v_mfma_f32_32x32x16_bf16 v[0:15], a[48:51], a[16:19], v[0:15]
    s_add_u32 m0, s37, s33
    ds_read_b64_tr_b16 a[112:113], v104 offset:8192
    ds_read_b64_tr_b16 a[114:115], v104 offset:9216
    v_mfma_f32_32x32x16_bf16 v[32:47], a[48:51], a[20:23], v[32:47]
    ds_read_b64_tr_b16 a[116:117], v105 offset:8192
    ds_read_b64_tr_b16 a[118:119], v105 offset:9216
    v_mfma_f32_32x32x16_bf16 v[16:31], a[52:55], a[16:19], v[16:31]
    buffer_load_dwordx4 v112, s[84:87], s83 offen offset:0 lds
    ds_read_b128 a[80:83], v102 offset:8192
    ds_read_b128 a[84:87], v103 offset:8192
    v_mfma_f32_32x32x16_bf16 v[48:63], a[52:55], a[20:23], v[48:63]
    buffer_load_dwordx4 v113, s[84:87], s83 offen offset:1024 lds
    ds_read_b64_tr_b16 a[120:121], v104 offset:12288
    ds_read_b64_tr_b16 a[122:123], v104 offset:13312
    v_mfma_f32_32x32x16_bf16 v[0:15], a[56:59], a[24:27], v[0:15]
    ds_read_b64_tr_b16 a[124:125], v105 offset:12288
    ds_read_b64_tr_b16 a[126:127], v105 offset:13312
    v_mfma_f32_32x32x16_bf16 v[32:47], a[56:59], a[28:31], v[32:47]
    buffer_load_dwordx4 v114, s[84:87], s83 offen offset:2048 lds
    ds_read_b128 a[88:91], v102 offset:12288
    ds_read_b128 a[92:95], v103 offset:12288
    v_mfma_f32_32x32x16_bf16 v[16:31], a[60:63], a[24:27], v[16:31]
    buffer_load_dwordx4 v115, s[84:87], s83 offen offset:3072 lds
    s_add_u32 s83, s83, 131072
    s_add_u32 s37, s37, 32768
    s_cmp_eq_u32 s37, 163840
    s_cselect_b32 s37, 0, s37
    v_mfma_f32_32x32x16_bf16 v[48:63], a[60:63], a[28:31], v[48:63]
    s_add_u32 s36, s36, 32768
    s_cmp_eq_u32 s36, 163840
    s_cselect_b32 s36, 0, s36
    s_waitcnt lgkmcnt(0)
    v_mfma_f32_32x32x16_bf16 v[0:15], a[96:99], a[64:67], v[0:15]
    v_add_u32 v102, s36, v106
    v_add_u32 v103, s36, v107
    v_add_u32 v104, s36, v108
    v_add_u32 v105, s36, v109
    v_mfma_f32_32x32x16_bf16 v[32:47], a[96:99], a[68:71], v[32:47]
    s_waitcnt vmcnt(24)
    s_barrier
    v_mfma_f32_32x32x16_bf16 v[16:31], a[100:103], a[64:67], v[16:31]
    ds_read_b64_tr_b16 a[32:33], v104 offset:0
    ds_read_b64_tr_b16 a[34:35], v104 offset:1024
    v_mfma_f32_32x32x16_bf16 v[48:63], a[100:103], a[68:71], v[48:63]
    ds_read_b64_tr_b16 a[36:37], v105 offset:0
    ds_read_b64_tr_b16 a[38:39], v105 offset:1024
    v_mfma_f32_32x32x16_bf16 v[0:15], a[104:107], a[72:75], v[0:15]
    ds_read_b128 a[0:3], v102 offset:0
    ds_read_b128 a[4:7], v103 offset:0
    v_mfma_f32_32x32x16_bf16 v[32:47], a[104:107], a[76:79], v[32:47]
    ds_read_b64_tr_b16 a[40:41], v104 offset:4096
    ds_read_b64_tr_b16 a[42:43], v104 offset:5120
    v_mfma_f32_32x32x16_bf16 v[16:31], a[108:111], a[72:75], v[16:31]
    ds_read_b64_tr_b16 a[44:45], v105 offset:4096
    ds_read_b64_tr_b16 a[46:47], v105 offset:5120
    v_mfma_f32_32x32x16_bf16 v[48:63], a[108:111], a[76:79], v[48:63]
    ds_read_b128 a[8:11], v102 offset:4096
    ds_read_b128 a[12:15], v103 offset:4096
    v_mfma_f32_32x32x16_bf16 v[0:15], a[112:115], a[80:83], v[0:15]
    ds_read_b64_tr_b16 a[48:49], v104 offset:8192
    ds_read_b64_tr_b16 a[50:51], v104 offset:9216
    v_mfma_f32_32x32x16_bf16 v[32:47], a[112:115], a[84:87], v[32:47]
    ds_read_b64_tr_b16 a[52:53], v105 offset:8192
    ds_read_b64_tr_b16 a[54:55], v105 offset:9216
    v_mfma_f32_32x32x16_bf16 v[16:31], a[116:119], a[80:83], v[16:31]
    ds_read_b128 a[16:19], v102 offset:8192
    ds_read_b128 a[20:23], v103 offset:8192
    v_mfma_f32_32x32x16_bf16 v[48:63], a[116:119], a[84:87], v[48:63]
    ds_read_b64_tr_b16 a[56:57], v104 offset:12288
    ds_read_b64_tr_b16 a[58:59], v104 offset:13312
    v_mfma_f32_32x32x16_bf16 v[0:15], a[120:123], a[88:91], v[0:15]
    ds_read_b64_tr_b16 a[60:61], v105 offset:12288
    ds_read_b64_tr_b16 a[62:63], v105 offset:13312
    v_mfma_f32_32x32x16_bf16 v[32:47], a[120:123], a[92:95], v[32:47]
    ds_read_b128 a[24:27], v102 offset:12288
    ds_read_b128 a[28:31], v103 offset:12288
    v_mfma_f32_32x32x16_bf16 v[16:31], a[124:127], a[88:91], v[16:31]
    v_mfma_f32_32x32x16_bf16 v[48:63], a[124:127], a[92:95], v[48:63]
    s_add_u32 s36, s36, 32768
    s_cmp_eq_u32 s36, 163840
    s_cselect_b32 s36, 0, s36
    s_waitcnt lgkmcnt(0)
    v_mfma_f32_32x32x16_bf16 v[0:15], a[32:35], a[0:3], v[0:15]
    v_add_u32 v102, s36, v106
    v_add_u32 v103, s36, v107
    v_add_u32 v104, s36, v108
    v_add_u32 v105, s36, v109
    v_mfma_f32_32x32x16_bf16 v[32:47], a[32:35], a[4:7], v[32:47]
    s_waitcnt vmcnt(16)
    s_barrier
    v_mfma_f32_32x32x16_bf16 v[16:31], a[36:39], a[0:3], v[16:31]
    ds_read_b64_tr_b16 a[96:97], v104 offset:0
    ds_read_b64_tr_b16 a[98:99], v104 offset:1024
    v_mfma_f32_32x32x16_bf16 v[48:63], a[36:39], a[4:7], v[48:63]
    ds_read_b64_tr_b16 a[100:101], v105 offset:0
    ds_read_b64_tr_b16 a[102:103], v105 offset:1024
    v_mfma_f32_32x32x16_bf16 v[0:15], a[40:43], a[8:11], v[0:15]
    ds_read_b128 a[64:67], v102 offset:0
    ds_read_b128 a[68:71], v103 offset:0
    v_mfma_f32_32x32x16_bf16 v[32:47], a[40:43], a[12:15], v[32:47]
    ds_read_b64_tr_b16 a[104:105], v104 offset:4096
    ds_read_b64_tr_b16 a[106:107], v104 offset:5120
    v_mfma_f32_32x32x16_bf16 v[16:31], a[44:47], a[8:11], v[16:31]
    ds_read_b64_tr_b16 a[108:109], v105 offset:4096
    ds_read_b64_tr_b16 a[110:111], v105 offset:5120
    v_mfma_f32_32x32x16_bf16 v[48:63], a[44:47], a[12:15], v[48:63]
    ds_read_b128 a[72:75], v102 offset:4096
    ds_read_b128 a[76:79], v103 offset:4096
    v_mfma_f32_32x32x16_bf16 v[0:15], a[48:51], a[16:19], v[0:15]
    ds_read_b64_tr_b16 a[112:113], v104 offset:8192
    ds_read_b64_tr_b16 a[114:115], v104 offset:9216
    v_mfma_f32_32x32x16_bf16 v[32:47], a[48:51], a[20:23], v[32:47]
    ds_read_b64_tr_b16 a[116:117], v105 offset:8192
    ds_read_b64_tr_b16 a[118:119], v105 offset:9216
    v_mfma_f32_32x32x16_bf16 v[16:31], a[52:55], a[16:19], v[16:31]
    ds_read_b128 a[80:83], v102 offset:8192
    ds_read_b128 a[84:87], v103 offset:8192
    v_mfma_f32_32x32x16_bf16 v[48:63], a[52:55], a[20:23], v[48:63]
    ds_read_b64_tr_b16 a[120:121], v104 offset:12288
    ds_read_b64_tr_b16 a[122:123], v104 offset:13312
    v_mfma_f32_32x32x16_bf16 v[0:15], a[56:59], a[24:27], v[0:15]
    ds_read_b64_tr_b16 a[124:125], v105 offset:12288
    ds_read_b64_tr_b16 a[126:127], v105 offset:13312
    v_mfma_f32_32x32x16_bf16 v[32:47], a[56:59], a[28:31], v[32:47]
    ds_read_b128 a[88:91], v102 offset:12288
    ds_read_b128 a[92:95], v103 offset:12288
    v_mfma_f32_32x32x16_bf16 v[16:31], a[60:63], a[24:27], v[16:31]
    v_mfma_f32_32x32x16_bf16 v[48:63], a[60:63], a[28:31], v[48:63]
    s_add_u32 s36, s36, 32768
    s_cmp_eq_u32 s36, 163840
    s_cselect_b32 s36, 0, s36
    s_waitcnt lgkmcnt(0)
    v_mfma_f32_32x32x16_bf16 v[0:15], a[96:99], a[64:67], v[0:15]
    v_add_u32 v102, s36, v106
    v_add_u32 v103, s36, v107
    v_add_u32 v104, s36, v108
    v_add_u32 v105, s36, v109
    v_mfma_f32_32x32x16_bf16 v[32:47], a[96:99], a[68:71], v[32:47]
    s_waitcnt vmcnt(8)
    s_barrier
    v_mfma_f32_32x32x16_bf16 v[16:31], a[100:103], a[64:67], v[16:31]
    ds_read_b64_tr_b16 a[32:33], v104 offset:0
    ds_read_b64_tr_b16 a[34:35], v104 offset:1024
    v_mfma_f32_32x32x16_bf16 v[48:63], a[100:103], a[68:71], v[48:63]
    ds_read_b64_tr_b16 a[36:37], v105 offset:0
    ds_read_b64_tr_b16 a[38:39], v105 offset:1024
    v_mfma_f32_32x32x16_bf16 v[0:15], a[104:107], a[72:75], v[0:15]
    ds_read_b128 a[0:3], v102 offset:0
    ds_read_b128 a[4:7], v103 offset:0
    v_mfma_f32_32x32x16_bf16 v[32:47], a[104:107], a[76:79], v[32:47]
    ds_read_b64_tr_b16 a[40:41], v104 offset:4096
    ds_read_b64_tr_b16 a[42:43], v104 offset:5120
    v_mfma_f32_32x32x16_bf16 v[16:31], a[108:111], a[72:75], v[16:31]
    ds_read_b64_tr_b16 a[44:45], v105 offset:4096
    ds_read_b64_tr_b16 a[46:47], v105 offset:5120
    v_mfma_f32_32x32x16_bf16 v[48:63], a[108:111], a[76:79], v[48:63]
    ds_read_b128 a[8:11], v102 offset:4096
    ds_read_b128 a[12:15], v103 offset:4096
    v_mfma_f32_32x32x16_bf16 v[0:15], a[112:115], a[80:83], v[0:15]
    ds_read_b64_tr_b16 a[48:49], v104 offset:8192
    ds_read_b64_tr_b16 a[50:51], v104 offset:9216
    v_mfma_f32_32x32x16_bf16 v[32:47], a[112:115], a[84:87], v[32:47]
    ds_read_b64_tr_b16 a[52:53], v105 offset:8192
    ds_read_b64_tr_b16 a[54:55], v105 offset:9216
    v_mfma_f32_32x32x16_bf16 v[16:31], a[116:119], a[80:83], v[16:31]
    ds_read_b128 a[16:19], v102 offset:8192
    ds_read_b128 a[20:23], v103 offset:8192
    v_mfma_f32_32x32x16_bf16 v[48:63], a[116:119], a[84:87], v[48:63]
    ds_read_b64_tr_b16 a[56:57], v104 offset:12288
    ds_read_b64_tr_b16 a[58:59], v104 offset:13312
    v_mfma_f32_32x32x16_bf16 v[0:15], a[120:123], a[88:91], v[0:15]
    ds_read_b64_tr_b16 a[60:61], v105 offset:12288
    ds_read_b64_tr_b16 a[62:63], v105 offset:13312
    v_mfma_f32_32x32x16_bf16 v[32:47], a[120:123], a[92:95], v[32:47]
    ds_read_b128 a[24:27], v102 offset:12288
    ds_read_b128 a[28:31], v103 offset:12288
    v_mfma_f32_32x32x16_bf16 v[16:31], a[124:127], a[88:91], v[16:31]
    v_mfma_f32_32x32x16_bf16 v[48:63], a[124:127], a[92:95], v[48:63]
    s_add_u32 s36, s36, 32768
    s_cmp_eq_u32 s36, 163840
    s_cselect_b32 s36, 0, s36
    s_waitcnt lgkmcnt(0)
    v_mfma_f32_32x32x16_bf16 v[0:15], a[32:35], a[0:3], v[0:15]
    v_add_u32 v102, s36, v106
    v_add_u32 v103, s36, v107
    v_add_u32 v104, s36, v108
    v_add_u32 v105, s36, v109
    v_mfma_f32_32x32x16_bf16 v[32:47], a[32:35], a[4:7], v[32:47]
    s_waitcnt vmcnt(0)
    s_barrier
    v_mfma_f32_32x32x16_bf16 v[16:31], a[36:39], a[0:3], v[16:31]
    ds_read_b64_tr_b16 a[96:97], v104 offset:0
    ds_read_b64_tr_b16 a[98:99], v104 offset:1024
    v_mfma_f32_32x32x16_bf16 v[48:63], a[36:39], a[4:7], v[48:63]
    ds_read_b64_tr_b16 a[100:101], v105 offset:0
    ds_read_b64_tr_b16 a[102:103], v105 offset:1024
    v_mfma_f32_32x32x16_bf16 v[0:15], a[40:43], a[8:11], v[0:15]
    ds_read_b128 a[64:67], v102 offset:0
    ds_read_b128 a[68:71], v103 offset:0
    v_mfma_f32_32x32x16_bf16 v[32:47], a[40:43], a[12:15], v[32:47]
    ds_read_b64_tr_b16 a[104:105], v104 offset:4096
    ds_read_b64_tr_b16 a[106:107], v104 offset:5120
    v_mfma_f32_32x32x16_bf16 v[16:31], a[44:47], a[8:11], v[16:31]
    ds_read_b64_tr_b16 a[108:109], v105 offset:4096
    ds_read_b64_tr_b16 a[110:111], v105 offset:5120
    v_mfma_f32_32x32x16_bf16 v[48:63], a[44:47], a[12:15], v[48:63]
    ds_read_b128 a[72:75], v102 offset:4096
    ds_read_b128 a[76:79], v103 offset:4096
    v_mfma_f32_32x32x16_bf16 v[0:15], a[48:51], a[16:19], v[0:15]
    ds_read_b64_tr_b16 a[112:113], v104 offset:8192
    ds_read_b64_tr_b16 a[114:115], v104 offset:9216
    v_mfma_f32_32x32x16_bf16 v[32:47], a[48:51], a[20:23], v[32:47]
    ds_read_b64_tr_b16 a[116:117], v105 offset:8192
    ds_read_b64_tr_b16 a[118:119], v105 offset:9216
    v_mfma_f32_32x32x16_bf16 v[16:31], a[52:55], a[16:19], v[16:31]
    ds_read_b128 a[80:83], v102 offset:8192
    ds_read_b128 a[84:87], v103 offset:8192
    v_mfma_f32_32x32x16_bf16 v[48:63], a[52:55], a[20:23], v[48:63]
    ds_read_b64_tr_b16 a[120:121], v104 offset:12288
    ds_read_b64_tr_b16 a[122:123], v104 offset:13312
    v_mfma_f32_32x32x16_bf16 v[0:15], a[56:59], a[24:27], v[0:15]
    ds_read_b64_tr_b16 a[124:125], v105 offset:12288
    ds_read_b64_tr_b16 a[126:127], v105 offset:13312
    v_mfma_f32_32x32x16_bf16 v[32:47], a[56:59], a[28:31], v[32:47]
    ds_read_b128 a[88:91], v102 offset:12288
    ds_read_b128 a[92:95], v103 offset:12288
    v_mfma_f32_32x32x16_bf16 v[16:31], a[60:63], a[24:27], v[16:31]
    v_mfma_f32_32x32x16_bf16 v[48:63], a[60:63], a[28:31], v[48:63]
    s_add_u32 s36, s36, 32768
    s_cmp_eq_u32 s36, 163840
    s_cselect_b32 s36, 0, s36
    s_waitcnt lgkmcnt(0)
    v_mfma_f32_32x32x16_bf16 v[32:47], a[96:99], a[68:71], v[32:47]
    v_mfma_f32_32x32x16_bf16 v[48:63], a[100:103], a[68:71], v[48:63]
    v_mfma_f32_32x32x16_bf16 v[32:47], a[104:107], a[76:79], v[32:47]
    v_mfma_f32_32x32x16_bf16 v[48:63], a[108:111], a[76:79], v[48:63]
    v_mfma_f32_32x32x16_bf16 v[32:47], a[112:115], a[84:87], v[32:47]
    v_mfma_f32_32x32x16_bf16 v[48:63], a[116:119], a[84:87], v[48:63]
    v_mfma_f32_32x32x16_bf16 v[32:47], a[120:123], a[92:95], v[32:47]
    v_mfma_f32_32x32x16_bf16 v[48:63], a[124:127], a[92:95], v[48:63]
    v_mfma_f32_32x32x16_bf16 v[0:15], a[96:99], a[64:67], v[0:15]
    v_mfma_f32_32x32x16_bf16 v[16:31], a[100:103], a[64:67], v[16:31]
    v_mfma_f32_32x32x16_bf16 v[0:15], a[104:107], a[72:75], v[0:15]
    v_mfma_f32_32x32x16_bf16 v[16:31], a[108:111], a[72:75], v[16:31]
    v_mfma_f32_32x32x16_bf16 v[0:15], a[112:115], a[80:83], v[0:15]
    v_mfma_f32_32x32x16_bf16 v[16:31], a[116:119], a[80:83], v[16:31]
    v_mfma_f32_32x32x16_bf16 v[0:15], a[120:123], a[88:91], v[0:15]
    v_mfma_f32_32x32x16_bf16 v[16:31], a[124:127], a[88:91], v[16:31]
    s_add_u32 s36, s36, 32768
    s_cmp_eq_u32 s36, 163840
    s_cselect_b32 s36, 0, s36
    s_add_u32 s24, s4, 46137344
    s_addc_u32 s25, s5, 0
    s_mov_b32 s26, 4194304
    s_mov_b32 s27, 0x00020000
    s_lshl_b32 s52, s2, 2
    s_add_u32 s52, s52, s3
    s_xor_b32 s53, s52, 4
    s_lshl_b32 s60, s52, 12
    s_lshl_b32 s61, s53, 12
    v_lshlrev_b32 v116, 4, v100
    v_cvt_pk_bf16_f32 v176, v32, v33
    v_cvt_pk_bf16_f32 v177, v34, v35
    v_cvt_pk_bf16_f32 v178, v36, v37
    v_cvt_pk_bf16_f32 v179, v38, v39
    buffer_store_dwordx4 v[176:179], v116, s[24:27], s60 offen offset:0 sc1
    v_cvt_pk_bf16_f32 v180, v40, v41
    v_cvt_pk_bf16_f32 v181, v42, v43
    v_cvt_pk_bf16_f32 v182, v44, v45
    v_cvt_pk_bf16_f32 v183, v46, v47
    buffer_store_dwordx4 v[180:183], v116, s[24:27], s60 offen offset:1024 sc1
    v_cvt_pk_bf16_f32 v184, v48, v49
    v_cvt_pk_bf16_f32 v185, v50, v51
    v_cvt_pk_bf16_f32 v186, v52, v53
    v_cvt_pk_bf16_f32 v187, v54, v55
    buffer_store_dwordx4 v[184:187], v116, s[24:27], s60 offen offset:2048 sc1
    v_cvt_pk_bf16_f32 v188, v56, v57
    v_cvt_pk_bf16_f32 v189, v58, v59
    v_cvt_pk_bf16_f32 v190, v60, v61
    v_cvt_pk_bf16_f32 v191, v62, v63
    buffer_store_dwordx4 v[188:191], v116, s[24:27], s60 offen offset:3072 sc1
    v_lshlrev_b32 v192, 16, v64
    v_and_b32 v193, 0xffff0000, v64
    v_lshlrev_b32 v194, 16, v65
    v_and_b32 v195, 0xffff0000, v65
    v_lshlrev_b32 v196, 16, v66
    v_and_b32 v197, 0xffff0000, v66
    v_lshlrev_b32 v198, 16, v67
    v_and_b32 v199, 0xffff0000, v67
    v_lshlrev_b32 v200, 16, v68
    v_and_b32 v201, 0xffff0000, v68
    v_lshlrev_b32 v202, 16, v69
    v_and_b32 v203, 0xffff0000, v69
    v_lshlrev_b32 v204, 16, v70
    v_and_b32 v205, 0xffff0000, v70
    v_lshlrev_b32 v206, 16, v71
    v_and_b32 v207, 0xffff0000, v71
    v_lshlrev_b32 v208, 16, v72
    v_and_b32 v209, 0xffff0000, v72
    v_lshlrev_b32 v210, 16, v73
    v_and_b32 v211, 0xffff0000, v73
    v_lshlrev_b32 v212, 16, v74
    v_and_b32 v213, 0xffff0000, v74
    v_lshlrev_b32 v214, 16, v75
    v_and_b32 v215, 0xffff0000, v75
    v_lshlrev_b32 v216, 16, v76
    v_and_b32 v217, 0xffff0000, v76
    v_lshlrev_b32 v218, 16, v77
    v_and_b32 v219, 0xffff0000, v77
    v_lshlrev_b32 v220, 16, v78
    v_and_b32 v221, 0xffff0000, v78
    v_lshlrev_b32 v222, 16, v79
    v_and_b32 v223, 0xffff0000, v79
    v_fmac_f32 v192, v128, v0
    v_fmac_f32 v193, v129, v1
    v_fmac_f32 v194, v130, v2
    v_fmac_f32 v195, v131, v3
    v_fmac_f32 v196, v132, v4
    v_fmac_f32 v197, v133, v5
    v_fmac_f32 v198, v134, v6
    v_fmac_f32 v199, v135, v7
    v_fmac_f32 v200, v136, v8
    v_fmac_f32 v201, v137, v9
    v_fmac_f32 v202, v138, v10
    v_fmac_f32 v203, v139, v11
    v_fmac_f32 v204, v140, v12
    v_fmac_f32 v205, v141, v13
    v_fmac_f32 v206, v142, v14
    v_fmac_f32 v207, v143, v15
    v_fmac_f32 v208, v144, v16
    v_fmac_f32 v209, v145, v17
    v_fmac_f32 v210, v146, v18
    v_fmac_f32 v211, v147, v19
    v_fmac_f32 v212, v148, v20
    v_fmac_f32 v213, v149, v21
    v_fmac_f32 v214, v150, v22
    v_fmac_f32 v215, v151, v23
    v_fmac_f32 v216, v152, v24
    v_fmac_f32 v217, v153, v25
    v_fmac_f32 v218, v154, v26
    v_fmac_f32 v219, v155, v27
    v_fmac_f32 v220, v156, v28
    v_fmac_f32 v221, v157, v29
    v_fmac_f32 v222, v158, v30
    v_fmac_f32 v223, v159, v31
    s_mov_b32 s66, 0x40000
L_b_xpoll:
    buffer_load_dwordx4 v[160:163], v116, s[24:27], s61 offen offset:0 sc1
    buffer_load_dwordx4 v[164:167], v116, s[24:27], s61 offen offset:1024 sc1
    buffer_load_dwordx4 v[168:171], v116, s[24:27], s61 offen offset:2048 sc1
    buffer_load_dwordx4 v[172:175], v116, s[24:27], s61 offen offset:3072 sc1
    s_waitcnt vmcnt(0)
    v_max3_u32 v98, v160, v161, v162
    v_max3_u32 v98, v98, v163, v164
    v_max3_u32 v98, v98, v165, v166
    v_max3_u32 v98, v98, v167, v168
    v_max3_u32 v98, v98, v169, v170
    v_max3_u32 v98, v98, v171, v172
    v_max3_u32 v98, v98, v173, v174
    v_max_u32 v98, v98, v175
    v_cmp_eq_u32 vcc, -1, v98
    s_nop 1
    s_cmp_eq_u64 vcc, 0
    s_cbranch_scc1 L_b_xgot
    s_sub_u32 s66, s66, 1
    s_cmp_lg_u32 s66, 0
    s_cbranch_scc1 L_b_xpoll
L_b_xgot:
    v_lshlrev_b32 v98, 16, v160
    v_and_b32 v99, 0xffff0000, v160
    v_fmac_f32 v192, v128, v98
    v_fmac_f32 v193, v129, v99
    v_cvt_pk_bf16_f32 v120, v192, v193
    v_lshlrev_b32 v98, 16, v161
    v_and_b32 v99, 0xffff0000, v161
    v_fmac_f32 v194, v130, v98
    v_fmac_f32 v195, v131, v99
    v_cvt_pk_bf16_f32 v121, v194, v195
    v_lshlrev_b32 v98, 16, v162
    v_and_b32 v99, 0xffff0000, v162
    v_fmac_f32 v196, v132, v98
    v_fmac_f32 v197, v133, v99
    v_cvt_pk_bf16_f32 v122, v196, v197
    v_lshlrev_b32 v98, 16, v163
    v_and_b32 v99, 0xffff0000, v163
    v_fmac_f32 v198, v134, v98
    v_fmac_f32 v199, v135, v99
    v_cvt_pk_bf16_f32 v123, v198, v199
    buffer_store_dwordx4 v[120:123], v93, s[16:19], 0 offen offset:0
    v_lshlrev_b32 v98, 16, v164
    v_and_b32 v99, 0xffff0000, v164
    v_fmac_f32 v200, v136, v98
    v_fmac_f32 v201, v137, v99
    v_cvt_pk_bf16_f32 v124, v200, v201
    v_lshlrev_b32 v98, 16, v165
    v_and_b32 v99, 0xffff0000, v165
    v_fmac_f32 v202, v138, v98
    v_fmac_f32 v203, v139, v99
    v_cvt_pk_bf16_f32 v125, v202, v203
    v_lshlrev_b32 v98, 16, v166
    v_and_b32 v99, 0xffff0000, v166
    v_fmac_f32 v204, v140, v98
    v_fmac_f32 v205, v141, v99
    v_cvt_pk_bf16_f32 v126, v204, v205
    v_lshlrev_b32 v98, 16, v167
    v_and_b32 v99, 0xffff0000, v167
    v_fmac_f32 v206, v142, v98
    v_fmac_f32 v207, v143, v99
    v_cvt_pk_bf16_f32 v127, v206, v207
    buffer_store_dwordx4 v[124:127], v93, s[16:19], 0 offen offset:32
    v_lshlrev_b32 v98, 16, v168
    v_and_b32 v99, 0xffff0000, v168
    v_fmac_f32 v208, v144, v98
    v_fmac_f32 v209, v145, v99
    v_cvt_pk_bf16_f32 v120, v208, v209
    v_lshlrev_b32 v98, 16, v169
    v_and_b32 v99, 0xffff0000, v169
    v_fmac_f32 v210, v146, v98
    v_fmac_f32 v211, v147, v99
    v_cvt_pk_bf16_f32 v121, v210, v211
    v_lshlrev_b32 v98, 16, v170
    v_and_b32 v99, 0xffff0000, v170
    v_fmac_f32 v212, v148, v98
    v_fmac_f32 v213, v149, v99
    v_cvt_pk_bf16_f32 v122, v212, v213
    v_lshlrev_b32 v98, 16, v171
    v_and_b32 v99, 0xffff0000, v171
    v_fmac_f32 v214, v150, v98
    v_fmac_f32 v215, v151, v99
    v_cvt_pk_bf16_f32 v123, v214, v215
    buffer_store_dwordx4 v[120:123], v93, s[16:19], 0 offen offset:64
    v_lshlrev_b32 v98, 16, v172
    v_and_b32 v99, 0xffff0000, v172
    v_fmac_f32 v216, v152, v98
    v_fmac_f32 v217, v153, v99
    v_cvt_pk_bf16_f32 v124, v216, v217
    v_lshlrev_b32 v98, 16, v173
    v_and_b32 v99, 0xffff0000, v173
    v_fmac_f32 v218, v154, v98
    v_fmac_f32 v219, v155, v99
    v_cvt_pk_bf16_f32 v125, v218, v219
    v_lshlrev_b32 v98, 16, v174
    v_and_b32 v99, 0xffff0000, v174
    v_fmac_f32 v220, v156, v98
    v_fmac_f32 v221, v157, v99
    v_cvt_pk_bf16_f32 v126, v220, v221
    v_lshlrev_b32 v98, 16, v175
    v_and_b32 v99, 0xffff0000, v175
    v_fmac_f32 v222, v158, v98
    v_fmac_f32 v223, v159, v99
    v_cvt_pk_bf16_f32 v127, v222, v223
    buffer_store_dwordx4 v[124:127], v93, s[16:19], 0 offen offset:96
L_adaLN_cond__ssm_conv_h3__glu_gated_geglu__prompt_kernel_end:
    s_endpgm
.section .rodata,"a"
.p2align 6
.amdhsa_kernel adaLN_cond__ssm_conv_h3__glu_gated_geglu__prompt_kernel
  .amdhsa_next_free_vgpr 512
  .amdhsa_next_free_sgpr 102
  .amdhsa_accum_offset 256
  .amdhsa_group_segment_fixed_size 0
  .amdhsa_kernarg_size 120
  .amdhsa_user_sgpr_count 2
  .amdhsa_user_sgpr_kernarg_segment_ptr 1
  .amdhsa_system_sgpr_workgroup_id_x 1
  .amdhsa_float_denorm_mode_32 3
  .amdhsa_float_denorm_mode_16_64 3
.end_amdhsa_kernel
```
